```python
import torch

def _softmax(x, axis=-1):
    return torch.softmax(x, dim=axis)
def _gelu(x):
    return torch.nn.functional.gelu(x, approximate="tanh")
def _silu(x):
    return torch.nn.functional.silu(x)
def _sigmoid(x):
    return torch.sigmoid(x)
def _layernorm(x, axis=-1, eps=1e-5):
    m = x.mean(dim=axis, keepdim=True)
    v = x.var(dim=axis, keepdim=True, unbiased=False)
    return (x - m) / torch.sqrt(v + eps)
def _scatter_add(tgt, idx, src, axis=0):
    return tgt.clone().index_add_(axis, idx, src)
def _segment_sum(src, seg, n):
    out = torch.zeros((n,) + src.shape[1:], dtype=src.dtype)
    return out.index_add_(0, seg, src)
def _pad(x, pw):
    flat = tuple(v for pair in reversed(pw) for v in pair)
    return torch.nn.functional.pad(x, flat)

kernel_name = 'sequential_preLN__ssm_conv_s4__mixer_s_mlp__prompt'

def setup_inputs():

    _w = (lambda a: (lambda t: t.to(torch.bfloat16) if t.is_floating_point() else t)(torch.as_tensor(a)))
    def _A_setup():
        B, L, D, N = 1, 2048, 640, 192
        A_re = -(lambda _x: torch.exp(torch.as_tensor(_x)))((lambda *s: torch.randn(*s, dtype=torch.bfloat16) * 6.4)(D, N))
        A_im = torch.pi * (lambda *s: torch.randn(*s, dtype=torch.bfloat16) * 0.05)(D, N)
        B_re = (lambda *s: torch.randn(*s, dtype=torch.bfloat16) * 0.05)(D, N)
        B_im = (lambda *s: torch.randn(*s, dtype=torch.bfloat16) * 0.05)(D, N)
        C_re = (lambda *s: torch.randn(*s, dtype=torch.bfloat16) * 0.05)(D, N)
        C_im = (lambda *s: torch.randn(*s, dtype=torch.bfloat16) * 0.05)(D, N)
        log_dt = (lambda *s: torch.randn(*s, dtype=torch.bfloat16) * 0.05)(D) * 0.5 - 4.0
        Dskip = (lambda *s: torch.randn(*s, dtype=torch.bfloat16) * 0.05)(D)
        return {
            "u": _w((lambda *s: torch.randn(*s, dtype=torch.bfloat16) * 0.05)(B, L, D)),
            "A_re": _w(A_re),
            "A_im": _w(A_im),
            "B_re": _w(B_re),
            "B_im": _w(B_im),
            "C_re": _w(C_re),
            "C_im": _w(C_im),
            "log_dt": _w(log_dt),
            "Dskip": _w(Dskip),
        }
    _A_in = _A_setup()

    def _B_setup():
        B, S, D, F = 1, 2048, 640, 1536
        return {
            "x":  _w((lambda *s: torch.randn(*s, dtype=torch.bfloat16) * 0.05)(B, S, D)),
            "w1": _w((lambda *s: torch.randn(*s, dtype=torch.bfloat16) * 6.4)(D, D) * (D ** -0.5)),
            "w2": _w((lambda *s: torch.randn(*s, dtype=torch.bfloat16) * 6.4)(D, D) * (D ** -0.5)),
            "w3": _w((lambda *s: torch.randn(*s, dtype=torch.bfloat16) * 6.4)(D, F) * (D ** -0.5)),
            "w4": _w((lambda *s: torch.randn(*s, dtype=torch.bfloat16) * 6.4)(F, D) * (F ** -0.5)),
        }
    _B_in = _B_setup()

    return {
        "A_u": _A_in["u"],
        "A_A_re": _A_in["A_re"],
        "A_A_im": _A_in["A_im"],
        "A_B_re": _A_in["B_re"],
        "A_B_im": _A_in["B_im"],
        "A_C_re": _A_in["C_re"],
        "A_C_im": _A_in["C_im"],
        "A_log_dt": _A_in["log_dt"],
        "A_Dskip": _A_in["Dskip"],
        "B_x": _B_in["x"],
        "B_w1": _B_in["w1"],
        "B_w2": _B_in["w2"],
        "B_w3": _B_in["w3"],
        "B_w4": _B_in["w4"],
    }

def reference(A_u, A_A_re, A_A_im, A_B_re, A_B_im, A_C_re, A_C_im, A_log_dt, A_Dskip, B_x, B_w1, B_w2, B_w3, B_w4):
    def _A_ref(u, A_re, A_im, B_re, B_im, C_re, C_im, log_dt, Dskip):
        Bsz, L, D = u.shape
        dt = torch.exp(log_dt)[:, None]
        A = A_re + 1j * A_im
        Bc = B_re + 1j * B_im
        Cc = C_re + 1j * C_im
        logdA = dt * A
        dB = dt * Bc
        l = (lambda x, dt: x.to(dt))(torch.arange(L), A_re.dtype)
        P = torch.exp(logdA[:, :, None] * l[None, None, :])
        K = torch.einsum("dn,dnl,dn->dl", Cc, P, dB).real
        L2 = 2 * L
        Kp = _pad(K, ((0, 0), (0, L)))
        up = (lambda x, *d: x.permute(*d))(u, 0, 2, 1)
        up = _pad(up, ((0, 0), (0, 0), (0, L)))
        Kf = (lambda x, axes=(-2,-1): torch.fft.rfft2(x.float(), dim=axes))(Kp[:, None, :], axes=(-2, -1))
        Uf = (lambda x, axes=(-2,-1): torch.fft.rfft2(x.float(), dim=axes))(up[:, :, None, :], axes=(-2, -1))
        Yf = Uf * Kf[None, :, :, :]
        y = (lambda x, s, axes=(-2,-1): torch.fft.irfft2(x, s=s, dim=axes).to(torch.bfloat16))(Yf, (1, L2), axes=(-2, -1))[:, :, 0, :L]
        y = (lambda x, *d: x.permute(*d))(y, 0, 2, 1) + u * Dskip[None, None, :]
        return y

    def _B_ref(x, w1, w2, w3, w4):
        B, S, D = x.shape
        h = _gelu(_layernorm(x, axis=-1) @ w1)
        c = D // 4
        g0 = _pad(h[:, :, 0*c:1*c], ((0, 0), (1, 0), (0, 0)))[:, :S, :]
        g1 = _pad(h[:, :, 1*c:2*c], ((0, 0), (0, 1), (0, 0)))[:, 1:, :]
        g2 = _pad(h[:, :, 2*c:3*c], ((0, 0), (2, 0), (0, 0)))[:, :S, :]
        g3 = _pad(h[:, :, 3*c:   ], ((0, 0), (0, 2), (0, 0)))[:, 2:, :]
        hs = torch.concatenate([g0, g1, g2, g3], axis=-1) @ w2
        x1 = x + hs
        h2 = _gelu(_layernorm(x1, axis=-1) @ w3) @ w4
        return x1 + h2

    x = A_u
    h = x + _A_ref(_layernorm(x, axis=-1), A_A_re, A_A_im, A_B_re, A_B_im, A_C_re, A_C_im, A_log_dt, A_Dskip)
    h2 = h + _B_ref(_layernorm(h, axis=-1), B_w1, B_w2, B_w3, B_w4)
    return h2
```

```asm
; @launch grid=(256,1,1) block=(256,1,1) lds=163840
.amdgcn_target "amdgcn-amd-amdhsa--gfx950"
.text
.globl sequential_preLN__ssm_conv_s4__mixer_s_mlp__prompt_kernel
.p2align 8
.type sequential_preLN__ssm_conv_s4__mixer_s_mlp__prompt_kernel,@function
sequential_preLN__ssm_conv_s4__mixer_s_mlp__prompt_kernel:
    s_cmp_ge_u32 s2, 256
    s_cbranch_scc1 D_EXIT
    s_load_dwordx16 s[16:31], s[0:1], 0
    s_getpc_b64 s[64:65]
D_PC:
    v_lshrrev_b32 v2, 2, v0
    v_lshlrev_b32 v2, 7, v2
    global_load_dword v251, v2, s[64:65]
    s_load_dwordx2 s[40:41], s[0:1], 128
    s_load_dwordx8 s[32:39], s[0:1], 80
    s_load_dwordx2 s[46:47], s[0:1], 64
    s_load_dwordx4 s[48:51], s[0:1], 112
    v_and_b32 v1, 63, v0
    v_lshrrev_b32 v2, 6, v0
    s_mov_b32 s42, 0xffff0000
    v_readfirstlane_b32 s3, v2
    s_and_b32 s4, s2, 7
    s_lshr_b32 s5, s2, 6
    s_lshr_b32 s6, s2, 3
    s_lshl_b32 s52, s4, 5
    s_add_u32 s52, s52, s6
    s_and_b32 s6, s6, 7
    s_lshl_b32 s7, s4, 2
    s_add_u32 s7, s7, s5
    s_and_b32 s53, s52, 1
    s_lshr_b32 s52, s52, 1
    s_mul_i32 s52, s52, 5
    s_lshl_b32 s54, s53, 1
    s_add_u32 s52, s52, s54
    s_and_b32 s54, s2, 63
    s_lshl_b32 s54, s54, 5
    s_lshl_b32 s55, s5, 3
    s_add_u32 s54, s54, s55
    v_lshrrev_b32 v7, 5, v0
    v_and_b32 v8, 31, v0
    v_add_u32 v9, s54, v7
    v_mul_u32_u24 v9, 1280, v9
    v_lshl_add_u32 v9, v8, 3, v9
    s_add_u32 s54, s52, s3
    s_mul_i32 s55, s54, 384
    v_lshl_add_u32 v10, v1, 1, s55
    s_lshl_b32 s55, s54, 1
    v_mov_b32 v11, s55
    s_waitcnt lgkmcnt(0)
    s_mov_b32 s8, s40
    s_mov_b32 s9, s41
    s_mov_b32 s10, 0x1a63000
    s_mov_b32 s11, 0x00020000
    s_cmp_lg_u32 s3, 3
    s_cbranch_scc1 D_NOINIT
    s_cmp_ge_u32 s2, 13
    s_cbranch_scc1 D_NOINIT
    v_lshrrev_b32 v2, 3, v1
    v_lshlrev_b32 v2, 8, v2
    v_and_b32 v3, 7, v1
    v_lshl_add_u32 v2, v3, 4, v2
    v_mov_b32 v44, 0
    v_mov_b32 v45, 0
    v_mov_b32 v46, 0
    v_mov_b32 v47, 0
    s_lshl_b32 s59, s2, 12
    s_add_u32 s59, s59, 6144
    buffer_store_dwordx4 v[44:47], v2, s[8:11], s59 offen sc1
    buffer_store_dwordx4 v[44:47], v2, s[8:11], s59 offen offset:2048 sc1
    s_cmp_lg_u32 s2, 0
    s_cbranch_scc1 D_NOINIT
    s_movk_i32 s59, 4096
    buffer_store_dwordx4 v[44:47], v2, s[8:11], 0 offen sc1
    buffer_store_dwordx4 v[44:47], v2, s[8:11], 0 offen offset:2048 sc1
    buffer_store_dwordx4 v[44:47], v2, s[8:11], s59 offen sc1
D_NOINIT:
    global_load_dwordx2 v[12:13], v9, s[16:17] offset:0
    global_load_dwordx2 v[14:15], v9, s[16:17] offset:256
    global_load_dwordx2 v[16:17], v9, s[16:17] offset:512
    global_load_dwordx2 v[18:19], v9, s[16:17] offset:768
    global_load_dwordx2 v[20:21], v9, s[16:17] offset:1024
    s_barrier
    s_cmp_eq_u32 s3, 3
    s_cbranch_scc1 D_W3_ISSUE
    global_load_ushort v118, v11, s[30:31]
    global_load_ushort v100, v10, s[18:19] offset:0
    global_load_ushort v101, v10, s[20:21] offset:0
    global_load_ushort v102, v10, s[22:23] offset:0
    global_load_ushort v103, v10, s[24:25] offset:0
    global_load_ushort v104, v10, s[26:27] offset:0
    global_load_ushort v105, v10, s[28:29] offset:0
    global_load_ushort v106, v10, s[18:19] offset:128
    global_load_ushort v107, v10, s[20:21] offset:128
    global_load_ushort v108, v10, s[22:23] offset:128
    global_load_ushort v109, v10, s[24:25] offset:128
    global_load_ushort v110, v10, s[26:27] offset:128
    global_load_ushort v111, v10, s[28:29] offset:128
    global_load_ushort v112, v10, s[18:19] offset:256
    global_load_ushort v113, v10, s[20:21] offset:256
    global_load_ushort v114, v10, s[22:23] offset:256
    global_load_ushort v115, v10, s[24:25] offset:256
    global_load_ushort v116, v10, s[26:27] offset:256
    global_load_ushort v117, v10, s[28:29] offset:256
    s_branch D_ISSUED
D_W3_ISSUE:
    s_mul_i32 s59, s52, 384
    v_lshl_add_u32 v10, v1, 1, s59
    s_lshl_b32 s59, s52, 1
    v_mov_b32 v11, s59
    global_load_ushort v100, v10, s[18:19] offset:256
    global_load_ushort v101, v10, s[20:21] offset:256
    global_load_ushort v102, v11, s[30:31] offset:0
    global_load_ushort v103, v10, s[18:19] offset:640
    global_load_ushort v104, v10, s[20:21] offset:640
    global_load_ushort v105, v11, s[30:31] offset:2
    global_load_ushort v106, v10, s[18:19] offset:1024
    global_load_ushort v107, v10, s[20:21] offset:1024
    global_load_ushort v108, v11, s[30:31] offset:4
    s_cmp_lg_u32 s2, 0
    s_cbranch_scc1 D_W3_PF
    s_waitcnt vmcnt(14)
    v_mov_b32 v2, 1
    v_mov_b32 v3, 0
    global_store_dword v3, v2, s[50:51] sc1
    s_branch D_ISSUED
D_W3_PF:
    s_lshr_b32 s59, s2, 3
    s_add_u32 s59, s59, s2
    s_and_b32 s59, s59, 3
    s_add_u32 s59, s59, 1
    s_lshl_b32 s59, s59, 13
    v_lshl_add_u32 v2, v1, 7, s59
    v_min_u32 v2, D_CODE_END-D_PC-4, v2
    global_load_dword v250, v2, s[64:65]
D_ISSUED:
    v_and_b32 v4, 15, v1
    v_lshrrev_b32 v5, 4, v1
    v_lshlrev_b32 v6, 4, v1
    v_mul_u32_u24 v9, 1344, v7
    v_lshl_add_u32 v9, v8, 3, v9
    v_mul_u32_u24 v2, 1366, v0
    v_lshrrev_b32 v2, 16, v2
    v_mul_u32_u24 v3, 48, v2
    v_sub_u32 v3, v0, v3
    v_mul_u32_u24 v2, 3840, v2
    v_lshl_add_u32 v2, v3, 4, v2
    v_mov_b32 v44, 0
    v_mov_b32 v45, 0
    v_mov_b32 v46, 0
    v_mov_b32 v47, 0
    v_cmp_gt_u32 vcc, 192, v0
    s_and_saveexec_b64 s[44:45], vcc
    ds_write_b128 v2, v[44:47] offset:49920
    s_mov_b64 exec, s[44:45]
    s_min_u32 s55, s3, 2
    s_mul_i32 s55, s55, 1664
    s_add_u32 s55, s55, 65280
    v_and_b32 v2, 3, v1
    v_lshl_add_u32 v2, v2, 4, s55
    ds_write_b128 v2, v[44:47]
    v_mov_b32 v90, 128000
    ds_write_b128 v90, v[44:47]
    ds_write_b128 v90, v[44:47] offset:16
    v_lshlrev_b32 v2, 3, v0
    v_sub_u32 v2, 2047, v2
    v_cvt_f32_i32 v42, v2
    v_cmp_gt_i32 vcc, 256, v2
    v_lshlrev_b32 v2, 1, v2
    v_add_u32 v2, 65344, v2
    s_mov_b32 s55, 31296
    v_add_f32 v43, 0x80000000, v42
    v_add_f32 v44, 0xbf800000, v42
    v_cvt_pk_bf16_f32 v45, v43, v44
    v_and_b32 v43, 0xffff, v45
    v_lshl_add_u32 v43, v43, 1, s55
    v_mov_b32 v44, v2
    v_cndmask_b32 v120, v43, v44, vcc
    v_lshrrev_b32 v43, 16, v45
    v_lshl_add_u32 v43, v43, 1, s55
    v_add_u32 v44, -2, v2
    v_cndmask_b32 v121, v43, v44, vcc
    v_add_f32 v43, 0xc0000000, v42
    v_add_f32 v44, 0xc0400000, v42
    v_cvt_pk_bf16_f32 v45, v43, v44
    v_and_b32 v43, 0xffff, v45
    v_lshl_add_u32 v43, v43, 1, s55
    v_add_u32 v44, -4, v2
    v_cndmask_b32 v122, v43, v44, vcc
    v_lshrrev_b32 v43, 16, v45
    v_lshl_add_u32 v43, v43, 1, s55
    v_add_u32 v44, -6, v2
    v_cndmask_b32 v123, v43, v44, vcc
    v_add_f32 v43, 0xc0800000, v42
    v_add_f32 v44, 0xc0a00000, v42
    v_cvt_pk_bf16_f32 v45, v43, v44
    v_and_b32 v43, 0xffff, v45
    v_lshl_add_u32 v43, v43, 1, s55
    v_add_u32 v44, -8, v2
    v_cndmask_b32 v124, v43, v44, vcc
    v_lshrrev_b32 v43, 16, v45
    v_lshl_add_u32 v43, v43, 1, s55
    v_add_u32 v44, -10, v2
    v_cndmask_b32 v125, v43, v44, vcc
    v_add_f32 v43, 0xc0c00000, v42
    v_add_f32 v44, 0xc0e00000, v42
    v_cvt_pk_bf16_f32 v45, v43, v44
    v_and_b32 v43, 0xffff, v45
    v_lshl_add_u32 v43, v43, 1, s55
    v_add_u32 v44, -12, v2
    v_cndmask_b32 v126, v43, v44, vcc
    v_lshrrev_b32 v43, 16, v45
    v_lshl_add_u32 v43, v43, 1, s55
    v_add_u32 v44, -14, v2
    v_cndmask_b32 v127, v43, v44, vcc
    v_add_f32 v43, 0xc1000000, v42
    v_add_f32 v44, 0xc1100000, v42
    v_cvt_pk_bf16_f32 v45, v43, v44
    v_and_b32 v43, 0xffff, v45
    v_lshl_add_u32 v43, v43, 1, s55
    v_add_u32 v44, -16, v2
    v_cndmask_b32 v128, v43, v44, vcc
    v_lshrrev_b32 v43, 16, v45
    v_lshl_add_u32 v43, v43, 1, s55
    v_add_u32 v44, -18, v2
    v_cndmask_b32 v129, v43, v44, vcc
    v_add_f32 v43, 0xc1200000, v42
    v_add_f32 v44, 0xc1300000, v42
    v_cvt_pk_bf16_f32 v45, v43, v44
    v_and_b32 v43, 0xffff, v45
    v_lshl_add_u32 v43, v43, 1, s55
    v_add_u32 v44, -20, v2
    v_cndmask_b32 v130, v43, v44, vcc
    s_lshr_b32 s54, s3, 1
    s_add_u32 s54, s54, s53
    s_and_b32 s55, s3, 1
    s_lshl_b32 s56, s53, 1
    s_sub_u32 s56, 2, s56
    s_add_u32 s57, s52, s54
    s_add_u32 s58, s52, s56
    v_sub_u32 v2, 3, v4
    v_and_b32 v2, 3, v2
    v_mul_u32_u24 v2, 4160, v2
    v_lshl_add_u32 v2, v5, 4, v2
    v_lshrrev_b32 v3, 2, v4
    v_lshlrev_b32 v3, 3, v3
    v_sub_u32 v2, v2, v3
    v_add_u32 v2, 56, v2
    v_mul_u32_u24 v3, 3840, v5
    v_mul_u32_u24 v42, 48, v4
    v_add_u32 v3, v3, v42
    v_add_u32 v3, 49968, v3
    s_mul_i32 s59, s54, 16640
    s_lshl_b32 s60, s55, 5
    s_sub_u32 s59, s59, s60
    v_add_u32 v92, s59, v2
    s_lshl_b32 s59, s54, 4
    v_add_u32 v93, s59, v3
    s_mul_i32 s59, s56, 16640
    s_lshl_b32 s60, s53, 5
    s_sub_u32 s59, s59, s60
    s_lshl_b32 s60, s3, 8
    s_sub_u32 s59, s59, s60
    s_add_u32 s59, s59, 768
    v_add_u32 v94, s59, v2
    s_lshl_b32 s59, s56, 4
    s_mul_i32 s60, s3, 192
    s_sub_u32 s59, s59, s60
    s_add_u32 s59, s59, 576
    v_add_u32 v95, s59, v3
    v_add_u32 v2, 0, v1
    v_mul_u32_u24 v3, 21846, v2
    v_lshrrev_b32 v3, 16, v3
    v_mul_u32_u24 v42, 3, v3
    v_sub_u32 v2, v2, v42
    v_add_u32 v2, s52, v2
    v_mul_u32_u24 v96, 20480, v3
    v_lshrrev_b32 v3, 2, v2
    v_lshl_add_u32 v96, v3, 7, v96
    v_and_b32 v2, 3, v2
    v_lshl_add_u32 v96, v2, 4, v96
    v_add_u32 v2, 64, v1
    v_mul_u32_u24 v3, 21846, v2
    v_lshrrev_b32 v3, 16, v3
    v_mul_u32_u24 v42, 3, v3
    v_sub_u32 v2, v2, v42
    v_add_u32 v2, s52, v2
    v_mul_u32_u24 v97, 20480, v3
    v_lshrrev_b32 v3, 2, v2
    v_lshl_add_u32 v97, v3, 7, v97
    v_and_b32 v2, 3, v2
    v_lshl_add_u32 v97, v2, 4, v97
    v_add_u32 v2, 128, v1
    v_mul_u32_u24 v3, 21846, v2
    v_lshrrev_b32 v3, 16, v3
    v_mul_u32_u24 v42, 3, v3
    v_sub_u32 v2, v2, v42
    v_add_u32 v2, s52, v2
    v_mul_u32_u24 v98, 20480, v3
    v_lshrrev_b32 v3, 2, v2
    v_lshl_add_u32 v98, v3, 7, v98
    v_and_b32 v2, 3, v2
    v_lshl_add_u32 v98, v2, 4, v98
    v_lshlrev_b32 v91, 10, v5
    v_bfe_u32 v2, v1, 2, 2
    v_lshl_add_u32 v91, v2, 7, v91
    v_and_b32 v2, 3, v1
    v_lshl_add_u32 v91, v2, 3, v91
    s_lshl_b32 s61, s3, 13
    s_add_u32 s61, s61, 129024
    v_add_u32 v91, s61, v91
    v_and_b32 v99, 7, v1
    v_lshlrev_b32 v99, 8, v99
    s_lshl_b32 s59, s57, 1
    v_mov_b32 v87, s59
    s_lshl_b32 s59, s58, 1
    v_mov_b32 v88, s59
    s_lshl_b32 s59, s3, 12
    s_add_u32 s59, s59, 77568
    v_add_u32 v83, s59, v6
    s_lshl_b32 s59, s3, 10
    s_add_u32 s59, s59, 77568
    v_add_u32 v82, s59, v6
    v_lshrrev_b32 v2, 1, v5
    v_and_b32 v3, 1, v5
    v_mul_u32_u24 v84, 48, v4
    v_lshl_add_u32 v84, v3, 3, v84
    v_mul_u32_u24 v85, 3840, v2
    v_add_u32 v85, v85, v84
    v_mul_u32_u24 v86, 3072, v2
    v_add_u32 v86, v86, v84
    s_mul_i32 s59, s55, 7680
    s_lshl_b32 s60, s54, 4
    s_add_u32 s59, s59, s60
    v_add_u32 v76, s59, v85
    s_mul_i32 s59, s55, 6144
    s_add_u32 s59, s59, s60
    s_add_u32 s59, s59, 65280
    v_add_u32 v77, s59, v86
    s_mul_i32 s59, s53, 7680
    s_lshl_b32 s60, s56, 4
    s_mul_i32 s61, s3, 768
    s_add_u32 s60, s60, s61
    s_add_u32 s59, s59, s60
    v_add_u32 v78, s59, v85
    s_mul_i32 s59, s53, 6144
    s_add_u32 s59, s59, s60
    s_add_u32 s59, s59, 65280
    v_add_u32 v79, s59, v86
    v_lshlrev_b32 v80, 10, v2
    v_lshl_add_u32 v80, v4, 4, v80
    v_lshl_add_u32 v81, v3, 3, v80
    v_lshl_add_u32 v80, v3, 8, v80
    s_lshl_b32 s57, s57, 12
    s_lshl_b32 s60, s55, 11
    s_add_u32 s57, s57, s60
    s_add_u32 s57, s57, 0x50f000
    s_lshl_b32 s58, s58, 12
    s_lshl_b32 s60, s53, 11
    s_add_u32 s58, s58, s60
    s_lshl_b32 s60, s3, 8
    s_add_u32 s58, s58, s60
    s_add_u32 s58, s58, 0x50f000
    v_accvgpr_write_b32 a248, v76
    v_accvgpr_write_b32 a249, v77
    v_accvgpr_write_b32 a250, v78
    v_accvgpr_write_b32 a251, v79
    v_accvgpr_write_b32 a252, v80
    v_accvgpr_write_b32 a253, v81
    v_accvgpr_write_b32 a254, v82
    v_accvgpr_write_b32 a255, v83
    s_lshl_b32 s64, s3, 8
    s_add_u32 s64, s64, s2
    s_cmp_lt_u32 s64, 400
    s_cselect_b32 s43, 1, 0
    s_cbranch_scc0 D_B1DONE
    s_lshl_b32 s61, s3, 13
    s_add_u32 s61, s61, 129024
    s_mov_b32 s68, s32
    s_mov_b32 s69, s33
    s_mov_b32 s70, 819200
    s_mov_b32 s71, 0x00020000
    s_movk_i32 s65, 1280
    s_movk_i32 s97, 10
    s_mov_b32 s98, 0x1999999a
    s_movk_i32 s96, 20480
    s_mov_b32 s67, 0x78f000
    s_mov_b32 s99, 0
    s_cmp_ge_u32 s64, 200
    s_cselect_b32 s68, s34, s68
    s_cselect_b32 s69, s35, s69
    s_cselect_b32 s67, 0x857000, s67
    s_cselect_b32 s99, 200, s99
    s_cmp_ge_u32 s64, 400
    s_cselect_b32 s68, s36, s68
    s_cselect_b32 s69, s37, s69
    s_cselect_b32 s67, 0x91f000, s67
    s_cselect_b32 s99, 400, s99
    s_cselect_b32 s70, 1966080, s70
    s_cselect_b32 s65, 3072, s65
    s_cselect_b32 s97, 24, s97
    s_cselect_b32 s98, 0xaaaaaab, s98
    s_cmp_ge_u32 s64, 880
    s_cselect_b32 s68, s38, s68
    s_cselect_b32 s69, s39, s69
    s_cselect_b32 s67, 0xaff000, s67
    s_cselect_b32 s99, 880, s99
    s_cselect_b32 s65, 1280, s65
    s_cselect_b32 s97, 10, s97
    s_cselect_b32 s98, 0x1999999a, s98
    s_cselect_b32 s96, 49152, s96
    s_sub_u32 s99, s64, s99
    s_mul_hi_u32 s100, s99, s98
    s_mul_i32 s101, s100, s97
    s_sub_u32 s101, s99, s101
    s_mul_i32 s66, s100, s65
    s_lshl_b32 s66, s66, 5
    s_lshl_b32 s99, s101, 7
    s_add_u32 s66, s66, s99
    s_mul_i32 s99, s101, s96
    s_lshl_b32 s99, s99, 2
    s_add_u32 s67, s67, s99
    s_lshl_b32 s99, s100, 10
    s_add_u32 s67, s67, s99
    v_lshrrev_b32 v2, 3, v1
    v_mul_lo_u32 v2, v2, s65
    v_and_b32 v3, 7, v1
    v_lshl_add_u32 v2, v3, 4, v2
    s_lshl_b32 s99, s65, 3
    s_add_u32 m0, s61, 0
    s_nop 0
    buffer_load_dwordx4 v2, s[68:71], s66 offen lds
    s_add_u32 m0, s61, 1024
    s_add_u32 s66, s66, s99
    buffer_load_dwordx4 v2, s[68:71], s66 offen lds
    s_add_u32 m0, s61, 2048
    s_add_u32 s66, s66, s99
    buffer_load_dwordx4 v2, s[68:71], s66 offen lds
    s_add_u32 m0, s61, 3072
    s_add_u32 s66, s66, s99
    buffer_load_dwordx4 v2, s[68:71], s66 offen lds
    s_mov_b32 s31, s67
    s_mov_b32 s30, s96
D_B1DONE:
    s_lshl_b32 s64, s2, 2
    s_add_u32 s64, s64, s3
    s_add_u32 s64, s64, 400
    s_mov_b32 s68, s32
    s_mov_b32 s69, s33
    s_mov_b32 s70, 819200
    s_mov_b32 s71, 0x00020000
    s_movk_i32 s65, 1280
    s_movk_i32 s97, 10
    s_mov_b32 s98, 0x1999999a
    s_movk_i32 s96, 20480
    s_mov_b32 s67, 0x78f000
    s_mov_b32 s99, 0
    s_cmp_ge_u32 s64, 200
    s_cselect_b32 s68, s34, s68
    s_cselect_b32 s69, s35, s69
    s_cselect_b32 s67, 0x857000, s67
    s_cselect_b32 s99, 200, s99
    s_cmp_ge_u32 s64, 400
    s_cselect_b32 s68, s36, s68
    s_cselect_b32 s69, s37, s69
    s_cselect_b32 s67, 0x91f000, s67
    s_cselect_b32 s99, 400, s99
    s_cselect_b32 s70, 1966080, s70
    s_cselect_b32 s65, 3072, s65
    s_cselect_b32 s97, 24, s97
    s_cselect_b32 s98, 0xaaaaaab, s98
    s_cmp_ge_u32 s64, 880
    s_cselect_b32 s68, s38, s68
    s_cselect_b32 s69, s39, s69
    s_cselect_b32 s67, 0xaff000, s67
    s_cselect_b32 s99, 880, s99
    s_cselect_b32 s65, 1280, s65
    s_cselect_b32 s97, 10, s97
    s_cselect_b32 s98, 0x1999999a, s98
    s_cselect_b32 s96, 49152, s96
    s_sub_u32 s99, s64, s99
    s_mul_hi_u32 s100, s99, s98
    s_mul_i32 s101, s100, s97
    s_sub_u32 s101, s99, s101
    s_mul_i32 s66, s100, s65
    s_lshl_b32 s66, s66, 5
    s_lshl_b32 s99, s101, 7
    s_add_u32 s66, s66, s99
    s_mul_i32 s99, s101, s96
    s_lshl_b32 s99, s99, 2
    s_add_u32 s67, s67, s99
    s_lshl_b32 s99, s100, 10
    s_add_u32 s67, s67, s99
    s_cmp_ge_u32 s64, 1360
    s_cselect_b32 s70, 0, s70
    s_cselect_b32 s67, 0x7ff00000, s67
    v_lshrrev_b32 v89, 3, v1
    v_mul_lo_u32 v89, v89, s65
    v_and_b32 v3, 7, v1
    v_lshl_add_u32 v89, v3, 4, v89
    s_lshl_b32 s99, s65, 3
    s_lshl_b32 s98, s3, 13
    s_add_u32 s98, s98, 133120
    s_cmp_eq_u32 s3, 3
    s_cbranch_scc0 D_XW
    s_waitcnt vmcnt(10)
    s_branch D_XW27
D_XW:
    s_cmp_eq_u32 s43, 1
    s_cbranch_scc1 D_XW27
    s_waitcnt vmcnt(19)
D_XW27:
    s_waitcnt vmcnt(23)
    v_lshlrev_b32 v22, 16, v12
    v_and_b32 v23, s42, v12
    v_lshlrev_b32 v24, 16, v13
    v_and_b32 v25, s42, v13
    v_lshlrev_b32 v26, 16, v14
    v_and_b32 v27, s42, v14
    v_lshlrev_b32 v28, 16, v15
    v_and_b32 v29, s42, v15
    v_lshlrev_b32 v30, 16, v16
    v_and_b32 v31, s42, v16
    v_lshlrev_b32 v32, 16, v17
    v_and_b32 v33, s42, v17
    v_lshlrev_b32 v34, 16, v18
    v_and_b32 v35, s42, v18
    v_lshlrev_b32 v36, 16, v19
    v_and_b32 v37, s42, v19
    v_lshlrev_b32 v38, 16, v20
    v_and_b32 v39, s42, v20
    v_lshlrev_b32 v40, 16, v21
    v_and_b32 v41, s42, v21
    v_pk_add_f32 v[42:43], v[22:23], v[24:25]
    v_pk_add_f32 v[42:43], v[42:43], v[26:27]
    v_pk_add_f32 v[42:43], v[42:43], v[28:29]
    v_pk_add_f32 v[42:43], v[42:43], v[30:31]
    v_pk_add_f32 v[42:43], v[42:43], v[32:33]
    v_pk_add_f32 v[42:43], v[42:43], v[34:35]
    v_pk_add_f32 v[42:43], v[42:43], v[36:37]
    v_pk_add_f32 v[42:43], v[42:43], v[38:39]
    v_pk_add_f32 v[42:43], v[42:43], v[40:41]
    v_add_f32 v42, v42, v43
    s_nop 1
    v_add_f32_dpp v42, v42, v42 quad_perm:[1,0,3,2] row_mask:0xf bank_mask:0xf
    s_nop 1
    v_add_f32_dpp v42, v42, v42 quad_perm:[2,3,0,1] row_mask:0xf bank_mask:0xf
    s_nop 1
    v_add_f32_dpp v42, v42, v42 row_half_mirror row_mask:0xf bank_mask:0xf
    s_nop 1
    v_add_f32_dpp v42, v42, v42 row_mirror row_mask:0xf bank_mask:0xf
    s_nop 1
    v_mov_b32 v44, v42
    s_nop 1
    v_permlane16_swap_b32 v42, v44
    s_nop 0
    v_add_f32 v42, v42, v44
    s_mov_b32 s59, 0x3acccccd
    v_mul_f32 v42, s59, v42
    v_pk_add_f32 v[44:45], v[22:23], v[42:43] op_sel_hi:[1,0] neg_lo:[0,1] neg_hi:[0,1]
    v_pk_mul_f32 v[46:47], v[44:45], v[44:45]
    v_pk_add_f32 v[44:45], v[24:25], v[42:43] op_sel_hi:[1,0] neg_lo:[0,1] neg_hi:[0,1]
    v_pk_fma_f32 v[46:47], v[44:45], v[44:45], v[46:47]
    v_pk_add_f32 v[44:45], v[26:27], v[42:43] op_sel_hi:[1,0] neg_lo:[0,1] neg_hi:[0,1]
    v_pk_fma_f32 v[46:47], v[44:45], v[44:45], v[46:47]
    v_pk_add_f32 v[44:45], v[28:29], v[42:43] op_sel_hi:[1,0] neg_lo:[0,1] neg_hi:[0,1]
    v_pk_fma_f32 v[46:47], v[44:45], v[44:45], v[46:47]
    v_pk_add_f32 v[44:45], v[30:31], v[42:43] op_sel_hi:[1,0] neg_lo:[0,1] neg_hi:[0,1]
    v_pk_fma_f32 v[46:47], v[44:45], v[44:45], v[46:47]
    v_pk_add_f32 v[44:45], v[32:33], v[42:43] op_sel_hi:[1,0] neg_lo:[0,1] neg_hi:[0,1]
    v_pk_fma_f32 v[46:47], v[44:45], v[44:45], v[46:47]
    v_pk_add_f32 v[44:45], v[34:35], v[42:43] op_sel_hi:[1,0] neg_lo:[0,1] neg_hi:[0,1]
    v_pk_fma_f32 v[46:47], v[44:45], v[44:45], v[46:47]
    v_pk_add_f32 v[44:45], v[36:37], v[42:43] op_sel_hi:[1,0] neg_lo:[0,1] neg_hi:[0,1]
    v_pk_fma_f32 v[46:47], v[44:45], v[44:45], v[46:47]
    v_pk_add_f32 v[44:45], v[38:39], v[42:43] op_sel_hi:[1,0] neg_lo:[0,1] neg_hi:[0,1]
    v_pk_fma_f32 v[46:47], v[44:45], v[44:45], v[46:47]
    v_pk_add_f32 v[44:45], v[40:41], v[42:43] op_sel_hi:[1,0] neg_lo:[0,1] neg_hi:[0,1]
    v_pk_fma_f32 v[46:47], v[44:45], v[44:45], v[46:47]
    v_add_f32 v46, v46, v47
    s_nop 1
    v_add_f32_dpp v46, v46, v46 quad_perm:[1,0,3,2] row_mask:0xf bank_mask:0xf
    s_nop 1
    v_add_f32_dpp v46, v46, v46 quad_perm:[2,3,0,1] row_mask:0xf bank_mask:0xf
    s_nop 1
    v_add_f32_dpp v46, v46, v46 row_half_mirror row_mask:0xf bank_mask:0xf
    s_nop 1
    v_add_f32_dpp v46, v46, v46 row_mirror row_mask:0xf bank_mask:0xf
    s_nop 1
    v_mov_b32 v44, v46
    s_nop 1
    v_permlane16_swap_b32 v46, v44
    s_nop 0
    v_add_f32 v46, v46, v44
    v_mul_f32 v46, s59, v46
    v_cvt_pk_bf16_f32 v44, v42, v46
    v_lshlrev_b32 v42, 16, v44
    v_and_b32 v46, s42, v44
    v_add_f32 v46, 0x3727c5ac, v46
    v_cvt_pk_bf16_f32 v46, v46, v46
    v_and_b32 v46, s42, v46
    v_sqrt_f32 v46, v46
    v_pk_add_f32 v[22:23], v[22:23], v[42:43] op_sel_hi:[1,0] neg_lo:[0,1] neg_hi:[0,1]
    v_pk_add_f32 v[24:25], v[24:25], v[42:43] op_sel_hi:[1,0] neg_lo:[0,1] neg_hi:[0,1]
    v_pk_add_f32 v[26:27], v[26:27], v[42:43] op_sel_hi:[1,0] neg_lo:[0,1] neg_hi:[0,1]
    v_pk_add_f32 v[28:29], v[28:29], v[42:43] op_sel_hi:[1,0] neg_lo:[0,1] neg_hi:[0,1]
    v_pk_add_f32 v[30:31], v[30:31], v[42:43] op_sel_hi:[1,0] neg_lo:[0,1] neg_hi:[0,1]
    v_pk_add_f32 v[32:33], v[32:33], v[42:43] op_sel_hi:[1,0] neg_lo:[0,1] neg_hi:[0,1]
    v_pk_add_f32 v[34:35], v[34:35], v[42:43] op_sel_hi:[1,0] neg_lo:[0,1] neg_hi:[0,1]
    v_pk_add_f32 v[36:37], v[36:37], v[42:43] op_sel_hi:[1,0] neg_lo:[0,1] neg_hi:[0,1]
    v_pk_add_f32 v[38:39], v[38:39], v[42:43] op_sel_hi:[1,0] neg_lo:[0,1] neg_hi:[0,1]
    v_pk_add_f32 v[40:41], v[40:41], v[42:43] op_sel_hi:[1,0] neg_lo:[0,1] neg_hi:[0,1]
    v_cvt_pk_bf16_f32 v46, v46, v46
    v_and_b32 v46, s42, v46
    v_rcp_f32 v48, v46
    v_cvt_pk_bf16_f32 v44, v22, v23
    v_lshlrev_b32 v22, 16, v44
    v_and_b32 v23, s42, v44
    v_pk_mul_f32 v[22:23], v[22:23], v[48:49] op_sel_hi:[1,0]
    v_cvt_pk_bf16_f32 v50, v22, v23
    v_cvt_pk_bf16_f32 v44, v24, v25
    v_lshlrev_b32 v24, 16, v44
    v_and_b32 v25, s42, v44
    v_pk_mul_f32 v[24:25], v[24:25], v[48:49] op_sel_hi:[1,0]
    v_cvt_pk_bf16_f32 v51, v24, v25
    ds_write_b64 v9, v[50:51] offset:0
    v_cvt_pk_bf16_f32 v44, v26, v27
    v_lshlrev_b32 v26, 16, v44
    v_and_b32 v27, s42, v44
    v_pk_mul_f32 v[26:27], v[26:27], v[48:49] op_sel_hi:[1,0]
    v_cvt_pk_bf16_f32 v52, v26, v27
    v_cvt_pk_bf16_f32 v44, v28, v29
    v_lshlrev_b32 v28, 16, v44
    v_and_b32 v29, s42, v44
    v_pk_mul_f32 v[28:29], v[28:29], v[48:49] op_sel_hi:[1,0]
    v_cvt_pk_bf16_f32 v53, v28, v29
    ds_write_b64 v9, v[52:53] offset:256
    v_cvt_pk_bf16_f32 v44, v30, v31
    v_lshlrev_b32 v30, 16, v44
    v_and_b32 v31, s42, v44
    v_pk_mul_f32 v[30:31], v[30:31], v[48:49] op_sel_hi:[1,0]
    v_cvt_pk_bf16_f32 v54, v30, v31
    v_cvt_pk_bf16_f32 v44, v32, v33
    v_lshlrev_b32 v32, 16, v44
    v_and_b32 v33, s42, v44
    v_pk_mul_f32 v[32:33], v[32:33], v[48:49] op_sel_hi:[1,0]
    v_cvt_pk_bf16_f32 v55, v32, v33
    ds_write_b64 v9, v[54:55] offset:512
    v_cvt_pk_bf16_f32 v44, v34, v35
    v_lshlrev_b32 v34, 16, v44
    v_and_b32 v35, s42, v44
    v_pk_mul_f32 v[34:35], v[34:35], v[48:49] op_sel_hi:[1,0]
    v_cvt_pk_bf16_f32 v56, v34, v35
    v_cvt_pk_bf16_f32 v44, v36, v37
    v_lshlrev_b32 v36, 16, v44
    v_and_b32 v37, s42, v44
    v_pk_mul_f32 v[36:37], v[36:37], v[48:49] op_sel_hi:[1,0]
    v_cvt_pk_bf16_f32 v57, v36, v37
    ds_write_b64 v9, v[56:57] offset:768
    v_cvt_pk_bf16_f32 v44, v38, v39
    v_lshlrev_b32 v38, 16, v44
    v_and_b32 v39, s42, v44
    v_pk_mul_f32 v[38:39], v[38:39], v[48:49] op_sel_hi:[1,0]
    v_cvt_pk_bf16_f32 v58, v38, v39
    v_cvt_pk_bf16_f32 v44, v40, v41
    v_lshlrev_b32 v40, 16, v44
    v_and_b32 v41, s42, v44
    v_pk_mul_f32 v[40:41], v[40:41], v[48:49] op_sel_hi:[1,0]
    v_cvt_pk_bf16_f32 v59, v40, v41
    ds_write_b64 v9, v[58:59] offset:1024
    ds_write_b64 v9, v[12:13] offset:10784
    ds_write_b64 v9, v[14:15] offset:11040
    ds_write_b64 v9, v[16:17] offset:11296
    ds_write_b64 v9, v[18:19] offset:11552
    ds_write_b64 v9, v[20:21] offset:11808
    s_waitcnt lgkmcnt(0)
    s_barrier
    global_load_ushort v87, v87, s[46:47]
    global_load_ushort v88, v88, s[46:47]
    s_cmp_eq_u32 s3, 3
    s_cbranch_scc0 D_KGEN
    s_mov_b32 s12, s50
    s_mov_b32 s13, s51
    s_mov_b32 s14, 0x100
    s_mov_b32 s15, 0x00020000
    v_mov_b32 v76, 0
    v_mov_b32 v77, 1
    buffer_load_dword v78, v76, s[12:15], 0 offen sc1
    v_bfe_u32 v2, v1, 2, 2
    v_mul_u32_u24 v9, 1344, v2
    v_lshl_add_u32 v9, v5, 4, v9
    v_bfe_u32 v2, v1, 1, 1
    v_lshl_add_u32 v9, v2, 3, v9
    v_and_b32 v2, 1, v1
    v_mul_u32_u24 v2, 10784, v2
    v_add_u32 v9, v9, v2
    s_mul_i32 s59, s2, 20480
    ds_read_b64_tr_b16 v[12:13], v9 offset:0
    ds_read_b64_tr_b16 v[14:15], v9 offset:5376
    ds_read_b64_tr_b16 v[16:17], v9 offset:64
    ds_read_b64_tr_b16 v[18:19], v9 offset:5440
    ds_read_b64_tr_b16 v[20:21], v9 offset:128
    ds_read_b64_tr_b16 v[22:23], v9 offset:5504
    ds_read_b64_tr_b16 v[24:25], v9 offset:192
    ds_read_b64_tr_b16 v[26:27], v9 offset:5568
    ds_read_b64_tr_b16 v[28:29], v9 offset:256
    ds_read_b64_tr_b16 v[30:31], v9 offset:5632
    s_waitcnt lgkmcnt(8)
    s_add_u32 s60, s59, 61440
    buffer_store_dwordx4 v[12:15], v6, s[8:11], s60 offen offset:0 sc1
    s_waitcnt lgkmcnt(6)
    buffer_store_dwordx4 v[16:19], v6, s[8:11], s60 offen offset:1024 sc1
    s_waitcnt lgkmcnt(4)
    buffer_store_dwordx4 v[20:23], v6, s[8:11], s60 offen offset:2048 sc1
    s_waitcnt lgkmcnt(2)
    buffer_store_dwordx4 v[24:27], v6, s[8:11], s60 offen offset:3072 sc1
    s_waitcnt lgkmcnt(0)
    s_add_u32 s60, s59, 65536
    buffer_store_dwordx4 v[28:31], v6, s[8:11], s60 offen offset:0 sc1
    ds_read_b64_tr_b16 v[32:33], v9 offset:320
    ds_read_b64_tr_b16 v[34:35], v9 offset:5696
    ds_read_b64_tr_b16 v[36:37], v9 offset:384
    ds_read_b64_tr_b16 v[38:39], v9 offset:5760
    ds_read_b64_tr_b16 v[40:41], v9 offset:448
    ds_read_b64_tr_b16 v[42:43], v9 offset:5824
    ds_read_b64_tr_b16 v[44:45], v9 offset:512
    ds_read_b64_tr_b16 v[46:47], v9 offset:5888
    ds_read_b64_tr_b16 v[48:49], v9 offset:576
    ds_read_b64_tr_b16 v[50:51], v9 offset:5952
    s_waitcnt lgkmcnt(8)
    buffer_store_dwordx4 v[32:35], v6, s[8:11], s60 offen offset:1024 sc1
    s_waitcnt lgkmcnt(6)
    buffer_store_dwordx4 v[36:39], v6, s[8:11], s60 offen offset:2048 sc1
    s_waitcnt lgkmcnt(4)
    buffer_store_dwordx4 v[40:43], v6, s[8:11], s60 offen offset:3072 sc1
    s_waitcnt lgkmcnt(2)
    s_add_u32 s60, s59, 69632
    buffer_store_dwordx4 v[44:47], v6, s[8:11], s60 offen offset:0 sc1
    s_waitcnt lgkmcnt(0)
    buffer_store_dwordx4 v[48:51], v6, s[8:11], s60 offen offset:1024 sc1
    ds_read_b64_tr_b16 v[12:13], v9 offset:640
    ds_read_b64_tr_b16 v[14:15], v9 offset:6016
    ds_read_b64_tr_b16 v[16:17], v9 offset:704
    ds_read_b64_tr_b16 v[18:19], v9 offset:6080
    ds_read_b64_tr_b16 v[20:21], v9 offset:768
    ds_read_b64_tr_b16 v[22:23], v9 offset:6144
    ds_read_b64_tr_b16 v[24:25], v9 offset:832
    ds_read_b64_tr_b16 v[26:27], v9 offset:6208
    ds_read_b64_tr_b16 v[28:29], v9 offset:896
    ds_read_b64_tr_b16 v[30:31], v9 offset:6272
    s_waitcnt lgkmcnt(8)
    s_add_u32 s60, s59, 71680
    buffer_store_dwordx4 v[12:15], v6, s[8:11], s60 offen offset:0 sc1
    s_waitcnt lgkmcnt(6)
    buffer_store_dwordx4 v[16:19], v6, s[8:11], s60 offen offset:1024 sc1
    s_waitcnt lgkmcnt(4)
    buffer_store_dwordx4 v[20:23], v6, s[8:11], s60 offen offset:2048 sc1
    s_waitcnt lgkmcnt(2)
    buffer_store_dwordx4 v[24:27], v6, s[8:11], s60 offen offset:3072 sc1
    s_waitcnt lgkmcnt(0)
    s_add_u32 s60, s59, 75776
    buffer_store_dwordx4 v[28:31], v6, s[8:11], s60 offen offset:0 sc1
    ds_read_b64_tr_b16 v[32:33], v9 offset:960
    ds_read_b64_tr_b16 v[34:35], v9 offset:6336
    ds_read_b64_tr_b16 v[36:37], v9 offset:1024
    ds_read_b64_tr_b16 v[38:39], v9 offset:6400
    ds_read_b64_tr_b16 v[40:41], v9 offset:1088
    ds_read_b64_tr_b16 v[42:43], v9 offset:6464
    ds_read_b64_tr_b16 v[44:45], v9 offset:1152
    ds_read_b64_tr_b16 v[46:47], v9 offset:6528
    ds_read_b64_tr_b16 v[48:49], v9 offset:1216
    ds_read_b64_tr_b16 v[50:51], v9 offset:6592
    s_waitcnt lgkmcnt(8)
    buffer_store_dwordx4 v[32:35], v6, s[8:11], s60 offen offset:1024 sc1
    s_waitcnt lgkmcnt(6)
    buffer_store_dwordx4 v[36:39], v6, s[8:11], s60 offen offset:2048 sc1
    s_waitcnt lgkmcnt(4)
    buffer_store_dwordx4 v[40:43], v6, s[8:11], s60 offen offset:3072 sc1
    s_waitcnt lgkmcnt(2)
    s_add_u32 s60, s59, 79872
    buffer_store_dwordx4 v[44:47], v6, s[8:11], s60 offen offset:0 sc1
    s_waitcnt lgkmcnt(0)
    buffer_store_dwordx4 v[48:51], v6, s[8:11], s60 offen offset:1024 sc1
    v_mul_u32_u24 v79, 144, v1
    v_add_u32 v79, 21760, v79
    s_mov_b32 s43, 0
    s_waitcnt vmcnt(23)
D_W3_BG:
    s_mov_b32 s60, 0x3fb8aa3b
    v_lshlrev_b32 v56, 16, v100
    v_lshlrev_b32 v57, 16, v101
    v_lshlrev_b32 v58, 16, v102
    v_mov_b32 v100, v103
    v_mov_b32 v101, v104
    v_mov_b32 v102, v105
    v_mov_b32 v103, v106
    v_mov_b32 v104, v107
    v_mov_b32 v105, v108
    v_mul_f32 v58, s60, v58
    v_exp_f32 v58, v58
    s_nop 0
    v_cvt_pk_bf16_f32 v58, v58, v58
    v_and_b32 v58, s42, v58
    v_mul_f32 v56, v58, v56
    v_mul_f32 v57, v58, v57
    v_mul_f32 v56, s60, v56
    v_mul_f32 v57, 0.15915494, v57
    v_mul_f32 v56, 0x41000000, v56
    v_mul_f32 v57, 0x41000000, v57
    v_exp_f32 v56, v56
    v_fract_f32 v57, v57
    v_cos_f32 v40, v57
    v_sin_f32 v41, v57
    s_nop 0
    v_mul_f32 v40, v40, v56
    v_mul_f32 v41, v41, v56
    s_branch D_BGEN
D_W3_RET:
    v_add_u32 v79, 9216, v79
    s_add_u32 s43, s43, 1
    v_mov_b32 v2, s43
    s_waitcnt lgkmcnt(0)
    ds_write_b32 v90, v2 offset:8
    s_cmp_eq_u32 s43, 2
    s_cbranch_scc1 D_W3_BG
    s_cmp_eq_u32 s43, 3
    s_cbranch_scc1 D_JOIN
    s_waitcnt vmcnt(0)
    v_cmp_ge_u32 vcc, v78, v77
    s_cmp_eq_u64 vcc, -1
    s_cbranch_scc1 POLLD_2
    s_mov_b32 s63, 20000
POLL_1:
    buffer_load_dword v78, v76, s[12:15], 0 offen sc1
    s_waitcnt vmcnt(0)
    v_cmp_ge_u32 vcc, v78, v77
    s_cmp_eq_u64 vcc, -1
    s_cbranch_scc1 POLLD_2
    s_sleep 2
    s_sub_u32 s63, s63, 1
    s_cmp_lg_u32 s63, 0
    s_cbranch_scc1 POLL_1
POLLD_2:
    s_and_b32 s60, s2, 7
    s_lshl_b32 s60, s60, 8
    v_mov_b32 v2, 0
    v_mov_b32 v11, 1
    s_mov_b64 exec, 1
    buffer_atomic_add v11, v2, s[8:11], s60 offen sc0 sc1
    s_mov_b64 exec, -1
    s_getreg_b32 s61, hwreg(HW_REG_XCC_ID)
    s_mov_b32 s63, 0
D_TK:
    s_and_b32 s61, s61, 7
    s_lshl_b32 s60, s61, 8
    s_add_u32 s60, s60, 8192
    v_mov_b32 v78, 1
    s_mov_b64 exec, 1
    buffer_atomic_add v78, v76, s[8:11], s60 offen sc0 sc1
    s_mov_b64 exec, -1
    s_waitcnt vmcnt(0)
    v_readfirstlane_b32 s62, v78
    s_nop 3
    s_cmp_lt_u32 s62, 32
    s_cbranch_scc1 D_TKD
    s_add_u32 s61, s61, 1
    s_add_u32 s63, s63, 1
    s_cmp_lt_u32 s63, 8
    s_cbranch_scc1 D_TK
D_TKD:
    s_lshl_b32 s61, s61, 5
    s_and_b32 s62, s62, 31
    s_or_b32 s61, s61, s62
    s_and_b32 s61, s61, 255
    v_mov_b32 v78, s61
    ds_write_b32 v90, v78 offset:4
    v_readfirstlane_b32 s60, v11
    s_nop 3
    s_cmp_lg_u32 s60, 31
    s_cbranch_scc1 NOTLAST_3
    v_mov_b32 v3, 1
    s_mov_b32 s60, 2048
    v_and_b32 v2, 7, v1
    v_lshlrev_b32 v2, 8, v2
    s_mov_b64 exec, 0xff
    buffer_atomic_add v3, v2, s[8:11], s60 offen sc1
    s_mov_b64 exec, -1
NOTLAST_3:
    s_branch D_W3_BG
D_JOIN:
    s_getreg_b32 s60, hwreg(HW_REG_XCC_ID)
    s_and_b32 s60, s60, 7
    s_lshl_b32 s60, s60, 8
    s_add_u32 s60, s60, 2048
    v_mov_b32 v7, s60
    v_mov_b32 v8, 8
    s_mov_b32 s63, 20000
POLL_4:
    buffer_load_dword v11, v7, s[8:11], 0 offen sc1
    s_waitcnt vmcnt(0)
    v_cmp_ge_u32 vcc, v11, v8
    s_cmp_eq_u64 vcc, -1
    s_cbranch_scc1 POLLD_5
    s_sleep 2
    s_sub_u32 s63, s63, 1
    s_cmp_lg_u32 s63, 0
    s_cbranch_scc1 POLL_4
POLLD_5:
    s_mov_b32 s60, 0xf000
    s_mov_b32 m0, 50688
    s_nop 0
    buffer_load_dwordx4 v96, s[8:11], s60 offen sc1 lds
    s_mov_b32 m0, 51712
    s_nop 0
    buffer_load_dwordx4 v97, s[8:11], s60 offen sc1 lds
    s_mov_b32 m0, 52736
    s_nop 0
    buffer_load_dwordx4 v98, s[8:11], s60 offen sc1 lds
    s_mov_b32 s60, 0x14f000
    s_mov_b32 m0, 54528
    s_nop 0
    buffer_load_dwordx4 v96, s[8:11], s60 offen sc1 lds
    s_mov_b32 m0, 55552
    s_nop 0
    buffer_load_dwordx4 v97, s[8:11], s60 offen sc1 lds
    s_mov_b32 m0, 56576
    s_nop 0
    buffer_load_dwordx4 v98, s[8:11], s60 offen sc1 lds
    s_mov_b32 s60, 0x28f000
    s_mov_b32 m0, 58368
    s_nop 0
    buffer_load_dwordx4 v96, s[8:11], s60 offen sc1 lds
    s_mov_b32 m0, 59392
    s_nop 0
    buffer_load_dwordx4 v97, s[8:11], s60 offen sc1 lds
    s_mov_b32 m0, 60416
    s_nop 0
    buffer_load_dwordx4 v98, s[8:11], s60 offen sc1 lds
    s_mov_b32 s60, 0x3cf000
    s_mov_b32 m0, 62208
    s_nop 0
    buffer_load_dwordx4 v96, s[8:11], s60 offen sc1 lds
    s_mov_b32 m0, 63232
    s_nop 0
    buffer_load_dwordx4 v97, s[8:11], s60 offen sc1 lds
    s_mov_b32 m0, 64256
    s_nop 0
    buffer_load_dwordx4 v98, s[8:11], s60 offen sc1 lds
D_JOIN2:
    ds_read_b32 v11, v90
    s_waitcnt lgkmcnt(0)
    v_readfirstlane_b32 s60, v11
    s_sleep 1
    s_cmp_lt_u32 s60, 3
    s_cbranch_scc1 D_JOIN2
    s_and_b32 s60, s2, 7
    s_lshl_b32 s60, s60, 8
    s_add_u32 s60, s60, 4096
    v_mov_b32 v2, 0
    v_mov_b32 v109, 1
    s_mov_b64 exec, 1
    buffer_atomic_add v109, v2, s[8:11], s60 offen sc0 sc1
    s_mov_b64 exec, -1
    s_branch D_KG_DONE
D_KGEN:
    s_mul_i32 s59, s3, 16384
    s_add_u32 s59, s59, 77568
    v_mul_u32_u24 v9, 112, v1
    v_add_u32 v9, s59, v9
    v_mul_u32_u24 v79, 144, v1
    s_add_u32 s60, s59, 7168
    v_add_u32 v79, s60, v79
    v_lshrrev_b32 v8, 5, v1
    v_bfe_u32 v2, v1, 3, 1
    v_lshl_add_u32 v2, v8, 2, v2
    v_bfe_u32 v3, v1, 4, 1
    v_lshlrev_b32 v3, 5, v3
    v_and_b32 v11, 3, v1
    v_lshl_add_u32 v3, v11, 3, v3
    v_bfe_u32 v11, v1, 2, 1
    v_mul_u32_u24 v10, 112, v2
    v_add_u32 v10, v10, v3
    v_mul_u32_u24 v81, 48, v11
    v_add3_u32 v10, v10, v81, s59
    v_mul_u32_u24 v80, 144, v2
    v_add_u32 v80, v80, v3
    v_lshl_add_u32 v80, v11, 6, v80
    s_mul_i32 s59, s3, 9216
    s_add_u32 s59, s59, 21760
    v_add_u32 v81, s59, v80
    v_add_u32 v80, s60, v80
    v_and_b32 v7, 31, v1
    v_mov_b32 v12, 0
    v_mov_b32 v13, 0
    v_mov_b32 v14, 0
    v_mov_b32 v15, 0
    v_mov_b32 v16, 0
    v_mov_b32 v17, 0
    v_mov_b32 v18, 0
    v_mov_b32 v19, 0
    v_mov_b32 v20, 0
    v_mov_b32 v21, 0
    v_mov_b32 v22, 0
    v_mov_b32 v23, 0
    v_mov_b32 v24, 0
    v_mov_b32 v25, 0
    v_mov_b32 v26, 0
    v_mov_b32 v27, 0
    s_cmp_eq_u32 s43, 1
    s_cbranch_scc1 D_PW9
    s_waitcnt vmcnt(2)
D_PW9:
    s_waitcnt vmcnt(6)
    s_mov_b32 s60, 0x3fb8aa3b
    v_lshlrev_b32 v118, 16, v118
    v_mul_f32 v118, s60, v118
    v_exp_f32 v118, v118
    s_nop 0
    v_cvt_pk_bf16_f32 v118, v118, v118
    v_and_b32 v118, s42, v118
    s_mov_b32 s61, 0
    v_lshlrev_b32 v28, 16, v100
    v_lshlrev_b32 v29, 16, v101
    v_lshlrev_b32 v30, 16, v102
    v_lshlrev_b32 v31, 16, v103
    v_lshlrev_b32 v32, 16, v104
    v_lshlrev_b32 v33, 16, v105
    v_mul_f32 v28, v118, v28
    v_mul_f32 v29, v118, v29
    v_mul_f32 v30, v118, v30
    v_mul_f32 v31, v118, v31
    v_mul_f32 v28, s60, v28
    v_mul_f32 v29, 0.15915494, v29
    v_mul_f32 v34, v33, v31
    v_mul_f32 v35, v33, v30
    v_fma_f32 v36, v32, v30, -v34
    v_fma_f32 v37, v32, v31, v35
    v_mul_f32 v58, 0x3f800000, v28
    v_mul_f32 v59, 0x3f800000, v29
    v_exp_f32 v58, v58
    v_fract_f32 v59, v59
    v_cos_f32 v38, v59
    v_sin_f32 v39, v59
    v_mov_b32 v100, v106
    v_mov_b32 v101, v107
    v_mov_b32 v102, v108
    v_mov_b32 v103, v109
    v_mul_f32 v38, v38, v58
    v_mul_f32 v39, v39, v58
    v_mul_f32 v58, 0x41000000, v28
    v_mul_f32 v59, 0x41000000, v29
    v_exp_f32 v58, v58
    v_fract_f32 v59, v59
    v_cos_f32 v40, v59
    v_sin_f32 v41, v59
    v_mov_b32 v104, v110
    v_mov_b32 v105, v111
    v_mov_b32 v106, v112
    v_mov_b32 v107, v113
    v_mul_f32 v40, v40, v58
    v_mul_f32 v41, v41, v58
    v_mul_f32 v58, 0x43800000, v28
    v_mul_f32 v59, 0x43800000, v29
    v_exp_f32 v58, v58
    v_fract_f32 v59, v59
    v_cos_f32 v42, v59
    v_sin_f32 v43, v59
    v_mov_b32 v108, v114
    v_mov_b32 v109, v115
    v_mov_b32 v110, v116
    v_mov_b32 v111, v117
    v_mul_f32 v42, v42, v58
    v_mul_f32 v43, v43, v58
D_KGL:
    v_pk_mul_f32 v[34:35], v[38:39], v[38:39] op_sel:[1,1] op_sel_hi:[1,0] neg_lo:[1,0]
    v_pk_fma_f32 v[44:45], v[38:39], v[38:39], v[34:35] op_sel:[0,0,0] op_sel_hi:[0,1,1]
    v_pk_mul_f32 v[34:35], v[42:43], v[42:43] op_sel:[1,1] op_sel_hi:[1,0] neg_lo:[1,0]
    v_pk_fma_f32 v[50:51], v[42:43], v[42:43], v[34:35] op_sel:[0,0,0] op_sel_hi:[0,1,1]
    v_pk_mul_f32 v[34:35], v[44:45], v[44:45] op_sel:[1,1] op_sel_hi:[1,0] neg_lo:[1,0]
    v_pk_fma_f32 v[46:47], v[44:45], v[44:45], v[34:35] op_sel:[0,0,0] op_sel_hi:[0,1,1]
    v_pk_mul_f32 v[34:35], v[36:37], v[38:39] op_sel:[1,1] op_sel_hi:[1,0] neg_lo:[1,0]
    v_pk_fma_f32 v[54:55], v[36:37], v[38:39], v[34:35] op_sel:[0,0,0] op_sel_hi:[0,1,1]
    v_cvt_pk_bf16_f32 v60, v36, v54
    v_cvt_pk_bf16_f32 v64, v37, v55
    v_pk_mul_f32 v[34:35], v[36:37], v[44:45] op_sel:[1,1] op_sel_hi:[1,0] neg_lo:[1,0]
    v_pk_fma_f32 v[52:53], v[36:37], v[44:45], v[34:35] op_sel:[0,0,0] op_sel_hi:[0,1,1]
    v_pk_mul_f32 v[34:35], v[54:55], v[44:45] op_sel:[1,1] op_sel_hi:[1,0] neg_lo:[1,0]
    v_pk_fma_f32 v[54:55], v[54:55], v[44:45], v[34:35] op_sel:[0,0,0] op_sel_hi:[0,1,1]
    v_cvt_pk_bf16_f32 v61, v52, v54
    v_cvt_pk_bf16_f32 v65, v53, v55
    v_pk_mul_f32 v[34:35], v[52:53], v[44:45] op_sel:[1,1] op_sel_hi:[1,0] neg_lo:[1,0]
    v_pk_fma_f32 v[52:53], v[52:53], v[44:45], v[34:35] op_sel:[0,0,0] op_sel_hi:[0,1,1]
    v_pk_mul_f32 v[34:35], v[54:55], v[44:45] op_sel:[1,1] op_sel_hi:[1,0] neg_lo:[1,0]
    v_pk_fma_f32 v[54:55], v[54:55], v[44:45], v[34:35] op_sel:[0,0,0] op_sel_hi:[0,1,1]
    v_cvt_pk_bf16_f32 v62, v52, v54
    v_cvt_pk_bf16_f32 v66, v53, v55
    v_pk_mul_f32 v[34:35], v[52:53], v[44:45] op_sel:[1,1] op_sel_hi:[1,0] neg_lo:[1,0]
    v_pk_fma_f32 v[52:53], v[52:53], v[44:45], v[34:35] op_sel:[0,0,0] op_sel_hi:[0,1,1]
    v_pk_mul_f32 v[34:35], v[54:55], v[44:45] op_sel:[1,1] op_sel_hi:[1,0] neg_lo:[1,0]
    v_pk_fma_f32 v[54:55], v[54:55], v[44:45], v[34:35] op_sel:[0,0,0] op_sel_hi:[0,1,1]
    v_cvt_pk_bf16_f32 v63, v52, v54
    v_cvt_pk_bf16_f32 v67, v53, v55
    ds_write_b128 v9, v[60:63] offset:0
    ds_write_b128 v9, v[64:67] offset:48
    v_pk_mul_f32 v[34:35], v[36:37], v[42:43] op_sel:[1,1] op_sel_hi:[1,0] neg_lo:[1,0]
    v_pk_fma_f32 v[52:53], v[36:37], v[42:43], v[34:35] op_sel:[0,0,0] op_sel_hi:[0,1,1]
    v_pk_mul_f32 v[34:35], v[52:53], v[44:45] op_sel:[1,1] op_sel_hi:[1,0] neg_lo:[1,0]
    v_pk_fma_f32 v[54:55], v[52:53], v[44:45], v[34:35] op_sel:[0,0,0] op_sel_hi:[0,1,1]
    v_cvt_pk_bf16_f32 v68, v52, v54
    v_cvt_pk_bf16_f32 v72, v53, v55
    v_pk_mul_f32 v[34:35], v[52:53], v[46:47] op_sel:[1,1] op_sel_hi:[1,0] neg_lo:[1,0]
    v_pk_fma_f32 v[52:53], v[52:53], v[46:47], v[34:35] op_sel:[0,0,0] op_sel_hi:[0,1,1]
    v_pk_mul_f32 v[34:35], v[54:55], v[46:47] op_sel:[1,1] op_sel_hi:[1,0] neg_lo:[1,0]
    v_pk_fma_f32 v[54:55], v[54:55], v[46:47], v[34:35] op_sel:[0,0,0] op_sel_hi:[0,1,1]
    v_cvt_pk_bf16_f32 v69, v52, v54
    v_cvt_pk_bf16_f32 v73, v53, v55
    v_pk_mul_f32 v[34:35], v[36:37], v[50:51] op_sel:[1,1] op_sel_hi:[1,0] neg_lo:[1,0]
    v_pk_fma_f32 v[56:57], v[36:37], v[50:51], v[34:35] op_sel:[0,0,0] op_sel_hi:[0,1,1]
    v_pk_mul_f32 v[34:35], v[56:57], v[46:47] op_sel:[1,1] op_sel_hi:[1,0] neg_lo:[1,0]
    v_pk_fma_f32 v[54:55], v[56:57], v[46:47], v[34:35] op_sel:[0,0,0] op_sel_hi:[0,1,1]
    v_cvt_pk_bf16_f32 v70, v56, v54
    v_cvt_pk_bf16_f32 v74, v57, v55
    v_pk_mul_f32 v[34:35], v[56:57], v[42:43] op_sel:[1,1] op_sel_hi:[1,0] neg_lo:[1,0]
    v_pk_fma_f32 v[52:53], v[56:57], v[42:43], v[34:35] op_sel:[0,0,0] op_sel_hi:[0,1,1]
    v_pk_mul_f32 v[34:35], v[54:55], v[42:43] op_sel:[1,1] op_sel_hi:[1,0] neg_lo:[1,0]
    v_pk_fma_f32 v[54:55], v[54:55], v[42:43], v[34:35] op_sel:[0,0,0] op_sel_hi:[0,1,1]
    v_cvt_pk_bf16_f32 v71, v52, v54
    v_cvt_pk_bf16_f32 v75, v53, v55
    ds_write_b128 v9, v[68:71] offset:16
    ds_write_b128 v9, v[72:75] offset:64
    v_pk_mul_f32 v[34:35], v[52:53], v[50:51] op_sel:[1,1] op_sel_hi:[1,0] neg_lo:[1,0]
    v_pk_fma_f32 v[54:55], v[52:53], v[50:51], v[34:35] op_sel:[0,0,0] op_sel_hi:[0,1,1]
    v_pk_mul_f32 v[34:35], v[56:57], v[50:51] op_sel:[1,1] op_sel_hi:[1,0] neg_lo:[1,0]
    v_pk_fma_f32 v[52:53], v[56:57], v[50:51], v[34:35] op_sel:[0,0,0] op_sel_hi:[0,1,1]
    v_cvt_pk_bf16_f32 v60, v52, v54
    v_cvt_pk_bf16_f32 v64, v53, v55
    v_pk_mul_f32 v[34:35], v[52:53], v[50:51] op_sel:[1,1] op_sel_hi:[1,0] neg_lo:[1,0]
    v_pk_fma_f32 v[52:53], v[52:53], v[50:51], v[34:35] op_sel:[0,0,0] op_sel_hi:[0,1,1]
    v_pk_mul_f32 v[34:35], v[54:55], v[50:51] op_sel:[1,1] op_sel_hi:[1,0] neg_lo:[1,0]
    v_pk_fma_f32 v[54:55], v[54:55], v[50:51], v[34:35] op_sel:[0,0,0] op_sel_hi:[0,1,1]
    v_cvt_pk_bf16_f32 v61, v52, v54
    v_cvt_pk_bf16_f32 v65, v53, v55
    v_pk_mul_f32 v[34:35], v[52:53], v[50:51] op_sel:[1,1] op_sel_hi:[1,0] neg_lo:[1,0]
    v_pk_fma_f32 v[52:53], v[52:53], v[50:51], v[34:35] op_sel:[0,0,0] op_sel_hi:[0,1,1]
    v_cvt_pk_bf16_f32 v62, v52, v52
    v_cvt_pk_bf16_f32 v66, v53, v53
    ds_write_b128 v9, v[60:63] offset:32
    ds_write_b128 v9, v[64:67] offset:80
    s_cmp_lt_u32 s61, 2
    s_cbranch_scc1 D_BGEN
    v_mov_b32 v80, v81
D_BWAIT:
    ds_read_b32 v2, v90 offset:8
    s_waitcnt lgkmcnt(0)
    v_readfirstlane_b32 s59, v2
    s_nop 3
    s_cmp_gt_u32 s59, s3
    s_cbranch_scc0 D_BWAIT
    s_branch D_BDONE
D_BGEN:
    v_pk_mul_f32 v[34:35], v[40:41], v[40:41] op_sel:[1,1] op_sel_hi:[1,0] neg_lo:[1,0]
    v_pk_fma_f32 v[48:49], v[40:41], v[40:41], v[34:35] op_sel:[0,0,0] op_sel_hi:[0,1,1]
    v_mov_b32 v52, 1.0
    v_mov_b32 v53, 0
    v_cvt_pk_bf16_f32 v68, v52, v40
    v_cvt_pk_bf16_f32 v72, -v53, -v41
    v_pk_mul_f32 v[34:35], v[40:41], v[48:49] op_sel:[1,1] op_sel_hi:[1,0] neg_lo:[1,0]
    v_pk_fma_f32 v[54:55], v[40:41], v[48:49], v[34:35] op_sel:[0,0,0] op_sel_hi:[0,1,1]
    v_cvt_pk_bf16_f32 v69, v48, v54
    v_cvt_pk_bf16_f32 v73, -v49, -v55
    v_pk_mul_f32 v[34:35], v[48:49], v[48:49] op_sel:[1,1] op_sel_hi:[1,0] neg_lo:[1,0]
    v_pk_fma_f32 v[52:53], v[48:49], v[48:49], v[34:35] op_sel:[0,0,0] op_sel_hi:[0,1,1]
    v_pk_mul_f32 v[34:35], v[54:55], v[48:49] op_sel:[1,1] op_sel_hi:[1,0] neg_lo:[1,0]
    v_pk_fma_f32 v[54:55], v[54:55], v[48:49], v[34:35] op_sel:[0,0,0] op_sel_hi:[0,1,1]
    v_cvt_pk_bf16_f32 v70, v52, v54
    v_cvt_pk_bf16_f32 v74, -v53, -v55
    v_pk_mul_f32 v[34:35], v[52:53], v[48:49] op_sel:[1,1] op_sel_hi:[1,0] neg_lo:[1,0]
    v_pk_fma_f32 v[52:53], v[52:53], v[48:49], v[34:35] op_sel:[0,0,0] op_sel_hi:[0,1,1]
    v_pk_mul_f32 v[34:35], v[54:55], v[48:49] op_sel:[1,1] op_sel_hi:[1,0] neg_lo:[1,0]
    v_pk_fma_f32 v[54:55], v[54:55], v[48:49], v[34:35] op_sel:[0,0,0] op_sel_hi:[0,1,1]
    v_cvt_pk_bf16_f32 v71, v52, v54
    v_cvt_pk_bf16_f32 v75, -v53, -v55
    ds_write_b128 v79, v[68:71] offset:0
    ds_write_b128 v79, v[72:75] offset:64
    v_pk_mul_f32 v[34:35], v[52:53], v[48:49] op_sel:[1,1] op_sel_hi:[1,0] neg_lo:[1,0]
    v_pk_fma_f32 v[52:53], v[52:53], v[48:49], v[34:35] op_sel:[0,0,0] op_sel_hi:[0,1,1]
    v_pk_mul_f32 v[34:35], v[54:55], v[48:49] op_sel:[1,1] op_sel_hi:[1,0] neg_lo:[1,0]
    v_pk_fma_f32 v[54:55], v[54:55], v[48:49], v[34:35] op_sel:[0,0,0] op_sel_hi:[0,1,1]
    v_cvt_pk_bf16_f32 v60, v52, v54
    v_cvt_pk_bf16_f32 v64, -v53, -v55
    v_pk_mul_f32 v[34:35], v[52:53], v[48:49] op_sel:[1,1] op_sel_hi:[1,0] neg_lo:[1,0]
    v_pk_fma_f32 v[52:53], v[52:53], v[48:49], v[34:35] op_sel:[0,0,0] op_sel_hi:[0,1,1]
    v_pk_mul_f32 v[34:35], v[54:55], v[48:49] op_sel:[1,1] op_sel_hi:[1,0] neg_lo:[1,0]
    v_pk_fma_f32 v[54:55], v[54:55], v[48:49], v[34:35] op_sel:[0,0,0] op_sel_hi:[0,1,1]
    v_cvt_pk_bf16_f32 v61, v52, v54
    v_cvt_pk_bf16_f32 v65, -v53, -v55
    v_pk_mul_f32 v[34:35], v[52:53], v[48:49] op_sel:[1,1] op_sel_hi:[1,0] neg_lo:[1,0]
    v_pk_fma_f32 v[52:53], v[52:53], v[48:49], v[34:35] op_sel:[0,0,0] op_sel_hi:[0,1,1]
    v_pk_mul_f32 v[34:35], v[54:55], v[48:49] op_sel:[1,1] op_sel_hi:[1,0] neg_lo:[1,0]
    v_pk_fma_f32 v[54:55], v[54:55], v[48:49], v[34:35] op_sel:[0,0,0] op_sel_hi:[0,1,1]
    v_cvt_pk_bf16_f32 v62, v52, v54
    v_cvt_pk_bf16_f32 v66, -v53, -v55
    v_pk_mul_f32 v[34:35], v[52:53], v[48:49] op_sel:[1,1] op_sel_hi:[1,0] neg_lo:[1,0]
    v_pk_fma_f32 v[52:53], v[52:53], v[48:49], v[34:35] op_sel:[0,0,0] op_sel_hi:[0,1,1]
    v_pk_mul_f32 v[34:35], v[54:55], v[48:49] op_sel:[1,1] op_sel_hi:[1,0] neg_lo:[1,0]
    v_pk_fma_f32 v[54:55], v[54:55], v[48:49], v[34:35] op_sel:[0,0,0] op_sel_hi:[0,1,1]
    v_cvt_pk_bf16_f32 v63, v52, v54
    v_cvt_pk_bf16_f32 v67, -v53, -v55
    ds_write_b128 v79, v[60:63] offset:16
    ds_write_b128 v79, v[64:67] offset:80
    v_pk_mul_f32 v[34:35], v[52:53], v[48:49] op_sel:[1,1] op_sel_hi:[1,0] neg_lo:[1,0]
    v_pk_fma_f32 v[52:53], v[52:53], v[48:49], v[34:35] op_sel:[0,0,0] op_sel_hi:[0,1,1]
    v_pk_mul_f32 v[34:35], v[54:55], v[48:49] op_sel:[1,1] op_sel_hi:[1,0] neg_lo:[1,0]
    v_pk_fma_f32 v[54:55], v[54:55], v[48:49], v[34:35] op_sel:[0,0,0] op_sel_hi:[0,1,1]
    v_cvt_pk_bf16_f32 v68, v52, v54
    v_cvt_pk_bf16_f32 v72, -v53, -v55
    v_pk_mul_f32 v[34:35], v[52:53], v[48:49] op_sel:[1,1] op_sel_hi:[1,0] neg_lo:[1,0]
    v_pk_fma_f32 v[52:53], v[52:53], v[48:49], v[34:35] op_sel:[0,0,0] op_sel_hi:[0,1,1]
    v_pk_mul_f32 v[34:35], v[54:55], v[48:49] op_sel:[1,1] op_sel_hi:[1,0] neg_lo:[1,0]
    v_pk_fma_f32 v[54:55], v[54:55], v[48:49], v[34:35] op_sel:[0,0,0] op_sel_hi:[0,1,1]
    v_cvt_pk_bf16_f32 v69, v52, v54
    v_cvt_pk_bf16_f32 v73, -v53, -v55
    v_pk_mul_f32 v[34:35], v[52:53], v[48:49] op_sel:[1,1] op_sel_hi:[1,0] neg_lo:[1,0]
    v_pk_fma_f32 v[52:53], v[52:53], v[48:49], v[34:35] op_sel:[0,0,0] op_sel_hi:[0,1,1]
    v_pk_mul_f32 v[34:35], v[54:55], v[48:49] op_sel:[1,1] op_sel_hi:[1,0] neg_lo:[1,0]
    v_pk_fma_f32 v[54:55], v[54:55], v[48:49], v[34:35] op_sel:[0,0,0] op_sel_hi:[0,1,1]
    v_cvt_pk_bf16_f32 v70, v52, v54
    v_cvt_pk_bf16_f32 v74, -v53, -v55
    v_pk_mul_f32 v[34:35], v[52:53], v[48:49] op_sel:[1,1] op_sel_hi:[1,0] neg_lo:[1,0]
    v_pk_fma_f32 v[52:53], v[52:53], v[48:49], v[34:35] op_sel:[0,0,0] op_sel_hi:[0,1,1]
    v_pk_mul_f32 v[34:35], v[54:55], v[48:49] op_sel:[1,1] op_sel_hi:[1,0] neg_lo:[1,0]
    v_pk_fma_f32 v[54:55], v[54:55], v[48:49], v[34:35] op_sel:[0,0,0] op_sel_hi:[0,1,1]
    v_cvt_pk_bf16_f32 v71, v52, v54
    v_cvt_pk_bf16_f32 v75, -v53, -v55
    ds_write_b128 v79, v[68:71] offset:32
    ds_write_b128 v79, v[72:75] offset:96
    v_pk_mul_f32 v[34:35], v[52:53], v[48:49] op_sel:[1,1] op_sel_hi:[1,0] neg_lo:[1,0]
    v_pk_fma_f32 v[52:53], v[52:53], v[48:49], v[34:35] op_sel:[0,0,0] op_sel_hi:[0,1,1]
    v_pk_mul_f32 v[34:35], v[54:55], v[48:49] op_sel:[1,1] op_sel_hi:[1,0] neg_lo:[1,0]
    v_pk_fma_f32 v[54:55], v[54:55], v[48:49], v[34:35] op_sel:[0,0,0] op_sel_hi:[0,1,1]
    v_cvt_pk_bf16_f32 v60, v52, v54
    v_cvt_pk_bf16_f32 v64, -v53, -v55
    v_pk_mul_f32 v[34:35], v[52:53], v[48:49] op_sel:[1,1] op_sel_hi:[1,0] neg_lo:[1,0]
    v_pk_fma_f32 v[52:53], v[52:53], v[48:49], v[34:35] op_sel:[0,0,0] op_sel_hi:[0,1,1]
    v_pk_mul_f32 v[34:35], v[54:55], v[48:49] op_sel:[1,1] op_sel_hi:[1,0] neg_lo:[1,0]
    v_pk_fma_f32 v[54:55], v[54:55], v[48:49], v[34:35] op_sel:[0,0,0] op_sel_hi:[0,1,1]
    v_cvt_pk_bf16_f32 v61, v52, v54
    v_cvt_pk_bf16_f32 v65, -v53, -v55
    v_pk_mul_f32 v[34:35], v[52:53], v[48:49] op_sel:[1,1] op_sel_hi:[1,0] neg_lo:[1,0]
    v_pk_fma_f32 v[52:53], v[52:53], v[48:49], v[34:35] op_sel:[0,0,0] op_sel_hi:[0,1,1]
    v_pk_mul_f32 v[34:35], v[54:55], v[48:49] op_sel:[1,1] op_sel_hi:[1,0] neg_lo:[1,0]
    v_pk_fma_f32 v[54:55], v[54:55], v[48:49], v[34:35] op_sel:[0,0,0] op_sel_hi:[0,1,1]
    v_cvt_pk_bf16_f32 v62, v52, v54
    v_cvt_pk_bf16_f32 v66, -v53, -v55
    v_pk_mul_f32 v[34:35], v[52:53], v[48:49] op_sel:[1,1] op_sel_hi:[1,0] neg_lo:[1,0]
    v_pk_fma_f32 v[52:53], v[52:53], v[48:49], v[34:35] op_sel:[0,0,0] op_sel_hi:[0,1,1]
    v_pk_mul_f32 v[34:35], v[54:55], v[48:49] op_sel:[1,1] op_sel_hi:[1,0] neg_lo:[1,0]
    v_pk_fma_f32 v[54:55], v[54:55], v[48:49], v[34:35] op_sel:[0,0,0] op_sel_hi:[0,1,1]
    v_cvt_pk_bf16_f32 v63, v52, v54
    v_cvt_pk_bf16_f32 v67, -v53, -v55
    ds_write_b128 v79, v[60:63] offset:48
    ds_write_b128 v79, v[64:67] offset:112
    s_cmp_eq_u32 s3, 3
    s_cbranch_scc1 D_W3_RET
D_BDONE:
    ds_read_b64_tr_b16 v[132:133], v10 offset:0
    ds_read_b64_tr_b16 v[134:135], v10 offset:224
    ds_read_b64_tr_b16 v[136:137], v80 offset:0
    ds_read_b64_tr_b16 v[138:139], v80 offset:288
    ds_read_b64_tr_b16 v[140:141], v10 offset:896
    ds_read_b64_tr_b16 v[142:143], v10 offset:1120
    ds_read_b64_tr_b16 v[144:145], v80 offset:1152
    ds_read_b64_tr_b16 v[146:147], v80 offset:1440
    ds_read_b64_tr_b16 v[148:149], v10 offset:1792
    ds_read_b64_tr_b16 v[150:151], v10 offset:2016
    ds_read_b64_tr_b16 v[152:153], v80 offset:2304
    ds_read_b64_tr_b16 v[154:155], v80 offset:2592
    s_waitcnt lgkmcnt(8)
    v_mfma_f32_32x32x16_bf16 v[12:27], v[132:135], v[136:139], v[12:27]
    ds_read_b64_tr_b16 v[156:157], v10 offset:2688
    ds_read_b64_tr_b16 v[158:159], v10 offset:2912
    ds_read_b64_tr_b16 v[160:161], v80 offset:3456
    ds_read_b64_tr_b16 v[162:163], v80 offset:3744
    v_lshlrev_b32 v28, 16, v100
    v_lshlrev_b32 v29, 16, v101
    v_lshlrev_b32 v30, 16, v102
    v_lshlrev_b32 v31, 16, v103
    v_lshlrev_b32 v32, 16, v104
    v_lshlrev_b32 v33, 16, v105
    v_mul_f32 v28, v118, v28
    s_waitcnt lgkmcnt(8)
    v_mfma_f32_32x32x16_bf16 v[12:27], v[140:143], v[144:147], v[12:27]
    ds_read_b64_tr_b16 v[164:165], v10 offset:3584
    ds_read_b64_tr_b16 v[166:167], v10 offset:3808
    ds_read_b64_tr_b16 v[168:169], v80 offset:4608
    ds_read_b64_tr_b16 v[170:171], v80 offset:4896
    v_mul_f32 v29, v118, v29
    v_mul_f32 v30, v118, v30
    v_mul_f32 v31, v118, v31
    v_mul_f32 v28, s60, v28
    v_mul_f32 v29, 0.15915494, v29
    v_mul_f32 v34, v33, v31
    v_mul_f32 v35, v33, v30
    s_waitcnt lgkmcnt(8)
    v_mfma_f32_32x32x16_bf16 v[12:27], v[148:151], v[152:155], v[12:27]
    ds_read_b64_tr_b16 v[172:173], v10 offset:4480
    ds_read_b64_tr_b16 v[174:175], v10 offset:4704
    ds_read_b64_tr_b16 v[176:177], v80 offset:5760
    ds_read_b64_tr_b16 v[178:179], v80 offset:6048
    v_fma_f32 v36, v32, v30, -v34
    v_fma_f32 v37, v32, v31, v35
    v_mul_f32 v58, 0x3f800000, v28
    v_mul_f32 v59, 0x3f800000, v29
    v_exp_f32 v58, v58
    v_fract_f32 v59, v59
    v_cos_f32 v38, v59
    s_waitcnt lgkmcnt(8)
    v_mfma_f32_32x32x16_bf16 v[12:27], v[156:159], v[160:163], v[12:27]
    ds_read_b64_tr_b16 v[180:181], v10 offset:5376
    ds_read_b64_tr_b16 v[182:183], v10 offset:5600
    ds_read_b64_tr_b16 v[184:185], v80 offset:6912
    ds_read_b64_tr_b16 v[186:187], v80 offset:7200
    v_sin_f32 v39, v59
    v_mov_b32 v100, v106
    v_mov_b32 v101, v107
    v_mov_b32 v102, v108
    v_mov_b32 v103, v109
    v_mul_f32 v38, v38, v58
    v_mul_f32 v39, v39, v58
    s_waitcnt lgkmcnt(8)
    v_mfma_f32_32x32x16_bf16 v[12:27], v[164:167], v[168:171], v[12:27]
    ds_read_b64_tr_b16 v[188:189], v10 offset:6272
    ds_read_b64_tr_b16 v[190:191], v10 offset:6496
    ds_read_b64_tr_b16 v[192:193], v80 offset:8064
    ds_read_b64_tr_b16 v[194:195], v80 offset:8352
    v_mul_f32 v58, 0x41000000, v28
    v_mul_f32 v59, 0x41000000, v29
    v_exp_f32 v58, v58
    v_fract_f32 v59, v59
    v_cos_f32 v40, v59
    v_sin_f32 v41, v59
    v_mov_b32 v104, v110
    s_waitcnt lgkmcnt(8)
    v_mfma_f32_32x32x16_bf16 v[12:27], v[172:175], v[176:179], v[12:27]
    v_mov_b32 v105, v111
    v_mov_b32 v106, v112
    v_mov_b32 v107, v113
    v_mul_f32 v40, v40, v58
    v_mul_f32 v41, v41, v58
    v_mul_f32 v58, 0x43800000, v28
    v_mul_f32 v59, 0x43800000, v29
    s_waitcnt lgkmcnt(4)
    v_mfma_f32_32x32x16_bf16 v[12:27], v[180:183], v[184:187], v[12:27]
    v_exp_f32 v58, v58
    v_fract_f32 v59, v59
    v_cos_f32 v42, v59
    v_sin_f32 v43, v59
    v_mov_b32 v108, v114
    v_mov_b32 v109, v115
    v_mov_b32 v110, v116
    s_waitcnt lgkmcnt(0)
    v_mfma_f32_32x32x16_bf16 v[12:27], v[188:191], v[192:195], v[12:27]
    v_mov_b32 v111, v117
    v_mul_f32 v42, v42, v58
    v_mul_f32 v43, v43, v58
    s_add_u32 s61, s61, 1
    s_cmp_lg_u32 s61, 1
    s_cbranch_scc1 D_KGNP
    s_cmp_eq_u32 s43, 0
    s_cbranch_scc1 D_KGNP
    s_waitcnt vmcnt(0)
    ds_read_b64_tr_b16 v[60:61], v91 offset:0
    ds_read_b64_tr_b16 v[62:63], v91 offset:512
    ds_read_b64_tr_b16 v[64:65], v91 offset:32
    ds_read_b64_tr_b16 v[66:67], v91 offset:544
    ds_read_b64_tr_b16 v[68:69], v91 offset:64
    ds_read_b64_tr_b16 v[70:71], v91 offset:576
    ds_read_b64_tr_b16 v[72:73], v91 offset:96
    ds_read_b64_tr_b16 v[74:75], v91 offset:608
    s_waitcnt lgkmcnt(6)
    buffer_store_dwordx4 v[60:63], v6, s[8:11], s31 offen sc1
    s_add_u32 s31, s31, s30
    s_waitcnt lgkmcnt(4)
    buffer_store_dwordx4 v[64:67], v6, s[8:11], s31 offen sc1
    s_add_u32 s31, s31, s30
    s_waitcnt lgkmcnt(2)
    buffer_store_dwordx4 v[68:71], v6, s[8:11], s31 offen sc1
    s_add_u32 s31, s31, s30
    s_waitcnt lgkmcnt(0)
    buffer_store_dwordx4 v[72:75], v6, s[8:11], s31 offen sc1
D_KGNP:
    s_cmp_lg_u32 s61, 2
    s_cbranch_scc1 D_KGNS
    s_waitcnt vmcnt(0)
    v_mov_b32 v2, 1
    s_mov_b64 exec, 1
    ds_add_u32 v90, v2
    s_mov_b64 exec, -1
D_KGNS:
    s_cmp_lt_u32 s61, 3
    s_cbranch_scc1 D_KGL
    s_mul_i32 s59, s3, 1664
    s_add_u32 s59, s59, 65344
    v_lshlrev_b32 v28, 4, v7
    v_lshl_add_u32 v28, v8, 3, v28
    v_add_u32 v28, s59, v28
    v_cmp_eq_u32 vcc, 1, v8
    v_lshlrev_b32 v31, 3, v7
    v_add_u32 v29, 512, v31
    v_add_u32 v30, 516, v31
    v_lshlrev_b32 v31, 2, v7
    v_add_u32 v32, 768, v31
    v_cndmask_b32 v29, v29, v32, vcc
    v_add_u32 v32, 896, v31
    v_cndmask_b32 v30, v30, v32, vcc
    v_add_u32 v29, s59, v29
    v_add_u32 v30, s59, v30
    v_lshlrev_b32 v31, 1, v7
    v_lshl_add_u32 v31, v8, 8, v31
    v_add_u32 v31, s59, v31
    v_cvt_pk_bf16_f32 v34, v12, v13
    v_cvt_pk_bf16_f32 v35, v14, v15
    v_cvt_pk_bf16_f32 v36, v16, v17
    v_cvt_pk_bf16_f32 v37, v18, v19
    v_cvt_pk_bf16_f32 v38, v20, v20
    v_cvt_pk_bf16_f32 v39, v21, v21
    v_cvt_pk_bf16_f32 v40, v22, v22
    v_cvt_pk_bf16_f32 v41, v23, v23
    ds_write_b64 v28, v[34:35]
    ds_write_b32 v29, v36
    ds_write_b32 v30, v37
    ds_write_b16 v31, v38 offset:1024
    ds_write_b16 v31, v39 offset:1088
    ds_write_b16 v31, v40 offset:1152
    ds_write_b16 v31, v41 offset:1216
    s_waitcnt vmcnt(0)
D_KG_DONE:
    s_waitcnt lgkmcnt(0)
    s_barrier
    v_lshlrev_b32 v9, 4, v0
    ds_read_b32 v2, v90 offset:4
    ds_read_u16 v12, v120 offset:0
    ds_read_u16 v13, v121 offset:0
    ds_read_u16 v14, v122 offset:0
    ds_read_u16 v15, v123 offset:0
    ds_read_u16 v16, v124 offset:0
    ds_read_u16 v17, v125 offset:0
    ds_read_u16 v18, v126 offset:0
    ds_read_u16 v19, v127 offset:0
    ds_read_u16 v20, v128 offset:0
    ds_read_u16 v21, v129 offset:0
    ds_read_u16 v22, v130 offset:0
    s_add_u32 m0, s98, 0
    s_nop 0
    buffer_load_dwordx4 v89, s[68:71], s66 offen lds
    s_add_u32 m0, s98, 1024
    s_add_u32 s66, s66, s99
    buffer_load_dwordx4 v89, s[68:71], s66 offen lds
    s_add_u32 m0, s98, 2048
    s_add_u32 s66, s66, s99
    buffer_load_dwordx4 v89, s[68:71], s66 offen lds
    s_add_u32 m0, s98, 3072
    s_add_u32 s66, s66, s99
    buffer_load_dwordx4 v89, s[68:71], s66 offen lds
    s_getreg_b32 s60, hwreg(HW_REG_XCC_ID)
    s_and_b32 s60, s60, 7
    s_lshl_b32 s60, s60, 8
    s_add_u32 s60, s60, 6144
    v_mov_b32 v7, s60
    v_mov_b32 v8, 8
    s_waitcnt lgkmcnt(11)
    v_readfirstlane_b32 s7, v2
    s_nop 3
    s_lshr_b32 s4, s7, 5
    s_and_b32 s6, s7, 7
    s_lshr_b32 s7, s7, 3
    s_and_b32 s5, s7, 3
    s_mul_i32 s16, s6, 5
    s_add_u32 s17, s16, 4
    s_add_u32 s16, s16, s3
    s_lshl_b32 s18, s3, 10
    s_mul_i32 s19, s16, 20480
    s_mul_i32 s20, s17, 20480
    s_mul_i32 s21, s3, 5120
    s_add_u32 s20, s20, s21
    s_mul_i32 s29, s6, 12
    s_lshl_b32 s22, s3, 1
    s_add_u32 s22, s22, s29
    s_add_u32 s23, s29, s3
    s_add_u32 s23, s23, 8
    s_mul_i32 s24, s22, 20480
    s_mul_i32 s25, s23, 20480
    s_mul_i32 s26, s16, 49152
    s_mul_i32 s27, s17, 49152
    s_mul_i32 s28, s3, 12288
    s_add_u32 s27, s27, s28
    v_lshrrev_b32 v2, 2, v0
    v_mul_u32_u24 v2, 4160, v2
    v_and_b32 v3, 3, v0
    v_lshl_add_u32 v2, v3, 4, v2
    v_mov_b32 v100, 0
    v_mov_b32 v101, 0
    v_mov_b32 v102, 0
    v_mov_b32 v103, 0
    v_cmp_gt_u32 vcc, 48, v0
    s_waitcnt lgkmcnt(0)
    ds_read_u16 v24, v120 offset:1664
    ds_read_u16 v25, v121 offset:1664
    ds_read_u16 v26, v122 offset:1664
    ds_read_u16 v27, v123 offset:1664
    ds_read_u16 v28, v124 offset:1664
    ds_read_u16 v29, v125 offset:1664
    ds_read_u16 v30, v126 offset:1664
    ds_read_u16 v31, v127 offset:1664
    ds_read_u16 v32, v128 offset:1664
    ds_read_u16 v33, v129 offset:1664
    ds_read_u16 v34, v130 offset:1664
    v_lshl_or_b32 v48, v13, 16, v12
    v_lshl_or_b32 v49, v15, 16, v14
    v_lshl_or_b32 v50, v17, 16, v16
    v_lshl_or_b32 v51, v19, 16, v18
    ds_write_b128 v9, v[48:51] offset:0
    v_lshl_or_b32 v52, v14, 16, v13
    v_lshl_or_b32 v53, v16, 16, v15
    v_lshl_or_b32 v54, v18, 16, v17
    v_lshl_or_b32 v55, v20, 16, v19
    ds_write_b128 v9, v[52:55] offset:4160
    v_lshl_or_b32 v56, v15, 16, v14
    v_lshl_or_b32 v57, v17, 16, v16
    v_lshl_or_b32 v58, v19, 16, v18
    v_lshl_or_b32 v59, v21, 16, v20
    ds_write_b128 v9, v[56:59] offset:8320
    v_lshl_or_b32 v60, v16, 16, v15
    v_lshl_or_b32 v61, v18, 16, v17
    v_lshl_or_b32 v62, v20, 16, v19
    v_lshl_or_b32 v63, v22, 16, v21
    ds_write_b128 v9, v[60:63] offset:12480
    s_waitcnt lgkmcnt(4)
    ds_read_u16 v36, v120 offset:3328
    ds_read_u16 v37, v121 offset:3328
    ds_read_u16 v38, v122 offset:3328
    ds_read_u16 v39, v123 offset:3328
    ds_read_u16 v40, v124 offset:3328
    ds_read_u16 v41, v125 offset:3328
    ds_read_u16 v42, v126 offset:3328
    ds_read_u16 v43, v127 offset:3328
    ds_read_u16 v44, v128 offset:3328
    ds_read_u16 v45, v129 offset:3328
    ds_read_u16 v46, v130 offset:3328
    v_lshl_or_b32 v64, v25, 16, v24
    v_lshl_or_b32 v65, v27, 16, v26
    v_lshl_or_b32 v66, v29, 16, v28
    v_lshl_or_b32 v67, v31, 16, v30
    ds_write_b128 v9, v[64:67] offset:16640
    v_lshl_or_b32 v68, v26, 16, v25
    v_lshl_or_b32 v69, v28, 16, v27
    v_lshl_or_b32 v70, v30, 16, v29
    v_lshl_or_b32 v71, v32, 16, v31
    ds_write_b128 v9, v[68:71] offset:20800
    v_lshl_or_b32 v72, v27, 16, v26
    v_lshl_or_b32 v73, v29, 16, v28
    v_lshl_or_b32 v74, v31, 16, v30
    v_lshl_or_b32 v75, v33, 16, v32
    ds_write_b128 v9, v[72:75] offset:24960
    v_lshl_or_b32 v76, v28, 16, v27
    v_lshl_or_b32 v77, v30, 16, v29
    v_lshl_or_b32 v78, v32, 16, v31
    v_lshl_or_b32 v79, v34, 16, v33
    ds_write_b128 v9, v[76:79] offset:29120
    s_waitcnt lgkmcnt(4)
    v_lshl_or_b32 v48, v37, 16, v36
    v_lshl_or_b32 v49, v39, 16, v38
    v_lshl_or_b32 v50, v41, 16, v40
    v_lshl_or_b32 v51, v43, 16, v42
    ds_write_b128 v9, v[48:51] offset:33280
    v_lshl_or_b32 v52, v38, 16, v37
    v_lshl_or_b32 v53, v40, 16, v39
    v_lshl_or_b32 v54, v42, 16, v41
    v_lshl_or_b32 v55, v44, 16, v43
    ds_write_b128 v9, v[52:55] offset:37440
    v_lshl_or_b32 v56, v39, 16, v38
    v_lshl_or_b32 v57, v41, 16, v40
    v_lshl_or_b32 v58, v43, 16, v42
    v_lshl_or_b32 v59, v45, 16, v44
    ds_write_b128 v9, v[56:59] offset:41600
    v_lshl_or_b32 v60, v40, 16, v39
    v_lshl_or_b32 v61, v42, 16, v41
    v_lshl_or_b32 v62, v44, 16, v43
    v_lshl_or_b32 v63, v46, 16, v45
    ds_write_b128 v9, v[60:63] offset:45760
    s_and_saveexec_b64 s[44:45], vcc
    ds_write_b128 v2, v[100:103] offset:4096
    s_mov_b64 exec, s[44:45]
    s_waitcnt lgkmcnt(0)
    v_accvgpr_read_b32 v76, a248
    v_accvgpr_read_b32 v77, a249
    v_accvgpr_read_b32 v78, a250
    v_accvgpr_read_b32 v79, a251
    v_accvgpr_read_b32 v80, a252
    v_accvgpr_read_b32 v81, a253
    v_accvgpr_read_b32 v82, a254
    v_accvgpr_read_b32 v83, a255
    s_cmp_lg_u32 s3, 3
    s_cbranch_scc1 D_NBF
    s_waitcnt vmcnt(4)
    v_readfirstlane_b32 s60, v109
    s_nop 3
    s_cmp_lg_u32 s60, 31
    s_cbranch_scc1 NOTLAST_6
    v_mov_b32 v3, 1
    s_mov_b32 s60, 6144
    v_and_b32 v2, 7, v1
    v_lshlrev_b32 v2, 8, v2
    s_mov_b64 exec, 0xff
    buffer_atomic_add v3, v2, s[8:11], s60 offen sc1
    s_mov_b64 exec, -1
NOTLAST_6:
D_NBF:
    s_barrier
    ds_read_b64 v[128:129], v94 offset:3264
    ds_read_b64 v[130:131], v94 offset:3272
    ds_read_b128 v[144:147], v95 offset:144
    ds_read_b128 v[148:151], v95 offset:912
    ds_read_b128 v[152:155], v95 offset:1680
    ds_read_b128 v[156:159], v95 offset:2448
    ds_read_b64 v[132:133], v94 offset:2240
    ds_read_b64 v[134:135], v94 offset:2248
    ds_read_b64 v[136:137], v94 offset:1216
    ds_read_b64 v[138:139], v94 offset:1224
    ds_read_b64 v[140:141], v94 offset:192
    ds_read_b64 v[142:143], v94 offset:200
    s_waitcnt lgkmcnt(4)
    s_mul_i32 s59, s3, 3072
    s_mul_i32 s60, s3, 1310720
    s_add_u32 s60, s60, 0xf040
    v_mfma_f32_16x16x32_bf16 v[28:31], v[128:131], v[144:147], 0
    ds_read_b64 v[160:161], v94 offset:3200
    ds_read_b64 v[162:163], v94 offset:3208
    v_mfma_f32_16x16x32_bf16 v[32:35], v[128:131], v[148:151], 0
    ds_read_b128 v[176:179], v95 offset:96
    ds_read_b128 v[180:183], v95 offset:864
    v_mfma_f32_16x16x32_bf16 v[36:39], v[128:131], v[152:155], 0
    ds_read_b128 v[184:187], v95 offset:1632
    ds_read_b128 v[188:191], v95 offset:2400
    v_mfma_f32_16x16x32_bf16 v[40:43], v[128:131], v[156:159], 0
    ds_read_b64 v[164:165], v94 offset:2176
    ds_read_b64 v[166:167], v94 offset:2184
    v_mfma_f32_16x16x32_bf16 v[32:35], v[132:135], v[144:147], v[32:35]
    s_add_u32 m0, s59, 65280
    s_nop 0
    buffer_load_dwordx4 v96, s[8:11], s60 offen sc1 lds
    v_mfma_f32_16x16x32_bf16 v[36:39], v[132:135], v[148:151], v[36:39]
    ds_read_b64 v[168:169], v94 offset:1152
    ds_read_b64 v[170:171], v94 offset:1160
    v_mfma_f32_16x16x32_bf16 v[40:43], v[132:135], v[152:155], v[40:43]
    s_waitcnt lgkmcnt(10)
    v_mfma_f32_16x16x32_bf16 v[36:39], v[136:139], v[144:147], v[36:39]
    ds_read_b64 v[172:173], v94 offset:128
    ds_read_b64 v[174:175], v94 offset:136
    v_mfma_f32_16x16x32_bf16 v[40:43], v[136:139], v[148:151], v[40:43]
    s_add_u32 m0, s59, 66304
    s_nop 0
    buffer_load_dwordx4 v97, s[8:11], s60 offen sc1 lds
    v_mfma_f32_16x16x32_bf16 v[40:43], v[140:143], v[144:147], v[40:43]
    s_waitcnt lgkmcnt(4)
    v_mfma_f32_16x16x32_bf16 v[28:31], v[160:163], v[176:179], v[28:31]
    ds_read_b64 v[128:129], v94 offset:3136
    ds_read_b64 v[130:131], v94 offset:3144
    v_mfma_f32_16x16x32_bf16 v[32:35], v[160:163], v[180:183], v[32:35]
    ds_read_b128 v[144:147], v95 offset:48
    ds_read_b128 v[148:151], v95 offset:816
    v_mfma_f32_16x16x32_bf16 v[36:39], v[160:163], v[184:187], v[36:39]
    ds_read_b128 v[152:155], v95 offset:1584
    ds_read_b128 v[156:159], v95 offset:2352
    v_mfma_f32_16x16x32_bf16 v[40:43], v[160:163], v[188:191], v[40:43]
    ds_read_b64 v[132:133], v94 offset:2112
    ds_read_b64 v[134:135], v94 offset:2120
    v_mfma_f32_16x16x32_bf16 v[32:35], v[164:167], v[176:179], v[32:35]
    s_add_u32 m0, s59, 67328
    s_nop 0
    buffer_load_dwordx4 v98, s[8:11], s60 offen sc1 lds
    v_mfma_f32_16x16x32_bf16 v[36:39], v[164:167], v[180:183], v[36:39]
    ds_read_b64 v[136:137], v94 offset:1088
    ds_read_b64 v[138:139], v94 offset:1096
    v_mfma_f32_16x16x32_bf16 v[40:43], v[164:167], v[184:187], v[40:43]
    s_waitcnt lgkmcnt(10)
    v_mfma_f32_16x16x32_bf16 v[36:39], v[168:171], v[176:179], v[36:39]
    ds_read_b64 v[140:141], v94 offset:64
    ds_read_b64 v[142:143], v94 offset:72
    v_mfma_f32_16x16x32_bf16 v[40:43], v[168:171], v[180:183], v[40:43]
    v_mfma_f32_16x16x32_bf16 v[40:43], v[172:175], v[176:179], v[40:43]
    s_waitcnt lgkmcnt(4)
    v_mfma_f32_16x16x32_bf16 v[28:31], v[128:131], v[144:147], v[28:31]
    ds_read_b64 v[160:161], v94 offset:3072
    ds_read_b64 v[162:163], v94 offset:3080
    v_mfma_f32_16x16x32_bf16 v[32:35], v[128:131], v[148:151], v[32:35]
    ds_read_b128 v[176:179], v95 offset:0
    ds_read_b128 v[180:183], v95 offset:768
    v_mfma_f32_16x16x32_bf16 v[36:39], v[128:131], v[152:155], v[36:39]
    ds_read_b128 v[184:187], v95 offset:1536
    ds_read_b128 v[188:191], v95 offset:2304
    v_mfma_f32_16x16x32_bf16 v[40:43], v[128:131], v[156:159], v[40:43]
    ds_read_b64 v[164:165], v94 offset:2048
    ds_read_b64 v[166:167], v94 offset:2056
    v_mfma_f32_16x16x32_bf16 v[32:35], v[132:135], v[144:147], v[32:35]
    v_mfma_f32_16x16x32_bf16 v[36:39], v[132:135], v[148:151], v[36:39]
    ds_read_b64 v[168:169], v94 offset:1024
    ds_read_b64 v[170:171], v94 offset:1032
    v_mfma_f32_16x16x32_bf16 v[40:43], v[132:135], v[152:155], v[40:43]
    s_waitcnt lgkmcnt(10)
    v_mfma_f32_16x16x32_bf16 v[36:39], v[136:139], v[144:147], v[36:39]
    ds_read_b64 v[172:173], v94 offset:0
    ds_read_b64 v[174:175], v94 offset:8
    v_mfma_f32_16x16x32_bf16 v[40:43], v[136:139], v[148:151], v[40:43]
    v_mfma_f32_16x16x32_bf16 v[40:43], v[140:143], v[144:147], v[40:43]
    s_waitcnt lgkmcnt(4)
    v_mfma_f32_16x16x32_bf16 v[28:31], v[160:163], v[176:179], v[28:31]
    ds_read_b64 v[128:129], v92 offset:4032
    ds_read_b64 v[130:131], v92 offset:4040
    v_mfma_f32_16x16x32_bf16 v[32:35], v[160:163], v[180:183], v[32:35]
    ds_read_b128 v[144:147], v93 offset:720
    ds_read_b128 v[148:151], v93 offset:1488
    v_mfma_f32_16x16x32_bf16 v[36:39], v[160:163], v[184:187], v[36:39]
    ds_read_b128 v[152:155], v93 offset:2256
    ds_read_b128 v[156:159], v93 offset:3024
    v_mfma_f32_16x16x32_bf16 v[40:43], v[160:163], v[188:191], v[40:43]
    ds_read_b64 v[132:133], v92 offset:3008
    ds_read_b64 v[134:135], v92 offset:3016
    v_mfma_f32_16x16x32_bf16 v[32:35], v[164:167], v[176:179], v[32:35]
    v_mfma_f32_16x16x32_bf16 v[36:39], v[164:167], v[180:183], v[36:39]
    ds_read_b64 v[136:137], v92 offset:1984
    ds_read_b64 v[138:139], v92 offset:1992
    v_mfma_f32_16x16x32_bf16 v[40:43], v[164:167], v[184:187], v[40:43]
    s_waitcnt lgkmcnt(10)
    v_mfma_f32_16x16x32_bf16 v[36:39], v[168:171], v[176:179], v[36:39]
    ds_read_b64 v[140:141], v92 offset:960
    ds_read_b64 v[142:143], v92 offset:968
    v_mfma_f32_16x16x32_bf16 v[40:43], v[168:171], v[180:183], v[40:43]
    v_mfma_f32_16x16x32_bf16 v[40:43], v[172:175], v[176:179], v[40:43]
    s_waitcnt lgkmcnt(4)
    v_mfma_f32_16x16x32_bf16 v[12:15], v[128:131], v[144:147], 0
    ds_read_b64 v[160:161], v92 offset:3968
    ds_read_b64 v[162:163], v92 offset:3976
    v_mfma_f32_16x16x32_bf16 v[16:19], v[128:131], v[148:151], 0
    ds_read_b128 v[176:179], v93 offset:672
    ds_read_b128 v[180:183], v93 offset:1440
    v_mfma_f32_16x16x32_bf16 v[20:23], v[128:131], v[152:155], 0
    ds_read_b128 v[184:187], v93 offset:2208
    ds_read_b128 v[188:191], v93 offset:2976
    v_mfma_f32_16x16x32_bf16 v[24:27], v[128:131], v[156:159], 0
    ds_read_b64 v[164:165], v92 offset:2944
    ds_read_b64 v[166:167], v92 offset:2952
    v_mfma_f32_16x16x32_bf16 v[16:19], v[132:135], v[144:147], v[16:19]
    v_mfma_f32_16x16x32_bf16 v[20:23], v[132:135], v[148:151], v[20:23]
    ds_read_b64 v[168:169], v92 offset:1920
    ds_read_b64 v[170:171], v92 offset:1928
    v_mfma_f32_16x16x32_bf16 v[24:27], v[132:135], v[152:155], v[24:27]
    s_waitcnt lgkmcnt(10)
    v_mfma_f32_16x16x32_bf16 v[20:23], v[136:139], v[144:147], v[20:23]
    ds_read_b64 v[172:173], v92 offset:896
    ds_read_b64 v[174:175], v92 offset:904
    v_mfma_f32_16x16x32_bf16 v[24:27], v[136:139], v[148:151], v[24:27]
    v_mfma_f32_16x16x32_bf16 v[24:27], v[140:143], v[144:147], v[24:27]
    s_waitcnt lgkmcnt(4)
    ds_write_b128 v83, v[28:31] offset:0
    ds_write_b128 v83, v[32:35] offset:1024
    ds_write_b128 v83, v[36:39] offset:2048
    ds_write_b128 v83, v[40:43] offset:3072
    v_mfma_f32_16x16x32_bf16 v[12:15], v[160:163], v[176:179], v[12:15]
    ds_read_b64 v[128:129], v92 offset:3904
    ds_read_b64 v[130:131], v92 offset:3912
    v_mfma_f32_16x16x32_bf16 v[16:19], v[160:163], v[180:183], v[16:19]
    ds_read_b128 v[144:147], v93 offset:624
    ds_read_b128 v[148:151], v93 offset:1392
    v_mfma_f32_16x16x32_bf16 v[20:23], v[160:163], v[184:187], v[20:23]
    ds_read_b128 v[152:155], v93 offset:2160
    ds_read_b128 v[156:159], v93 offset:2928
    v_mfma_f32_16x16x32_bf16 v[24:27], v[160:163], v[188:191], v[24:27]
    ds_read_b64 v[132:133], v92 offset:2880
    ds_read_b64 v[134:135], v92 offset:2888
    v_mfma_f32_16x16x32_bf16 v[16:19], v[164:167], v[176:179], v[16:19]
    v_mfma_f32_16x16x32_bf16 v[20:23], v[164:167], v[180:183], v[20:23]
    ds_read_b64 v[136:137], v92 offset:1856
    ds_read_b64 v[138:139], v92 offset:1864
    v_mfma_f32_16x16x32_bf16 v[24:27], v[164:167], v[184:187], v[24:27]
    s_waitcnt lgkmcnt(10)
    v_mfma_f32_16x16x32_bf16 v[20:23], v[168:171], v[176:179], v[20:23]
    ds_read_b64 v[140:141], v92 offset:832
    ds_read_b64 v[142:143], v92 offset:840
    v_mfma_f32_16x16x32_bf16 v[24:27], v[168:171], v[180:183], v[24:27]
    v_mfma_f32_16x16x32_bf16 v[24:27], v[172:175], v[176:179], v[24:27]
    s_waitcnt lgkmcnt(4)
    v_mfma_f32_16x16x32_bf16 v[12:15], v[128:131], v[144:147], v[12:15]
    ds_read_b64 v[160:161], v92 offset:3840
    ds_read_b64 v[162:163], v92 offset:3848
    v_mfma_f32_16x16x32_bf16 v[16:19], v[128:131], v[148:151], v[16:19]
    ds_read_b128 v[176:179], v93 offset:576
    ds_read_b128 v[180:183], v93 offset:1344
    v_mfma_f32_16x16x32_bf16 v[20:23], v[128:131], v[152:155], v[20:23]
    ds_read_b128 v[184:187], v93 offset:2112
    ds_read_b128 v[188:191], v93 offset:2880
    v_mfma_f32_16x16x32_bf16 v[24:27], v[128:131], v[156:159], v[24:27]
    ds_read_b64 v[164:165], v92 offset:2816
    ds_read_b64 v[166:167], v92 offset:2824
    v_mfma_f32_16x16x32_bf16 v[16:19], v[132:135], v[144:147], v[16:19]
    v_mfma_f32_16x16x32_bf16 v[20:23], v[132:135], v[148:151], v[20:23]
    ds_read_b64 v[168:169], v92 offset:1792
    ds_read_b64 v[170:171], v92 offset:1800
    v_mfma_f32_16x16x32_bf16 v[24:27], v[132:135], v[152:155], v[24:27]
    s_waitcnt lgkmcnt(10)
    v_mfma_f32_16x16x32_bf16 v[20:23], v[136:139], v[144:147], v[20:23]
    ds_read_b64 v[172:173], v92 offset:768
    ds_read_b64 v[174:175], v92 offset:776
    v_mfma_f32_16x16x32_bf16 v[24:27], v[136:139], v[148:151], v[24:27]
    v_mfma_f32_16x16x32_bf16 v[24:27], v[140:143], v[144:147], v[24:27]
    s_waitcnt lgkmcnt(4)
    v_mfma_f32_16x16x32_bf16 v[12:15], v[160:163], v[176:179], v[12:15]
    ds_read_b64 v[128:129], v92 offset:3776
    ds_read_b64 v[130:131], v92 offset:3784
    v_mfma_f32_16x16x32_bf16 v[16:19], v[160:163], v[180:183], v[16:19]
    ds_read_b128 v[144:147], v93 offset:528
    ds_read_b128 v[148:151], v93 offset:1296
    v_mfma_f32_16x16x32_bf16 v[20:23], v[160:163], v[184:187], v[20:23]
    ds_read_b128 v[152:155], v93 offset:2064
    ds_read_b128 v[156:159], v93 offset:2832
    v_mfma_f32_16x16x32_bf16 v[24:27], v[160:163], v[188:191], v[24:27]
    ds_read_b64 v[132:133], v92 offset:2752
    ds_read_b64 v[134:135], v92 offset:2760
    v_mfma_f32_16x16x32_bf16 v[16:19], v[164:167], v[176:179], v[16:19]
    v_mfma_f32_16x16x32_bf16 v[20:23], v[164:167], v[180:183], v[20:23]
    ds_read_b64 v[136:137], v92 offset:1728
    ds_read_b64 v[138:139], v92 offset:1736
    v_mfma_f32_16x16x32_bf16 v[24:27], v[164:167], v[184:187], v[24:27]
    s_waitcnt lgkmcnt(10)
    v_mfma_f32_16x16x32_bf16 v[20:23], v[168:171], v[176:179], v[20:23]
    ds_read_b64 v[140:141], v92 offset:704
    ds_read_b64 v[142:143], v92 offset:712
    v_mfma_f32_16x16x32_bf16 v[24:27], v[168:171], v[180:183], v[24:27]
    v_mfma_f32_16x16x32_bf16 v[24:27], v[172:175], v[176:179], v[24:27]
    s_waitcnt lgkmcnt(4)
    buffer_load_dword v9, v7, s[8:11], 0 offen sc1
    v_mfma_f32_16x16x32_bf16 v[12:15], v[128:131], v[144:147], v[12:15]
    ds_read_b64 v[160:161], v92 offset:3712
    ds_read_b64 v[162:163], v92 offset:3720
    v_mfma_f32_16x16x32_bf16 v[16:19], v[128:131], v[148:151], v[16:19]
    ds_read_b128 v[176:179], v93 offset:480
    ds_read_b128 v[180:183], v93 offset:1248
    v_mfma_f32_16x16x32_bf16 v[20:23], v[128:131], v[152:155], v[20:23]
    ds_read_b128 v[184:187], v93 offset:2016
    ds_read_b128 v[188:191], v93 offset:2784
    v_mfma_f32_16x16x32_bf16 v[24:27], v[128:131], v[156:159], v[24:27]
    ds_read_b64 v[164:165], v92 offset:2688
    ds_read_b64 v[166:167], v92 offset:2696
    v_mfma_f32_16x16x32_bf16 v[16:19], v[132:135], v[144:147], v[16:19]
    v_mfma_f32_16x16x32_bf16 v[20:23], v[132:135], v[148:151], v[20:23]
    ds_read_b64 v[168:169], v92 offset:1664
    ds_read_b64 v[170:171], v92 offset:1672
    v_mfma_f32_16x16x32_bf16 v[24:27], v[132:135], v[152:155], v[24:27]
    s_waitcnt lgkmcnt(10)
    v_mfma_f32_16x16x32_bf16 v[20:23], v[136:139], v[144:147], v[20:23]
    ds_read_b64 v[172:173], v92 offset:640
    ds_read_b64 v[174:175], v92 offset:648
    v_mfma_f32_16x16x32_bf16 v[24:27], v[136:139], v[148:151], v[24:27]
    v_mfma_f32_16x16x32_bf16 v[24:27], v[140:143], v[144:147], v[24:27]
    s_waitcnt lgkmcnt(4)
    s_waitcnt vmcnt(1)
    ds_read_b64_tr_b16 v[60:61], v91 offset:4096
    ds_read_b64_tr_b16 v[62:63], v91 offset:4608
    ds_read_b64_tr_b16 v[64:65], v91 offset:4128
    ds_read_b64_tr_b16 v[66:67], v91 offset:4640
    ds_read_b64_tr_b16 v[68:69], v91 offset:4160
    ds_read_b64_tr_b16 v[70:71], v91 offset:4672
    ds_read_b64_tr_b16 v[72:73], v91 offset:4192
    ds_read_b64_tr_b16 v[74:75], v91 offset:4704
    s_waitcnt lgkmcnt(6)
    buffer_store_dwordx4 v[60:63], v6, s[8:11], s67 offen sc1
    s_add_u32 s67, s67, s96
    s_waitcnt lgkmcnt(4)
    buffer_store_dwordx4 v[64:67], v6, s[8:11], s67 offen sc1
    s_add_u32 s67, s67, s96
    s_waitcnt lgkmcnt(2)
    buffer_store_dwordx4 v[68:71], v6, s[8:11], s67 offen sc1
    s_add_u32 s67, s67, s96
    s_waitcnt lgkmcnt(0)
    buffer_store_dwordx4 v[72:75], v6, s[8:11], s67 offen sc1
    v_lshlrev_b32 v10, 16, v87
    v_lshlrev_b32 v84, 16, v88
    v_mfma_f32_16x16x32_bf16 v[12:15], v[160:163], v[176:179], v[12:15]
    ds_read_b64 v[128:129], v92 offset:3648
    ds_read_b64 v[130:131], v92 offset:3656
    v_mfma_f32_16x16x32_bf16 v[16:19], v[160:163], v[180:183], v[16:19]
    ds_read_b128 v[144:147], v93 offset:432
    ds_read_b128 v[148:151], v93 offset:1200
    v_mfma_f32_16x16x32_bf16 v[20:23], v[160:163], v[184:187], v[20:23]
    ds_read_b128 v[152:155], v93 offset:1968
    ds_read_b128 v[156:159], v93 offset:2736
    v_mfma_f32_16x16x32_bf16 v[24:27], v[160:163], v[188:191], v[24:27]
    ds_read_b64 v[132:133], v92 offset:2624
    ds_read_b64 v[134:135], v92 offset:2632
    v_mfma_f32_16x16x32_bf16 v[16:19], v[164:167], v[176:179], v[16:19]
    v_mfma_f32_16x16x32_bf16 v[20:23], v[164:167], v[180:183], v[20:23]
    ds_read_b64 v[136:137], v92 offset:1600
    ds_read_b64 v[138:139], v92 offset:1608
    v_mfma_f32_16x16x32_bf16 v[24:27], v[164:167], v[184:187], v[24:27]
    s_waitcnt lgkmcnt(10)
    v_mfma_f32_16x16x32_bf16 v[20:23], v[168:171], v[176:179], v[20:23]
    ds_read_b64 v[140:141], v92 offset:576
    ds_read_b64 v[142:143], v92 offset:584
    v_mfma_f32_16x16x32_bf16 v[24:27], v[168:171], v[180:183], v[24:27]
    v_mfma_f32_16x16x32_bf16 v[24:27], v[172:175], v[176:179], v[24:27]
    s_waitcnt lgkmcnt(4)
    s_waitcnt vmcnt(4)
    v_cmp_ge_u32 vcc, v9, v8
    s_cmp_eq_u64 vcc, -1
    s_cbranch_scc1 POLLD_8
    s_mov_b32 s63, 20000
POLL_7:
    buffer_load_dword v9, v7, s[8:11], 0 offen sc1
    s_waitcnt vmcnt(0)
    v_cmp_ge_u32 vcc, v9, v8
    s_cmp_eq_u64 vcc, -1
    s_cbranch_scc1 POLLD_8
    s_sleep 2
    s_sub_u32 s63, s63, 1
    s_cmp_lg_u32 s63, 0
    s_cbranch_scc1 POLL_7
POLLD_8:
    v_mfma_f32_16x16x32_bf16 v[12:15], v[128:131], v[144:147], v[12:15]
    ds_read_b64 v[160:161], v92 offset:3584
    ds_read_b64 v[162:163], v92 offset:3592
    v_mfma_f32_16x16x32_bf16 v[16:19], v[128:131], v[148:151], v[16:19]
    ds_read_b128 v[176:179], v93 offset:384
    ds_read_b128 v[180:183], v93 offset:1152
    v_mfma_f32_16x16x32_bf16 v[20:23], v[128:131], v[152:155], v[20:23]
    ds_read_b128 v[184:187], v93 offset:1920
    ds_read_b128 v[188:191], v93 offset:2688
    v_mfma_f32_16x16x32_bf16 v[24:27], v[128:131], v[156:159], v[24:27]
    ds_read_b64 v[164:165], v92 offset:2560
    ds_read_b64 v[166:167], v92 offset:2568
    v_mfma_f32_16x16x32_bf16 v[16:19], v[132:135], v[144:147], v[16:19]
    s_add_u32 s62, s19, 7925760
    buffer_load_dwordx4 a[0:3], v6, s[8:11], s62 offen offset:0
    v_mfma_f32_16x16x32_bf16 v[20:23], v[132:135], v[148:151], v[20:23]
    ds_read_b64 v[168:169], v92 offset:1536
    ds_read_b64 v[170:171], v92 offset:1544
    v_mfma_f32_16x16x32_bf16 v[24:27], v[132:135], v[152:155], v[24:27]
    s_waitcnt lgkmcnt(10)
    v_mfma_f32_16x16x32_bf16 v[20:23], v[136:139], v[144:147], v[20:23]
    ds_read_b64 v[172:173], v92 offset:512
    ds_read_b64 v[174:175], v92 offset:520
    v_mfma_f32_16x16x32_bf16 v[24:27], v[136:139], v[148:151], v[24:27]
    buffer_load_dwordx4 a[4:7], v6, s[8:11], s62 offen offset:1024
    v_mfma_f32_16x16x32_bf16 v[24:27], v[140:143], v[144:147], v[24:27]
    s_waitcnt lgkmcnt(4)
    v_mfma_f32_16x16x32_bf16 v[12:15], v[160:163], v[176:179], v[12:15]
    ds_read_b64 v[128:129], v92 offset:3520
    ds_read_b64 v[130:131], v92 offset:3528
    v_mfma_f32_16x16x32_bf16 v[16:19], v[160:163], v[180:183], v[16:19]
    ds_read_b128 v[144:147], v93 offset:336
    ds_read_b128 v[148:151], v93 offset:1104
    v_mfma_f32_16x16x32_bf16 v[20:23], v[160:163], v[184:187], v[20:23]
    ds_read_b128 v[152:155], v93 offset:1872
    ds_read_b128 v[156:159], v93 offset:2640
    v_mfma_f32_16x16x32_bf16 v[24:27], v[160:163], v[188:191], v[24:27]
    ds_read_b64 v[132:133], v92 offset:2496
    ds_read_b64 v[134:135], v92 offset:2504
    v_mfma_f32_16x16x32_bf16 v[16:19], v[164:167], v[176:179], v[16:19]
    buffer_load_dwordx4 a[8:11], v6, s[8:11], s62 offen offset:2048
    v_mfma_f32_16x16x32_bf16 v[20:23], v[164:167], v[180:183], v[20:23]
    ds_read_b64 v[136:137], v92 offset:1472
    ds_read_b64 v[138:139], v92 offset:1480
    v_mfma_f32_16x16x32_bf16 v[24:27], v[164:167], v[184:187], v[24:27]
    s_waitcnt lgkmcnt(10)
    v_mfma_f32_16x16x32_bf16 v[20:23], v[168:171], v[176:179], v[20:23]
    ds_read_b64 v[140:141], v92 offset:448
    ds_read_b64 v[142:143], v92 offset:456
    v_mfma_f32_16x16x32_bf16 v[24:27], v[168:171], v[180:183], v[24:27]
    buffer_load_dwordx4 a[12:15], v6, s[8:11], s62 offen offset:3072
    v_mfma_f32_16x16x32_bf16 v[24:27], v[172:175], v[176:179], v[24:27]
    s_waitcnt lgkmcnt(4)
    v_mfma_f32_16x16x32_bf16 v[12:15], v[128:131], v[144:147], v[12:15]
    ds_read_b64 v[160:161], v92 offset:3456
    ds_read_b64 v[162:163], v92 offset:3464
    v_mfma_f32_16x16x32_bf16 v[16:19], v[128:131], v[148:151], v[16:19]
    ds_read_b128 v[176:179], v93 offset:288
    ds_read_b128 v[180:183], v93 offset:1056
    v_mfma_f32_16x16x32_bf16 v[20:23], v[128:131], v[152:155], v[20:23]
    ds_read_b128 v[184:187], v93 offset:1824
    ds_read_b128 v[188:191], v93 offset:2592
    v_mfma_f32_16x16x32_bf16 v[24:27], v[128:131], v[156:159], v[24:27]
    ds_read_b64 v[164:165], v92 offset:2432
    ds_read_b64 v[166:167], v92 offset:2440
    v_mfma_f32_16x16x32_bf16 v[16:19], v[132:135], v[144:147], v[16:19]
    s_add_u32 s62, s19, 7929856
    buffer_load_dwordx4 a[16:19], v6, s[8:11], s62 offen offset:0
    v_mfma_f32_16x16x32_bf16 v[20:23], v[132:135], v[148:151], v[20:23]
    ds_read_b64 v[168:169], v92 offset:1408
    ds_read_b64 v[170:171], v92 offset:1416
    v_mfma_f32_16x16x32_bf16 v[24:27], v[132:135], v[152:155], v[24:27]
    s_waitcnt lgkmcnt(10)
    v_mfma_f32_16x16x32_bf16 v[20:23], v[136:139], v[144:147], v[20:23]
    ds_read_b64 v[172:173], v92 offset:384
    ds_read_b64 v[174:175], v92 offset:392
    v_mfma_f32_16x16x32_bf16 v[24:27], v[136:139], v[148:151], v[24:27]
    buffer_load_dwordx4 a[20:23], v6, s[8:11], s62 offen offset:1024
    v_mfma_f32_16x16x32_bf16 v[24:27], v[140:143], v[144:147], v[24:27]
    s_waitcnt lgkmcnt(4)
    v_mfma_f32_16x16x32_bf16 v[12:15], v[160:163], v[176:179], v[12:15]
    ds_read_b64 v[128:129], v92 offset:3392
    ds_read_b64 v[130:131], v92 offset:3400
    v_mfma_f32_16x16x32_bf16 v[16:19], v[160:163], v[180:183], v[16:19]
    ds_read_b128 v[144:147], v93 offset:240
    ds_read_b128 v[148:151], v93 offset:1008
    v_mfma_f32_16x16x32_bf16 v[20:23], v[160:163], v[184:187], v[20:23]
    ds_read_b128 v[152:155], v93 offset:1776
    ds_read_b128 v[156:159], v93 offset:2544
    v_mfma_f32_16x16x32_bf16 v[24:27], v[160:163], v[188:191], v[24:27]
    ds_read_b64 v[132:133], v92 offset:2368
    ds_read_b64 v[134:135], v92 offset:2376
    v_mfma_f32_16x16x32_bf16 v[16:19], v[164:167], v[176:179], v[16:19]
    buffer_load_dwordx4 a[24:27], v6, s[8:11], s62 offen offset:2048
    v_mfma_f32_16x16x32_bf16 v[20:23], v[164:167], v[180:183], v[20:23]
    ds_read_b64 v[136:137], v92 offset:1344
    ds_read_b64 v[138:139], v92 offset:1352
    v_mfma_f32_16x16x32_bf16 v[24:27], v[164:167], v[184:187], v[24:27]
    s_waitcnt lgkmcnt(10)
    v_mfma_f32_16x16x32_bf16 v[20:23], v[168:171], v[176:179], v[20:23]
    ds_read_b64 v[140:141], v92 offset:320
    ds_read_b64 v[142:143], v92 offset:328
    v_mfma_f32_16x16x32_bf16 v[24:27], v[168:171], v[180:183], v[24:27]
    buffer_load_dwordx4 a[28:31], v6, s[8:11], s62 offen offset:3072
    v_mfma_f32_16x16x32_bf16 v[24:27], v[172:175], v[176:179], v[24:27]
    s_waitcnt lgkmcnt(4)
    v_mfma_f32_16x16x32_bf16 v[12:15], v[128:131], v[144:147], v[12:15]
    ds_read_b64 v[160:161], v92 offset:3328
    ds_read_b64 v[162:163], v92 offset:3336
    v_mfma_f32_16x16x32_bf16 v[16:19], v[128:131], v[148:151], v[16:19]
    ds_read_b128 v[176:179], v93 offset:192
    ds_read_b128 v[180:183], v93 offset:960
    v_mfma_f32_16x16x32_bf16 v[20:23], v[128:131], v[152:155], v[20:23]
    ds_read_b128 v[184:187], v93 offset:1728
    ds_read_b128 v[188:191], v93 offset:2496
    v_mfma_f32_16x16x32_bf16 v[24:27], v[128:131], v[156:159], v[24:27]
    ds_read_b64 v[164:165], v92 offset:2304
    ds_read_b64 v[166:167], v92 offset:2312
    v_mfma_f32_16x16x32_bf16 v[16:19], v[132:135], v[144:147], v[16:19]
    s_add_u32 s62, s19, 7933952
    buffer_load_dwordx4 a[32:35], v6, s[8:11], s62 offen offset:0
    v_mfma_f32_16x16x32_bf16 v[20:23], v[132:135], v[148:151], v[20:23]
    ds_read_b64 v[168:169], v92 offset:1280
    ds_read_b64 v[170:171], v92 offset:1288
    v_mfma_f32_16x16x32_bf16 v[24:27], v[132:135], v[152:155], v[24:27]
    s_waitcnt lgkmcnt(10)
    v_mfma_f32_16x16x32_bf16 v[20:23], v[136:139], v[144:147], v[20:23]
    ds_read_b64 v[172:173], v92 offset:256
    ds_read_b64 v[174:175], v92 offset:264
    v_mfma_f32_16x16x32_bf16 v[24:27], v[136:139], v[148:151], v[24:27]
    buffer_load_dwordx4 a[36:39], v6, s[8:11], s62 offen offset:1024
    v_mfma_f32_16x16x32_bf16 v[24:27], v[140:143], v[144:147], v[24:27]
    s_waitcnt lgkmcnt(4)
    v_mfma_f32_16x16x32_bf16 v[12:15], v[160:163], v[176:179], v[12:15]
    ds_read_b64 v[128:129], v92 offset:3264
    ds_read_b64 v[130:131], v92 offset:3272
    v_mfma_f32_16x16x32_bf16 v[16:19], v[160:163], v[180:183], v[16:19]
    ds_read_b128 v[144:147], v93 offset:144
    ds_read_b128 v[148:151], v93 offset:912
    v_mfma_f32_16x16x32_bf16 v[20:23], v[160:163], v[184:187], v[20:23]
    ds_read_b128 v[152:155], v93 offset:1680
    ds_read_b128 v[156:159], v93 offset:2448
    v_mfma_f32_16x16x32_bf16 v[24:27], v[160:163], v[188:191], v[24:27]
    ds_read_b64 v[132:133], v92 offset:2240
    ds_read_b64 v[134:135], v92 offset:2248
    v_mfma_f32_16x16x32_bf16 v[16:19], v[164:167], v[176:179], v[16:19]
    buffer_load_dwordx4 a[40:43], v6, s[8:11], s62 offen offset:2048
    v_mfma_f32_16x16x32_bf16 v[20:23], v[164:167], v[180:183], v[20:23]
    ds_read_b64 v[136:137], v92 offset:1216
    ds_read_b64 v[138:139], v92 offset:1224
    v_mfma_f32_16x16x32_bf16 v[24:27], v[164:167], v[184:187], v[24:27]
    s_waitcnt lgkmcnt(10)
    v_mfma_f32_16x16x32_bf16 v[20:23], v[168:171], v[176:179], v[20:23]
    ds_read_b64 v[140:141], v92 offset:192
    ds_read_b64 v[142:143], v92 offset:200
    v_mfma_f32_16x16x32_bf16 v[24:27], v[168:171], v[180:183], v[24:27]
    buffer_load_dwordx4 a[44:47], v6, s[8:11], s62 offen offset:3072
    v_mfma_f32_16x16x32_bf16 v[24:27], v[172:175], v[176:179], v[24:27]
    s_waitcnt lgkmcnt(4)
    v_mfma_f32_16x16x32_bf16 v[12:15], v[128:131], v[144:147], v[12:15]
    ds_read_b64 v[160:161], v92 offset:3200
    ds_read_b64 v[162:163], v92 offset:3208
    v_mfma_f32_16x16x32_bf16 v[16:19], v[128:131], v[148:151], v[16:19]
    ds_read_b128 v[176:179], v93 offset:96
    ds_read_b128 v[180:183], v93 offset:864
    v_mfma_f32_16x16x32_bf16 v[20:23], v[128:131], v[152:155], v[20:23]
    ds_read_b128 v[184:187], v93 offset:1632
    ds_read_b128 v[188:191], v93 offset:2400
    v_mfma_f32_16x16x32_bf16 v[24:27], v[128:131], v[156:159], v[24:27]
    ds_read_b64 v[164:165], v92 offset:2176
    ds_read_b64 v[166:167], v92 offset:2184
    v_mfma_f32_16x16x32_bf16 v[16:19], v[132:135], v[144:147], v[16:19]
    s_add_u32 s62, s19, 7938048
    buffer_load_dwordx4 a[48:51], v6, s[8:11], s62 offen offset:0
    v_mfma_f32_16x16x32_bf16 v[20:23], v[132:135], v[148:151], v[20:23]
    ds_read_b64 v[168:169], v92 offset:1152
    ds_read_b64 v[170:171], v92 offset:1160
    v_mfma_f32_16x16x32_bf16 v[24:27], v[132:135], v[152:155], v[24:27]
    s_waitcnt lgkmcnt(10)
    v_mfma_f32_16x16x32_bf16 v[20:23], v[136:139], v[144:147], v[20:23]
    ds_read_b64 v[172:173], v92 offset:128
    ds_read_b64 v[174:175], v92 offset:136
    v_mfma_f32_16x16x32_bf16 v[24:27], v[136:139], v[148:151], v[24:27]
    buffer_load_dwordx4 a[52:55], v6, s[8:11], s62 offen offset:1024
    v_mfma_f32_16x16x32_bf16 v[24:27], v[140:143], v[144:147], v[24:27]
    s_waitcnt lgkmcnt(4)
    s_barrier
    v_mfma_f32_16x16x32_bf16 v[12:15], v[160:163], v[176:179], v[12:15]
    ds_read_b64 v[128:129], v92 offset:3136
    ds_read_b64 v[130:131], v92 offset:3144
    v_mfma_f32_16x16x32_bf16 v[16:19], v[160:163], v[180:183], v[16:19]
    ds_read_b128 v[144:147], v93 offset:48
    ds_read_b128 v[148:151], v93 offset:816
    v_mfma_f32_16x16x32_bf16 v[20:23], v[160:163], v[184:187], v[20:23]
    ds_read_b128 v[152:155], v93 offset:1584
    ds_read_b128 v[156:159], v93 offset:2352
    v_mfma_f32_16x16x32_bf16 v[24:27], v[160:163], v[188:191], v[24:27]
    ds_read_b64 v[132:133], v92 offset:2112
    ds_read_b64 v[134:135], v92 offset:2120
    v_mfma_f32_16x16x32_bf16 v[16:19], v[164:167], v[176:179], v[16:19]
    buffer_load_dwordx4 a[56:59], v6, s[8:11], s62 offen offset:2048
    v_mfma_f32_16x16x32_bf16 v[20:23], v[164:167], v[180:183], v[20:23]
    ds_read_b64 v[136:137], v92 offset:1088
    ds_read_b64 v[138:139], v92 offset:1096
    v_mfma_f32_16x16x32_bf16 v[24:27], v[164:167], v[184:187], v[24:27]
    s_waitcnt lgkmcnt(10)
    v_mfma_f32_16x16x32_bf16 v[20:23], v[168:171], v[176:179], v[20:23]
    ds_read_b64 v[140:141], v92 offset:64
    ds_read_b64 v[142:143], v92 offset:72
    v_mfma_f32_16x16x32_bf16 v[24:27], v[168:171], v[180:183], v[24:27]
    buffer_load_dwordx4 a[60:63], v6, s[8:11], s62 offen offset:3072
    v_mfma_f32_16x16x32_bf16 v[24:27], v[172:175], v[176:179], v[24:27]
    s_waitcnt lgkmcnt(4)
    v_mfma_f32_16x16x32_bf16 v[12:15], v[128:131], v[144:147], v[12:15]
    ds_read_b64 v[160:161], v92 offset:3072
    ds_read_b64 v[162:163], v92 offset:3080
    v_mfma_f32_16x16x32_bf16 v[16:19], v[128:131], v[148:151], v[16:19]
    ds_read_b128 v[176:179], v93 offset:0
    ds_read_b128 v[180:183], v93 offset:768
    v_mfma_f32_16x16x32_bf16 v[20:23], v[128:131], v[152:155], v[20:23]
    ds_read_b128 v[184:187], v93 offset:1536
    ds_read_b128 v[188:191], v93 offset:2304
    v_mfma_f32_16x16x32_bf16 v[24:27], v[128:131], v[156:159], v[24:27]
    ds_read_b64 v[164:165], v92 offset:2048
    ds_read_b64 v[166:167], v92 offset:2056
    v_mfma_f32_16x16x32_bf16 v[16:19], v[132:135], v[144:147], v[16:19]
    v_mfma_f32_16x16x32_bf16 v[20:23], v[132:135], v[148:151], v[20:23]
    ds_read_b64 v[168:169], v92 offset:1024
    ds_read_b64 v[170:171], v92 offset:1032
    v_mfma_f32_16x16x32_bf16 v[24:27], v[132:135], v[152:155], v[24:27]
    s_waitcnt lgkmcnt(10)
    v_mfma_f32_16x16x32_bf16 v[20:23], v[136:139], v[144:147], v[20:23]
    ds_read_b64 v[172:173], v92 offset:0
    ds_read_b64 v[174:175], v92 offset:8
    v_mfma_f32_16x16x32_bf16 v[24:27], v[136:139], v[148:151], v[24:27]
    v_mfma_f32_16x16x32_bf16 v[24:27], v[140:143], v[144:147], v[24:27]
    s_waitcnt lgkmcnt(4)
    v_mfma_f32_16x16x32_bf16 v[12:15], v[160:163], v[176:179], v[12:15]
    v_mfma_f32_16x16x32_bf16 v[16:19], v[160:163], v[180:183], v[16:19]
    v_mfma_f32_16x16x32_bf16 v[20:23], v[160:163], v[184:187], v[20:23]
    v_mfma_f32_16x16x32_bf16 v[24:27], v[160:163], v[188:191], v[24:27]
    v_mfma_f32_16x16x32_bf16 v[16:19], v[164:167], v[176:179], v[16:19]
    v_mfma_f32_16x16x32_bf16 v[20:23], v[164:167], v[180:183], v[20:23]
    v_mfma_f32_16x16x32_bf16 v[24:27], v[164:167], v[184:187], v[24:27]
    s_waitcnt lgkmcnt(0)
    v_mfma_f32_16x16x32_bf16 v[20:23], v[168:171], v[176:179], v[20:23]
    v_mfma_f32_16x16x32_bf16 v[24:27], v[168:171], v[180:183], v[24:27]
    v_mfma_f32_16x16x32_bf16 v[24:27], v[172:175], v[176:179], v[24:27]
    ds_read_b64 v[50:51], v76 offset:50688
    ds_read_b64 v[60:61], v77 offset:0
    ds_read_b64 v[52:53], v76 offset:51456
    ds_read_b64 v[62:63], v77 offset:768
    ds_read_b64 v[54:55], v76 offset:52224
    ds_read_b64 v[64:65], v77 offset:1536
    ds_read_b64 v[56:57], v76 offset:52992
    ds_read_b64 v[66:67], v77 offset:2304
    ds_read_b64 v[58:59], v78 offset:50688
    ds_read_b64 v[68:69], v79
    ds_read_b128 v[28:31], v82 offset:0
    ds_read_b128 v[32:35], v82 offset:4096
    ds_read_b128 v[36:39], v82 offset:8192
    ds_read_b128 v[40:43], v82 offset:12288
    s_waitcnt lgkmcnt(12)
    v_lshlrev_b32 v100, 16, v50
    v_and_b32 v101, s42, v50
    v_lshlrev_b32 v102, 16, v51
    v_and_b32 v103, s42, v51
    v_pk_mul_f32 v[100:101], v[100:101], v[10:11] op_sel_hi:[1,0]
    v_pk_mul_f32 v[102:103], v[102:103], v[10:11] op_sel_hi:[1,0]
    v_cvt_pk_bf16_f32 v104, v100, v101
    v_cvt_pk_bf16_f32 v105, v102, v103
    v_cvt_pk_bf16_f32 v106, v12, v13
    v_cvt_pk_bf16_f32 v107, v14, v15
    v_lshlrev_b32 v100, 16, v104
    v_and_b32 v101, s42, v104
    v_lshlrev_b32 v102, 16, v105
    v_and_b32 v103, s42, v105
    v_lshlrev_b32 v12, 16, v106
    v_and_b32 v13, s42, v106
    v_lshlrev_b32 v14, 16, v107
    v_and_b32 v15, s42, v107
    v_pk_add_f32 v[12:13], v[12:13], v[100:101]
    v_pk_add_f32 v[14:15], v[14:15], v[102:103]
    v_cvt_pk_bf16_f32 v104, v12, v13
    v_cvt_pk_bf16_f32 v105, v14, v15
    v_lshlrev_b32 v100, 16, v104
    v_and_b32 v101, s42, v104
    v_lshlrev_b32 v102, 16, v105
    v_and_b32 v103, s42, v105
    v_lshlrev_b32 v12, 16, v60
    v_and_b32 v13, s42, v60
    v_lshlrev_b32 v14, 16, v61
    v_and_b32 v15, s42, v61
    v_pk_add_f32 v[12:13], v[12:13], v[100:101]
    v_pk_add_f32 v[14:15], v[14:15], v[102:103]
    v_cvt_pk_bf16_f32 v108, v12, v13
    v_cvt_pk_bf16_f32 v109, v14, v15
    s_waitcnt lgkmcnt(10)
    v_lshlrev_b32 v100, 16, v52
    v_and_b32 v101, s42, v52
    v_lshlrev_b32 v102, 16, v53
    v_and_b32 v103, s42, v53
    v_pk_mul_f32 v[100:101], v[100:101], v[10:11] op_sel_hi:[1,0]
    v_pk_mul_f32 v[102:103], v[102:103], v[10:11] op_sel_hi:[1,0]
    v_cvt_pk_bf16_f32 v104, v100, v101
    v_cvt_pk_bf16_f32 v105, v102, v103
    v_cvt_pk_bf16_f32 v106, v16, v17
    v_cvt_pk_bf16_f32 v107, v18, v19
    v_lshlrev_b32 v100, 16, v104
    v_and_b32 v101, s42, v104
    v_lshlrev_b32 v102, 16, v105
    v_and_b32 v103, s42, v105
    v_lshlrev_b32 v16, 16, v106
    v_and_b32 v17, s42, v106
    v_lshlrev_b32 v18, 16, v107
    v_and_b32 v19, s42, v107
    v_pk_add_f32 v[16:17], v[16:17], v[100:101]
    v_pk_add_f32 v[18:19], v[18:19], v[102:103]
    v_cvt_pk_bf16_f32 v104, v16, v17
    v_cvt_pk_bf16_f32 v105, v18, v19
    v_lshlrev_b32 v100, 16, v104
    v_and_b32 v101, s42, v104
    v_lshlrev_b32 v102, 16, v105
    v_and_b32 v103, s42, v105
    v_lshlrev_b32 v16, 16, v62
    v_and_b32 v17, s42, v62
    v_lshlrev_b32 v18, 16, v63
    v_and_b32 v19, s42, v63
    v_pk_add_f32 v[16:17], v[16:17], v[100:101]
    v_pk_add_f32 v[18:19], v[18:19], v[102:103]
    v_cvt_pk_bf16_f32 v110, v16, v17
    v_cvt_pk_bf16_f32 v111, v18, v19
    s_nop 1
    v_permlane16_swap_b32 v108, v110
    v_permlane16_swap_b32 v109, v111
    buffer_store_dwordx4 v[108:111], v80, s[8:11], s57 offen offset:0 sc1
    s_waitcnt lgkmcnt(8)
    v_lshlrev_b32 v100, 16, v54
    v_and_b32 v101, s42, v54
    v_lshlrev_b32 v102, 16, v55
    v_and_b32 v103, s42, v55
    v_pk_mul_f32 v[100:101], v[100:101], v[10:11] op_sel_hi:[1,0]
    v_pk_mul_f32 v[102:103], v[102:103], v[10:11] op_sel_hi:[1,0]
    v_cvt_pk_bf16_f32 v104, v100, v101
    v_cvt_pk_bf16_f32 v105, v102, v103
    v_cvt_pk_bf16_f32 v106, v20, v21
    v_cvt_pk_bf16_f32 v107, v22, v23
    v_lshlrev_b32 v100, 16, v104
    v_and_b32 v101, s42, v104
    v_lshlrev_b32 v102, 16, v105
    v_and_b32 v103, s42, v105
    v_lshlrev_b32 v20, 16, v106
    v_and_b32 v21, s42, v106
    v_lshlrev_b32 v22, 16, v107
    v_and_b32 v23, s42, v107
    v_pk_add_f32 v[20:21], v[20:21], v[100:101]
    v_pk_add_f32 v[22:23], v[22:23], v[102:103]
    v_cvt_pk_bf16_f32 v104, v20, v21
    v_cvt_pk_bf16_f32 v105, v22, v23
    v_lshlrev_b32 v100, 16, v104
    v_and_b32 v101, s42, v104
    v_lshlrev_b32 v102, 16, v105
    v_and_b32 v103, s42, v105
    v_lshlrev_b32 v20, 16, v64
    v_and_b32 v21, s42, v64
    v_lshlrev_b32 v22, 16, v65
    v_and_b32 v23, s42, v65
    v_pk_add_f32 v[20:21], v[20:21], v[100:101]
    v_pk_add_f32 v[22:23], v[22:23], v[102:103]
    v_cvt_pk_bf16_f32 v112, v20, v21
    v_cvt_pk_bf16_f32 v113, v22, v23
    s_waitcnt lgkmcnt(6)
    v_lshlrev_b32 v100, 16, v56
    v_and_b32 v101, s42, v56
    v_lshlrev_b32 v102, 16, v57
    v_and_b32 v103, s42, v57
    v_pk_mul_f32 v[100:101], v[100:101], v[10:11] op_sel_hi:[1,0]
    v_pk_mul_f32 v[102:103], v[102:103], v[10:11] op_sel_hi:[1,0]
    v_cvt_pk_bf16_f32 v104, v100, v101
    v_cvt_pk_bf16_f32 v105, v102, v103
    v_cvt_pk_bf16_f32 v106, v24, v25
    v_cvt_pk_bf16_f32 v107, v26, v27
    v_lshlrev_b32 v100, 16, v104
    v_and_b32 v101, s42, v104
    v_lshlrev_b32 v102, 16, v105
    v_and_b32 v103, s42, v105
    v_lshlrev_b32 v24, 16, v106
    v_and_b32 v25, s42, v106
    v_lshlrev_b32 v26, 16, v107
    v_and_b32 v27, s42, v107
    v_pk_add_f32 v[24:25], v[24:25], v[100:101]
    v_pk_add_f32 v[26:27], v[26:27], v[102:103]
    v_cvt_pk_bf16_f32 v104, v24, v25
    v_cvt_pk_bf16_f32 v105, v26, v27
    v_lshlrev_b32 v100, 16, v104
    v_and_b32 v101, s42, v104
    v_lshlrev_b32 v102, 16, v105
    v_and_b32 v103, s42, v105
    v_lshlrev_b32 v24, 16, v66
    v_and_b32 v25, s42, v66
    v_lshlrev_b32 v26, 16, v67
    v_and_b32 v27, s42, v67
    v_pk_add_f32 v[24:25], v[24:25], v[100:101]
    v_pk_add_f32 v[26:27], v[26:27], v[102:103]
    v_cvt_pk_bf16_f32 v114, v24, v25
    v_cvt_pk_bf16_f32 v115, v26, v27
    s_nop 1
    v_permlane16_swap_b32 v112, v114
    v_permlane16_swap_b32 v113, v115
    buffer_store_dwordx4 v[112:115], v80, s[8:11], s57 offen offset:512 sc1
    s_waitcnt lgkmcnt(0)
    v_pk_add_f32 v[28:29], v[28:29], v[32:33]
    v_pk_add_f32 v[36:37], v[36:37], v[40:41]
    v_pk_add_f32 v[30:31], v[30:31], v[34:35]
    v_pk_add_f32 v[38:39], v[38:39], v[42:43]
    v_pk_add_f32 v[28:29], v[28:29], v[36:37]
    v_pk_add_f32 v[30:31], v[30:31], v[38:39]
    v_lshlrev_b32 v100, 16, v58
    v_and_b32 v101, s42, v58
    v_lshlrev_b32 v102, 16, v59
    v_and_b32 v103, s42, v59
    v_pk_mul_f32 v[100:101], v[100:101], v[84:85] op_sel_hi:[1,0]
    v_pk_mul_f32 v[102:103], v[102:103], v[84:85] op_sel_hi:[1,0]
    v_cvt_pk_bf16_f32 v104, v100, v101
    v_cvt_pk_bf16_f32 v105, v102, v103
    v_cvt_pk_bf16_f32 v106, v28, v29
    v_cvt_pk_bf16_f32 v107, v30, v31
    v_lshlrev_b32 v100, 16, v104
    v_and_b32 v101, s42, v104
    v_lshlrev_b32 v102, 16, v105
    v_and_b32 v103, s42, v105
    v_lshlrev_b32 v28, 16, v106
    v_and_b32 v29, s42, v106
    v_lshlrev_b32 v30, 16, v107
    v_and_b32 v31, s42, v107
    v_pk_add_f32 v[28:29], v[28:29], v[100:101]
    v_pk_add_f32 v[30:31], v[30:31], v[102:103]
    v_cvt_pk_bf16_f32 v104, v28, v29
    v_cvt_pk_bf16_f32 v105, v30, v31
    v_lshlrev_b32 v100, 16, v104
    v_and_b32 v101, s42, v104
    v_lshlrev_b32 v102, 16, v105
    v_and_b32 v103, s42, v105
    v_lshlrev_b32 v28, 16, v68
    v_and_b32 v29, s42, v68
    v_lshlrev_b32 v30, 16, v69
    v_and_b32 v31, s42, v69
    v_pk_add_f32 v[28:29], v[28:29], v[100:101]
    v_pk_add_f32 v[30:31], v[30:31], v[102:103]
    v_cvt_pk_bf16_f32 v32, v28, v29
    v_cvt_pk_bf16_f32 v33, v30, v31
    buffer_store_dwordx2 v[32:33], v81, s[8:11], s58 offen sc1
    s_lshl_b32 s30, s16, 9
    s_lshl_b32 s31, s17, 9
    s_mul_i32 s29, s3, 20480
    v_mov_b32 v124, 0x3f803f80
    v_mov_b32 v125, 0x3f803f80
    v_mov_b32 v126, 0x3f803f80
    v_mov_b32 v127, 0x3f803f80
    v_mov_b32 v62, 0xbdd2d3e8
    v_mov_b32 v63, 0xbdd2d3e8
    v_mov_b32 v64, 0xc0135761
    v_mov_b32 v65, 0xc0135761
    v_add_u32 v27, 98304, v6
    v_lshrrev_b32 v128, 3, v1
    s_lshl_b32 s59, s3, 3
    v_add_u32 v128, s59, v128
    v_lshlrev_b32 v8, 12, v128
    v_bfe_u32 v128, v1, 4, 1
    s_and_b32 s59, s3, 1
    s_lshl_b32 s59, s59, 1
    v_or_b32 v128, s59, v128
    v_lshlrev_b32 v128, 1, v128
    v_and_b32 v129, 7, v1
    v_xor_b32 v128, v128, v129
    v_lshl_add_u32 v8, v128, 4, v8
    s_lshl_b32 s52, s5, 10
    s_lshl_b32 s59, s4, 7
    s_add_u32 s52, s52, s59
    v_bfe_u32 v128, v1, 2, 2
    v_lshlrev_b32 v129, 3, v5
    v_add_u32 v129, v129, v128
    v_lshlrev_b32 v129, 7, v129
    v_and_b32 v130, 3, v1
    v_lshl_add_u32 v129, v130, 3, v129
    v_lshrrev_b32 v128, 1, v128
    v_and_b32 v130, 1, v5
    v_lshl_or_b32 v128, v130, 1, v128
    s_add_u32 s59, s3, 0
    s_and_b32 s59, s59, 3
    v_xor_b32 v130, s59, v128
    v_lshl_add_u32 v12, v130, 5, v129
    v_add_u32 v16, 0x10000, v12
    s_add_u32 s59, s3, 1
    s_and_b32 s59, s59, 3
    v_xor_b32 v130, s59, v128
    v_lshl_add_u32 v13, v130, 5, v129
    v_add_u32 v17, 0x10000, v13
    s_add_u32 s59, s3, 2
    s_and_b32 s59, s59, 3
    v_xor_b32 v130, s59, v128
    v_lshl_add_u32 v14, v130, 5, v129
    v_add_u32 v18, 0x10000, v14
    s_add_u32 s59, s3, 3
    s_and_b32 s59, s59, 3
    v_xor_b32 v130, s59, v128
    v_lshl_add_u32 v15, v130, 5, v129
    v_add_u32 v19, 0x10000, v15
    v_and_b32 v130, 1, v5
    s_add_u32 s61, s3, 0
    v_add_u32 v130, s61, v130
    v_and_b32 v130, 3, v130
    v_lshlrev_b32 v128, 2, v130
    v_lshrrev_b32 v129, 3, v4
    v_lshl_add_u32 v128, v129, 1, v128
    s_lshl_b32 s59, s4, 4
    s_lshr_b32 s60, s5, 1
    s_add_u32 s59, s59, s60
    v_add_u32 v128, s59, v128
    v_mul_u32_u24 v20, 20480, v128
    v_and_b32 v128, 7, v4
    s_and_b32 s59, s5, 1
    s_lshl_b32 s59, s59, 3
    v_add_u32 v128, s59, v128
    v_lshl_add_u32 v20, v128, 4, v20
    v_lshrrev_b32 v128, 1, v5
    v_lshl_add_u32 v20, v128, 8, v20
    v_and_b32 v130, 1, v5
    s_add_u32 s61, s3, 2
    v_add_u32 v130, s61, v130
    v_and_b32 v130, 3, v130
    v_lshlrev_b32 v128, 2, v130
    v_lshrrev_b32 v129, 3, v4
    v_lshl_add_u32 v128, v129, 1, v128
    s_lshl_b32 s59, s4, 4
    s_lshr_b32 s60, s5, 1
    s_add_u32 s59, s59, s60
    v_add_u32 v128, s59, v128
    v_mul_u32_u24 v21, 20480, v128
    v_and_b32 v128, 7, v4
    s_and_b32 s59, s5, 1
    s_lshl_b32 s59, s59, 3
    v_add_u32 v128, s59, v128
    v_lshl_add_u32 v21, v128, 4, v21
    v_lshrrev_b32 v128, 1, v5
    v_lshl_add_u32 v21, v128, 8, v21
    v_mov_b32 v130, s3
    v_lshlrev_b32 v128, 2, v130
    v_lshrrev_b32 v129, 3, v4
    v_lshl_add_u32 v128, v129, 1, v128
    s_lshl_b32 s59, s4, 4
    s_lshr_b32 s60, s5, 1
    s_add_u32 s59, s59, s60
    v_add_u32 v128, s59, v128
    v_mul_u32_u24 v23, 20480, v128
    v_lshlrev_b32 v24, 4, v128
    v_and_b32 v128, 7, v4
    s_and_b32 s59, s5, 1
    s_lshl_b32 s59, s59, 3
    v_add_u32 v128, s59, v128
    v_lshl_add_u32 v23, v128, 4, v23
    v_add_u32 v24, v24, v128
    v_lshrrev_b32 v128, 1, v5
    v_lshl_add_u32 v22, v128, 8, v23
    v_and_b32 v128, 1, v5
    v_lshl_add_u32 v22, v128, 3, v22
    v_lshlrev_b32 v24, 3, v24
    s_add_u32 s62, s19, 7942144
    buffer_load_dwordx4 a[64:67], v6, s[8:11], s62 offen offset:0
    buffer_load_dwordx4 a[68:71], v6, s[8:11], s62 offen offset:1024
    buffer_load_dwordx4 a[72:75], v6, s[8:11], s62 offen offset:2048
    buffer_load_dwordx4 a[76:79], v6, s[8:11], s62 offen offset:3072
    s_waitcnt vmcnt(4)
    s_barrier
    s_cmp_lg_u32 s3, 0
    s_cbranch_scc1 PUB_9
    s_and_b32 s60, s2, 7
    s_lshl_b32 s60, s60, 8
    s_add_u32 s60, s60, 34816
    v_mov_b32 v2, 0
    v_mov_b32 v7, 1
    s_mov_b64 exec, 1
    buffer_atomic_add v7, v2, s[8:11], s60 offen sc0 sc1
    s_mov_b64 exec, -1
    s_waitcnt vmcnt(0)
    v_readfirstlane_b32 s60, v7
    s_nop 3
    s_cmp_lg_u32 s60, 31
    s_cbranch_scc1 NOTLAST_10
    v_mov_b32 v3, 1
    s_mov_b32 s60, 36864
    v_and_b32 v2, 7, v1
    v_lshlrev_b32 v2, 8, v2
    s_mov_b64 exec, 0xff
    buffer_atomic_add v3, v2, s[8:11], s60 offen sc1
    s_mov_b64 exec, -1
NOTLAST_10:
PUB_9:
    s_add_u32 m0, s21, 98304
    s_add_u32 s61, s20, 7925760
    buffer_load_dwordx4 v6, s[8:11], s61 offen offset:0 lds
    v_mfma_f32_16x16x32_bf16 v[40:43], a[0:3], v[124:127], 0
    buffer_load_dwordx4 v6, s[8:11], s61 offen offset:1024 lds
    v_mfma_f32_16x16x32_bf16 v[40:43], a[4:7], v[124:127], v[40:43]
    buffer_load_dwordx4 v6, s[8:11], s61 offen offset:2048 lds
    v_mfma_f32_16x16x32_bf16 v[40:43], a[8:11], v[124:127], v[40:43]
    buffer_load_dwordx4 v6, s[8:11], s61 offen offset:3072 lds
    v_mfma_f32_16x16x32_bf16 v[40:43], a[12:15], v[124:127], v[40:43]
    s_add_u32 m0, s21, 102400
    s_add_u32 s61, s20, 7929856
    buffer_load_dwordx4 v6, s[8:11], s61 offen offset:0 lds
    v_mfma_f32_16x16x32_bf16 v[40:43], a[16:19], v[124:127], v[40:43]
    s_add_u32 s62, s19, 8744960
    buffer_load_dwordx4 a[80:83], v6, s[8:11], s62 offen offset:0
    v_mfma_f32_16x16x32_bf16 v[40:43], a[20:23], v[124:127], v[40:43]
    buffer_load_dwordx4 a[84:87], v6, s[8:11], s62 offen offset:1024
    v_mfma_f32_16x16x32_bf16 v[40:43], a[24:27], v[124:127], v[40:43]
    buffer_load_dwordx4 a[88:91], v6, s[8:11], s62 offen offset:2048
    v_mfma_f32_16x16x32_bf16 v[40:43], a[28:31], v[124:127], v[40:43]
    buffer_load_dwordx4 a[92:95], v6, s[8:11], s62 offen offset:3072
    v_mfma_f32_16x16x32_bf16 v[40:43], a[32:35], v[124:127], v[40:43]
    s_add_u32 s62, s19, 8749056
    buffer_load_dwordx4 a[96:99], v6, s[8:11], s62 offen offset:0
    v_mfma_f32_16x16x32_bf16 v[40:43], a[36:39], v[124:127], v[40:43]
    buffer_load_dwordx4 a[100:103], v6, s[8:11], s62 offen offset:1024
    v_mfma_f32_16x16x32_bf16 v[40:43], a[40:43], v[124:127], v[40:43]
    buffer_load_dwordx4 a[104:107], v6, s[8:11], s62 offen offset:2048
    v_mfma_f32_16x16x32_bf16 v[40:43], a[44:47], v[124:127], v[40:43]
    buffer_load_dwordx4 a[108:111], v6, s[8:11], s62 offen offset:3072
    v_mfma_f32_16x16x32_bf16 v[40:43], a[48:51], v[124:127], v[40:43]
    s_add_u32 s62, s19, 8753152
    buffer_load_dwordx4 a[112:115], v6, s[8:11], s62 offen offset:0
    v_mfma_f32_16x16x32_bf16 v[40:43], a[52:55], v[124:127], v[40:43]
    buffer_load_dwordx4 a[116:119], v6, s[8:11], s62 offen offset:1024
    v_mfma_f32_16x16x32_bf16 v[40:43], a[56:59], v[124:127], v[40:43]
    buffer_load_dwordx4 a[120:123], v6, s[8:11], s62 offen offset:2048
    v_mfma_f32_16x16x32_bf16 v[40:43], a[60:63], v[124:127], v[40:43]
    buffer_load_dwordx4 a[124:127], v6, s[8:11], s62 offen offset:3072
    s_add_u32 s62, s19, 8757248
    buffer_load_dwordx4 a[128:131], v6, s[8:11], s62 offen offset:0
    buffer_load_dwordx4 a[132:135], v6, s[8:11], s62 offen offset:1024
    buffer_load_dwordx4 a[136:139], v6, s[8:11], s62 offen offset:2048
    buffer_load_dwordx4 a[140:143], v6, s[8:11], s62 offen offset:3072
    s_add_u32 s62, s19, 8761344
    buffer_load_dwordx4 a[144:147], v6, s[8:11], s62 offen offset:0
    buffer_load_dwordx4 a[148:151], v6, s[8:11], s62 offen offset:1024
    buffer_load_dwordx4 a[152:155], v6, s[8:11], s62 offen offset:2048
    buffer_load_dwordx4 a[156:159], v6, s[8:11], s62 offen offset:3072
    s_add_u32 m0, s21, 118784
    s_add_u32 s61, s20, 8744960
    buffer_load_dwordx4 v6, s[8:11], s61 offen offset:0 lds
    buffer_load_dwordx4 v6, s[8:11], s61 offen offset:1024 lds
    buffer_load_dwordx4 v6, s[8:11], s61 offen offset:2048 lds
    buffer_load_dwordx4 v6, s[8:11], s61 offen offset:3072 lds
    s_add_u32 m0, s21, 122880
    s_add_u32 s61, s20, 8749056
    buffer_load_dwordx4 v6, s[8:11], s61 offen offset:0 lds
    s_waitcnt vmcnt(30)
    v_mfma_f32_16x16x32_bf16 v[40:43], a[64:67], v[124:127], v[40:43]
    v_mfma_f32_16x16x32_bf16 v[40:43], a[68:71], v[124:127], v[40:43]
    v_mfma_f32_16x16x32_bf16 v[40:43], a[72:75], v[124:127], v[40:43]
    v_mfma_f32_16x16x32_bf16 v[40:43], a[76:79], v[124:127], v[40:43]
    s_cmp_lg_u32 s3, 0
    s_cbranch_scc1 AW_11
    s_lshl_b32 s60, s4, 8
    s_add_u32 s60, s60, 36864
    v_mov_b32 v2, s60
    v_mov_b32 v3, 8
    s_mov_b32 s63, 20000
POLL_12:
    buffer_load_dword v7, v2, s[8:11], 0 offen sc1
    s_waitcnt vmcnt(0)
    v_cmp_ge_u32 vcc, v7, v3
    s_cmp_eq_u64 vcc, -1
    s_cbranch_scc1 POLLD_13
    s_sleep 2
    s_sub_u32 s63, s63, 1
    s_cmp_lg_u32 s63, 0
    s_cbranch_scc1 POLL_12
POLLD_13:
AW_11:
    s_waitcnt vmcnt(0)
    s_barrier
    s_add_u32 m0, s18, 0
    s_add_u32 s61, s52, 0x50f000
    buffer_load_dwordx4 v8, s[8:11], s61 offen sc1 lds
    s_add_u32 m0, s18, 4096
    s_add_u32 s61, s52, 0x52f000
    buffer_load_dwordx4 v8, s[8:11], s61 offen sc1 lds
    s_add_u32 m0, s18, 8192
    s_add_u32 s61, s52, 0x54f000
    buffer_load_dwordx4 v8, s[8:11], s61 offen sc1 lds
    s_add_u32 m0, s18, 12288
    s_add_u32 s61, s52, 0x56f000
    buffer_load_dwordx4 v8, s[8:11], s61 offen sc1 lds
    s_add_u32 m0, s18, 16384
    s_add_u32 s61, s52, 0x58f000
    buffer_load_dwordx4 v8, s[8:11], s61 offen sc1 lds
    s_add_u32 m0, s18, 20480
    s_add_u32 s61, s52, 0x5af000
    buffer_load_dwordx4 v8, s[8:11], s61 offen sc1 lds
    s_add_u32 m0, s18, 24576
    s_add_u32 s61, s52, 0x5cf000
    buffer_load_dwordx4 v8, s[8:11], s61 offen sc1 lds
    s_add_u32 m0, s18, 28672
    s_add_u32 s61, s52, 0x5ef000
    buffer_load_dwordx4 v8, s[8:11], s61 offen sc1 lds
    s_add_u32 m0, s18, 32768
    s_add_u32 s61, s52, 0x60f000
    buffer_load_dwordx4 v8, s[8:11], s61 offen sc1 lds
    s_add_u32 m0, s18, 36864
    s_add_u32 s61, s52, 0x62f000
    buffer_load_dwordx4 v8, s[8:11], s61 offen sc1 lds
    s_add_u32 m0, s18, 40960
    s_add_u32 s61, s52, 0x64f000
    buffer_load_dwordx4 v8, s[8:11], s61 offen sc1 lds
    s_add_u32 m0, s18, 45056
    s_add_u32 s61, s52, 0x66f000
    buffer_load_dwordx4 v8, s[8:11], s61 offen sc1 lds
    ds_read_b128 v[128:131], v27 offset:0
    ds_read_b128 v[132:135], v27 offset:1024
    ds_read_b128 v[136:139], v27 offset:2048
    ds_read_b128 v[140:143], v27 offset:3072
    ds_read_b128 v[144:147], v27 offset:4096
    ds_read_b128 v[148:151], v27 offset:5120
    s_waitcnt lgkmcnt(5)
    v_mfma_f32_16x16x32_bf16 v[44:47], v[128:131], v[124:127], 0
    ds_read_b128 v[152:155], v27 offset:6144
    s_waitcnt lgkmcnt(5)
    v_mfma_f32_16x16x32_bf16 v[44:47], v[132:135], v[124:127], v[44:47]
    ds_read_b128 v[156:159], v27 offset:7168
    s_waitcnt lgkmcnt(5)
    v_mfma_f32_16x16x32_bf16 v[44:47], v[136:139], v[124:127], v[44:47]
    ds_read_b128 v[128:131], v27 offset:8192
    s_waitcnt lgkmcnt(5)
    v_mfma_f32_16x16x32_bf16 v[44:47], v[140:143], v[124:127], v[44:47]
    ds_read_b128 v[132:135], v27 offset:9216
    s_waitcnt lgkmcnt(5)
    v_mfma_f32_16x16x32_bf16 v[44:47], v[144:147], v[124:127], v[44:47]
    ds_read_b128 v[136:139], v27 offset:10240
    s_waitcnt lgkmcnt(5)
    v_mfma_f32_16x16x32_bf16 v[44:47], v[148:151], v[124:127], v[44:47]
    ds_read_b128 v[140:143], v27 offset:11264
    s_waitcnt lgkmcnt(5)
    v_mfma_f32_16x16x32_bf16 v[44:47], v[152:155], v[124:127], v[44:47]
    ds_read_b128 v[144:147], v27 offset:12288
    s_waitcnt lgkmcnt(5)
    v_mfma_f32_16x16x32_bf16 v[44:47], v[156:159], v[124:127], v[44:47]
    ds_read_b128 v[148:151], v27 offset:13312
    s_waitcnt lgkmcnt(5)
    v_mfma_f32_16x16x32_bf16 v[44:47], v[128:131], v[124:127], v[44:47]
    ds_read_b128 v[152:155], v27 offset:14336
    s_waitcnt lgkmcnt(5)
    v_mfma_f32_16x16x32_bf16 v[44:47], v[132:135], v[124:127], v[44:47]
    ds_read_b128 v[156:159], v27 offset:15360
    s_waitcnt lgkmcnt(5)
    v_mfma_f32_16x16x32_bf16 v[44:47], v[136:139], v[124:127], v[44:47]
    ds_read_b128 v[128:131], v27 offset:16384
    s_waitcnt lgkmcnt(5)
    v_mfma_f32_16x16x32_bf16 v[44:47], v[140:143], v[124:127], v[44:47]
    ds_read_b128 v[132:135], v27 offset:17408
    s_waitcnt lgkmcnt(5)
    v_mfma_f32_16x16x32_bf16 v[44:47], v[144:147], v[124:127], v[44:47]
    ds_read_b128 v[136:139], v27 offset:18432
    s_waitcnt lgkmcnt(5)
    v_mfma_f32_16x16x32_bf16 v[44:47], v[148:151], v[124:127], v[44:47]
    ds_read_b128 v[140:143], v27 offset:19456
    s_waitcnt lgkmcnt(5)
    v_mfma_f32_16x16x32_bf16 v[44:47], v[152:155], v[124:127], v[44:47]
    s_waitcnt lgkmcnt(4)
    v_mfma_f32_16x16x32_bf16 v[44:47], v[156:159], v[124:127], v[44:47]
    s_waitcnt lgkmcnt(3)
    v_mfma_f32_16x16x32_bf16 v[44:47], v[128:131], v[124:127], v[44:47]
    s_waitcnt lgkmcnt(2)
    v_mfma_f32_16x16x32_bf16 v[44:47], v[132:135], v[124:127], v[44:47]
    s_waitcnt lgkmcnt(1)
    v_mfma_f32_16x16x32_bf16 v[44:47], v[136:139], v[124:127], v[44:47]
    s_waitcnt lgkmcnt(0)
    v_mfma_f32_16x16x32_bf16 v[44:47], v[140:143], v[124:127], v[44:47]
    s_waitcnt vmcnt(10)
    s_barrier
    ds_read_b64_tr_b16 v[128:129], v12 offset:0
    ds_read_b64_tr_b16 v[130:131], v12 offset:512
    ds_read_b64_tr_b16 v[132:133], v13 offset:0
    ds_read_b64_tr_b16 v[134:135], v13 offset:512
    ds_read_b64_tr_b16 v[136:137], v14 offset:0
    ds_read_b64_tr_b16 v[138:139], v14 offset:512
    ds_read_b64_tr_b16 v[140:141], v15 offset:0
    ds_read_b64_tr_b16 v[142:143], v15 offset:512
    ds_read_b128 v[144:147], v27 offset:0
    ds_read_b64_tr_b16 v[148:149], v12 offset:4096
    ds_read_b64_tr_b16 v[150:151], v12 offset:4608
    ds_read_b64_tr_b16 v[152:153], v13 offset:4096
    ds_read_b64_tr_b16 v[154:155], v13 offset:4608
    ds_read_b64_tr_b16 v[156:157], v14 offset:4096
    ds_read_b64_tr_b16 v[158:159], v14 offset:4608
    ds_read_b64_tr_b16 v[160:161], v15 offset:4096
    ds_read_b64_tr_b16 v[162:163], v15 offset:4608
    ds_read_b128 v[164:167], v27 offset:1024
    s_waitcnt vmcnt(8)
    s_barrier
    s_waitcnt lgkmcnt(9)
    v_mfma_f32_16x16x32_bf16 v[68:71], a[0:3], v[128:131], 0
    ds_read_b64_tr_b16 v[168:169], v12 offset:8192
    ds_read_b64_tr_b16 v[170:171], v12 offset:8704
    v_mfma_f32_16x16x32_bf16 v[72:75], a[0:3], v[132:135], 0
    ds_read_b64_tr_b16 v[172:173], v13 offset:8192
    ds_read_b64_tr_b16 v[174:175], v13 offset:8704
    v_mfma_f32_16x16x32_bf16 v[76:79], a[0:3], v[136:139], 0
    ds_read_b64_tr_b16 v[176:177], v14 offset:8192
    ds_read_b64_tr_b16 v[178:179], v14 offset:8704
    v_mfma_f32_16x16x32_bf16 v[80:83], a[0:3], v[140:143], 0
    ds_read_b64_tr_b16 v[180:181], v15 offset:8192
    ds_read_b64_tr_b16 v[182:183], v15 offset:8704
    v_mfma_f32_16x16x32_bf16 v[84:87], v[144:147], v[128:131], 0
    ds_read_b128 v[184:187], v27 offset:2048
    s_add_u32 m0, s18, 49152
    v_mfma_f32_16x16x32_bf16 v[116:119], v[124:127], v[128:131], 0
    s_add_u32 s61, s52, 0x68f000
    buffer_load_dwordx4 v8, s[8:11], s61 offen sc1 lds
    v_mfma_f32_16x16x32_bf16 v[120:123], v[128:131], v[128:131], 0
    s_waitcnt lgkmcnt(9)
    v_mfma_f32_16x16x32_bf16 v[68:71], a[4:7], v[148:151], v[68:71]
    ds_read_b64_tr_b16 v[128:129], v12 offset:12288
    ds_read_b64_tr_b16 v[130:131], v12 offset:12800
    v_mfma_f32_16x16x32_bf16 v[72:75], a[4:7], v[152:155], v[72:75]
    ds_read_b64_tr_b16 v[132:133], v13 offset:12288
    ds_read_b64_tr_b16 v[134:135], v13 offset:12800
    v_mfma_f32_16x16x32_bf16 v[76:79], a[4:7], v[156:159], v[76:79]
    ds_read_b64_tr_b16 v[136:137], v14 offset:12288
    ds_read_b64_tr_b16 v[138:139], v14 offset:12800
    v_mfma_f32_16x16x32_bf16 v[80:83], a[4:7], v[160:163], v[80:83]
    ds_read_b64_tr_b16 v[140:141], v15 offset:12288
    ds_read_b64_tr_b16 v[142:143], v15 offset:12800
    v_mfma_f32_16x16x32_bf16 v[84:87], v[164:167], v[148:151], v[84:87]
    ds_read_b128 v[144:147], v27 offset:3072
    s_add_u32 m0, s18, 53248
    v_mfma_f32_16x16x32_bf16 v[116:119], v[124:127], v[148:151], v[116:119]
    s_add_u32 s61, s52, 0x6af000
    buffer_load_dwordx4 v8, s[8:11], s61 offen sc1 lds
    v_mfma_f32_16x16x32_bf16 v[120:123], v[148:151], v[148:151], v[120:123]
    s_waitcnt vmcnt(8)
    s_barrier
    s_waitcnt lgkmcnt(9)
    v_mfma_f32_16x16x32_bf16 v[68:71], a[8:11], v[168:171], v[68:71]
    ds_read_b64_tr_b16 v[148:149], v12 offset:16384
    ds_read_b64_tr_b16 v[150:151], v12 offset:16896
    v_mfma_f32_16x16x32_bf16 v[72:75], a[8:11], v[172:175], v[72:75]
    ds_read_b64_tr_b16 v[152:153], v13 offset:16384
    ds_read_b64_tr_b16 v[154:155], v13 offset:16896
    v_mfma_f32_16x16x32_bf16 v[76:79], a[8:11], v[176:179], v[76:79]
    ds_read_b64_tr_b16 v[156:157], v14 offset:16384
    ds_read_b64_tr_b16 v[158:159], v14 offset:16896
    v_mfma_f32_16x16x32_bf16 v[80:83], a[8:11], v[180:183], v[80:83]
    ds_read_b64_tr_b16 v[160:161], v15 offset:16384
    ds_read_b64_tr_b16 v[162:163], v15 offset:16896
    v_mfma_f32_16x16x32_bf16 v[84:87], v[184:187], v[168:171], v[84:87]
    ds_read_b128 v[164:167], v27 offset:4096
    s_add_u32 m0, s18, 57344
    v_mfma_f32_16x16x32_bf16 v[116:119], v[124:127], v[168:171], v[116:119]
    s_add_u32 s61, s52, 0x6cf000
    buffer_load_dwordx4 v8, s[8:11], s61 offen sc1 lds
    v_mfma_f32_16x16x32_bf16 v[120:123], v[168:171], v[168:171], v[120:123]
    s_waitcnt lgkmcnt(9)
    v_mfma_f32_16x16x32_bf16 v[68:71], a[12:15], v[128:131], v[68:71]
    ds_read_b64_tr_b16 v[168:169], v12 offset:20480
    ds_read_b64_tr_b16 v[170:171], v12 offset:20992
    v_mfma_f32_16x16x32_bf16 v[72:75], a[12:15], v[132:135], v[72:75]
    ds_read_b64_tr_b16 v[172:173], v13 offset:20480
    ds_read_b64_tr_b16 v[174:175], v13 offset:20992
    v_mfma_f32_16x16x32_bf16 v[76:79], a[12:15], v[136:139], v[76:79]
    ds_read_b64_tr_b16 v[176:177], v14 offset:20480
    ds_read_b64_tr_b16 v[178:179], v14 offset:20992
    v_mfma_f32_16x16x32_bf16 v[80:83], a[12:15], v[140:143], v[80:83]
    ds_read_b64_tr_b16 v[180:181], v15 offset:20480
    ds_read_b64_tr_b16 v[182:183], v15 offset:20992
    v_mfma_f32_16x16x32_bf16 v[84:87], v[144:147], v[128:131], v[84:87]
    ds_read_b128 v[184:187], v27 offset:5120
    s_add_u32 m0, s18, 61440
    v_mfma_f32_16x16x32_bf16 v[116:119], v[124:127], v[128:131], v[116:119]
    s_add_u32 s61, s52, 0x6ef000
    buffer_load_dwordx4 v8, s[8:11], s61 offen sc1 lds
    v_mfma_f32_16x16x32_bf16 v[120:123], v[128:131], v[128:131], v[120:123]
    s_waitcnt vmcnt(8)
    s_barrier
    s_waitcnt lgkmcnt(9)
    v_mfma_f32_16x16x32_bf16 v[68:71], a[16:19], v[148:151], v[68:71]
    ds_read_b64_tr_b16 v[128:129], v12 offset:24576
    ds_read_b64_tr_b16 v[130:131], v12 offset:25088
    v_mfma_f32_16x16x32_bf16 v[72:75], a[16:19], v[152:155], v[72:75]
    ds_read_b64_tr_b16 v[132:133], v13 offset:24576
    ds_read_b64_tr_b16 v[134:135], v13 offset:25088
    v_mfma_f32_16x16x32_bf16 v[76:79], a[16:19], v[156:159], v[76:79]
    ds_read_b64_tr_b16 v[136:137], v14 offset:24576
    ds_read_b64_tr_b16 v[138:139], v14 offset:25088
    v_mfma_f32_16x16x32_bf16 v[80:83], a[16:19], v[160:163], v[80:83]
    ds_read_b64_tr_b16 v[140:141], v15 offset:24576
    ds_read_b64_tr_b16 v[142:143], v15 offset:25088
    v_mfma_f32_16x16x32_bf16 v[84:87], v[164:167], v[148:151], v[84:87]
    ds_read_b128 v[144:147], v27 offset:6144
    s_add_u32 m0, s18, 65536
    v_mfma_f32_16x16x32_bf16 v[116:119], v[124:127], v[148:151], v[116:119]
    s_add_u32 s61, s52, 0x70f000
    buffer_load_dwordx4 v8, s[8:11], s61 offen sc1 lds
    v_mfma_f32_16x16x32_bf16 v[120:123], v[148:151], v[148:151], v[120:123]
    s_waitcnt lgkmcnt(9)
    v_mfma_f32_16x16x32_bf16 v[68:71], a[20:23], v[168:171], v[68:71]
    ds_read_b64_tr_b16 v[148:149], v12 offset:28672
    ds_read_b64_tr_b16 v[150:151], v12 offset:29184
    v_mfma_f32_16x16x32_bf16 v[72:75], a[20:23], v[172:175], v[72:75]
    ds_read_b64_tr_b16 v[152:153], v13 offset:28672
    ds_read_b64_tr_b16 v[154:155], v13 offset:29184
    v_mfma_f32_16x16x32_bf16 v[76:79], a[20:23], v[176:179], v[76:79]
    ds_read_b64_tr_b16 v[156:157], v14 offset:28672
    ds_read_b64_tr_b16 v[158:159], v14 offset:29184
    v_mfma_f32_16x16x32_bf16 v[80:83], a[20:23], v[180:183], v[80:83]
    ds_read_b64_tr_b16 v[160:161], v15 offset:28672
    ds_read_b64_tr_b16 v[162:163], v15 offset:29184
    v_mfma_f32_16x16x32_bf16 v[84:87], v[184:187], v[168:171], v[84:87]
    ds_read_b128 v[164:167], v27 offset:7168
    s_add_u32 m0, s18, 69632
    v_mfma_f32_16x16x32_bf16 v[116:119], v[124:127], v[168:171], v[116:119]
    s_add_u32 s61, s52, 0x72f000
    buffer_load_dwordx4 v8, s[8:11], s61 offen sc1 lds
    v_mfma_f32_16x16x32_bf16 v[120:123], v[168:171], v[168:171], v[120:123]
    s_waitcnt vmcnt(6)
    s_barrier
    s_waitcnt lgkmcnt(9)
    v_mfma_f32_16x16x32_bf16 v[68:71], a[24:27], v[128:131], v[68:71]
    ds_read_b64_tr_b16 v[168:169], v12 offset:32768
    ds_read_b64_tr_b16 v[170:171], v12 offset:33280
    v_mfma_f32_16x16x32_bf16 v[72:75], a[24:27], v[132:135], v[72:75]
    ds_read_b64_tr_b16 v[172:173], v13 offset:32768
    ds_read_b64_tr_b16 v[174:175], v13 offset:33280
    v_mfma_f32_16x16x32_bf16 v[76:79], a[24:27], v[136:139], v[76:79]
    ds_read_b64_tr_b16 v[176:177], v14 offset:32768
    ds_read_b64_tr_b16 v[178:179], v14 offset:33280
    v_mfma_f32_16x16x32_bf16 v[80:83], a[24:27], v[140:143], v[80:83]
    ds_read_b64_tr_b16 v[180:181], v15 offset:32768
    ds_read_b64_tr_b16 v[182:183], v15 offset:33280
    v_mfma_f32_16x16x32_bf16 v[84:87], v[144:147], v[128:131], v[84:87]
    ds_read_b128 v[184:187], v27 offset:8192
    s_add_u32 m0, s18, 73728
    v_mfma_f32_16x16x32_bf16 v[116:119], v[124:127], v[128:131], v[116:119]
    s_add_u32 s61, s52, 0x74f000
    buffer_load_dwordx4 v8, s[8:11], s61 offen sc1 lds
    v_mfma_f32_16x16x32_bf16 v[120:123], v[128:131], v[128:131], v[120:123]
    s_waitcnt lgkmcnt(9)
    v_mfma_f32_16x16x32_bf16 v[68:71], a[28:31], v[148:151], v[68:71]
    ds_read_b64_tr_b16 v[128:129], v12 offset:36864
    ds_read_b64_tr_b16 v[130:131], v12 offset:37376
    v_mfma_f32_16x16x32_bf16 v[72:75], a[28:31], v[152:155], v[72:75]
    ds_read_b64_tr_b16 v[132:133], v13 offset:36864
    ds_read_b64_tr_b16 v[134:135], v13 offset:37376
    v_mfma_f32_16x16x32_bf16 v[76:79], a[28:31], v[156:159], v[76:79]
    ds_read_b64_tr_b16 v[136:137], v14 offset:36864
    ds_read_b64_tr_b16 v[138:139], v14 offset:37376
    v_mfma_f32_16x16x32_bf16 v[80:83], a[28:31], v[160:163], v[80:83]
    ds_read_b64_tr_b16 v[140:141], v15 offset:36864
    ds_read_b64_tr_b16 v[142:143], v15 offset:37376
    v_mfma_f32_16x16x32_bf16 v[84:87], v[164:167], v[148:151], v[84:87]
    ds_read_b128 v[144:147], v27 offset:9216
    s_add_u32 m0, s18, 77824
    v_mfma_f32_16x16x32_bf16 v[116:119], v[124:127], v[148:151], v[116:119]
    s_add_u32 s61, s52, 0x76f000
    buffer_load_dwordx4 v8, s[8:11], s61 offen sc1 lds
    v_mfma_f32_16x16x32_bf16 v[120:123], v[148:151], v[148:151], v[120:123]
    s_waitcnt lgkmcnt(9)
    v_mfma_f32_16x16x32_bf16 v[68:71], a[32:35], v[168:171], v[68:71]
    ds_read_b64_tr_b16 v[148:149], v12 offset:40960
    ds_read_b64_tr_b16 v[150:151], v12 offset:41472
    v_mfma_f32_16x16x32_bf16 v[72:75], a[32:35], v[172:175], v[72:75]
    ds_read_b64_tr_b16 v[152:153], v13 offset:40960
    ds_read_b64_tr_b16 v[154:155], v13 offset:41472
    v_mfma_f32_16x16x32_bf16 v[76:79], a[32:35], v[176:179], v[76:79]
    ds_read_b64_tr_b16 v[156:157], v14 offset:40960
    ds_read_b64_tr_b16 v[158:159], v14 offset:41472
    v_mfma_f32_16x16x32_bf16 v[80:83], a[32:35], v[180:183], v[80:83]
    ds_read_b64_tr_b16 v[160:161], v15 offset:40960
    ds_read_b64_tr_b16 v[162:163], v15 offset:41472
    v_mfma_f32_16x16x32_bf16 v[84:87], v[184:187], v[168:171], v[84:87]
    ds_read_b128 v[164:167], v27 offset:10240
    s_add_u32 s62, s24, 9564160
    v_mfma_f32_16x16x32_bf16 v[116:119], v[124:127], v[168:171], v[116:119]
    buffer_load_dwordx4 a[160:163], v6, s[8:11], s62 offen offset:0
    v_mfma_f32_16x16x32_bf16 v[120:123], v[168:171], v[168:171], v[120:123]
    s_waitcnt lgkmcnt(9)
    v_mfma_f32_16x16x32_bf16 v[68:71], a[36:39], v[128:131], v[68:71]
    ds_read_b64_tr_b16 v[168:169], v12 offset:45056
    ds_read_b64_tr_b16 v[170:171], v12 offset:45568
    v_mfma_f32_16x16x32_bf16 v[72:75], a[36:39], v[132:135], v[72:75]
    ds_read_b64_tr_b16 v[172:173], v13 offset:45056
    ds_read_b64_tr_b16 v[174:175], v13 offset:45568
    v_mfma_f32_16x16x32_bf16 v[76:79], a[36:39], v[136:139], v[76:79]
    ds_read_b64_tr_b16 v[176:177], v14 offset:45056
    ds_read_b64_tr_b16 v[178:179], v14 offset:45568
    v_mfma_f32_16x16x32_bf16 v[80:83], a[36:39], v[140:143], v[80:83]
    ds_read_b64_tr_b16 v[180:181], v15 offset:45056
    ds_read_b64_tr_b16 v[182:183], v15 offset:45568
    v_mfma_f32_16x16x32_bf16 v[84:87], v[144:147], v[128:131], v[84:87]
    ds_read_b128 v[184:187], v27 offset:11264
    buffer_load_dwordx4 a[168:171], v6, s[8:11], s62 offen offset:1024
    v_mfma_f32_16x16x32_bf16 v[116:119], v[124:127], v[128:131], v[116:119]
    s_waitcnt vmcnt(6)
    s_barrier
    v_mfma_f32_16x16x32_bf16 v[120:123], v[128:131], v[128:131], v[120:123]
    s_waitcnt lgkmcnt(9)
    v_mfma_f32_16x16x32_bf16 v[68:71], a[40:43], v[148:151], v[68:71]
    ds_read_b64_tr_b16 v[128:129], v12 offset:49152
    ds_read_b64_tr_b16 v[130:131], v12 offset:49664
    v_mfma_f32_16x16x32_bf16 v[72:75], a[40:43], v[152:155], v[72:75]
    ds_read_b64_tr_b16 v[132:133], v13 offset:49152
    ds_read_b64_tr_b16 v[134:135], v13 offset:49664
    v_mfma_f32_16x16x32_bf16 v[76:79], a[40:43], v[156:159], v[76:79]
    ds_read_b64_tr_b16 v[136:137], v14 offset:49152
    ds_read_b64_tr_b16 v[138:139], v14 offset:49664
    v_mfma_f32_16x16x32_bf16 v[80:83], a[40:43], v[160:163], v[80:83]
    ds_read_b64_tr_b16 v[140:141], v15 offset:49152
    ds_read_b64_tr_b16 v[142:143], v15 offset:49664
    v_mfma_f32_16x16x32_bf16 v[84:87], v[164:167], v[148:151], v[84:87]
    ds_read_b128 v[144:147], v27 offset:12288
    buffer_load_dwordx4 a[176:179], v6, s[8:11], s62 offen offset:2048
    v_mfma_f32_16x16x32_bf16 v[116:119], v[124:127], v[148:151], v[116:119]
    v_mfma_f32_16x16x32_bf16 v[120:123], v[148:151], v[148:151], v[120:123]
    s_waitcnt lgkmcnt(9)
    v_mfma_f32_16x16x32_bf16 v[68:71], a[44:47], v[168:171], v[68:71]
    ds_read_b64_tr_b16 v[148:149], v12 offset:53248
    ds_read_b64_tr_b16 v[150:151], v12 offset:53760
    v_mfma_f32_16x16x32_bf16 v[72:75], a[44:47], v[172:175], v[72:75]
    ds_read_b64_tr_b16 v[152:153], v13 offset:53248
    ds_read_b64_tr_b16 v[154:155], v13 offset:53760
    v_mfma_f32_16x16x32_bf16 v[76:79], a[44:47], v[176:179], v[76:79]
    ds_read_b64_tr_b16 v[156:157], v14 offset:53248
    ds_read_b64_tr_b16 v[158:159], v14 offset:53760
    v_mfma_f32_16x16x32_bf16 v[80:83], a[44:47], v[180:183], v[80:83]
    ds_read_b64_tr_b16 v[160:161], v15 offset:53248
    ds_read_b64_tr_b16 v[162:163], v15 offset:53760
    v_mfma_f32_16x16x32_bf16 v[84:87], v[184:187], v[168:171], v[84:87]
    ds_read_b128 v[164:167], v27 offset:13312
    buffer_load_dwordx4 a[184:187], v6, s[8:11], s62 offen offset:3072
    v_mfma_f32_16x16x32_bf16 v[116:119], v[124:127], v[168:171], v[116:119]
    v_mfma_f32_16x16x32_bf16 v[120:123], v[168:171], v[168:171], v[120:123]
    s_waitcnt lgkmcnt(9)
    v_mfma_f32_16x16x32_bf16 v[68:71], a[48:51], v[128:131], v[68:71]
    ds_read_b64_tr_b16 v[168:169], v12 offset:57344
    ds_read_b64_tr_b16 v[170:171], v12 offset:57856
    v_mfma_f32_16x16x32_bf16 v[72:75], a[48:51], v[132:135], v[72:75]
    ds_read_b64_tr_b16 v[172:173], v13 offset:57344
    ds_read_b64_tr_b16 v[174:175], v13 offset:57856
    v_mfma_f32_16x16x32_bf16 v[76:79], a[48:51], v[136:139], v[76:79]
    ds_read_b64_tr_b16 v[176:177], v14 offset:57344
    ds_read_b64_tr_b16 v[178:179], v14 offset:57856
    v_mfma_f32_16x16x32_bf16 v[80:83], a[48:51], v[140:143], v[80:83]
    ds_read_b64_tr_b16 v[180:181], v15 offset:57344
    ds_read_b64_tr_b16 v[182:183], v15 offset:57856
    v_mfma_f32_16x16x32_bf16 v[84:87], v[144:147], v[128:131], v[84:87]
    ds_read_b128 v[184:187], v27 offset:14336
    s_add_u32 s62, s24, 9568256
    v_mfma_f32_16x16x32_bf16 v[116:119], v[124:127], v[128:131], v[116:119]
    buffer_load_dwordx4 a[192:195], v6, s[8:11], s62 offen offset:0
    v_mfma_f32_16x16x32_bf16 v[120:123], v[128:131], v[128:131], v[120:123]
    s_waitcnt lgkmcnt(9)
    v_mfma_f32_16x16x32_bf16 v[68:71], a[52:55], v[148:151], v[68:71]
    ds_read_b64_tr_b16 v[128:129], v12 offset:61440
    ds_read_b64_tr_b16 v[130:131], v12 offset:61952
    v_mfma_f32_16x16x32_bf16 v[72:75], a[52:55], v[152:155], v[72:75]
    ds_read_b64_tr_b16 v[132:133], v13 offset:61440
    ds_read_b64_tr_b16 v[134:135], v13 offset:61952
    v_mfma_f32_16x16x32_bf16 v[76:79], a[52:55], v[156:159], v[76:79]
    ds_read_b64_tr_b16 v[136:137], v14 offset:61440
    ds_read_b64_tr_b16 v[138:139], v14 offset:61952
    v_mfma_f32_16x16x32_bf16 v[80:83], a[52:55], v[160:163], v[80:83]
    ds_read_b64_tr_b16 v[140:141], v15 offset:61440
    ds_read_b64_tr_b16 v[142:143], v15 offset:61952
    v_mfma_f32_16x16x32_bf16 v[84:87], v[164:167], v[148:151], v[84:87]
    ds_read_b128 v[144:147], v27 offset:15360
    buffer_load_dwordx4 a[200:203], v6, s[8:11], s62 offen offset:1024
    v_mfma_f32_16x16x32_bf16 v[116:119], v[124:127], v[148:151], v[116:119]
    s_waitcnt vmcnt(6)
    s_barrier
    v_mfma_f32_16x16x32_bf16 v[120:123], v[148:151], v[148:151], v[120:123]
    s_waitcnt lgkmcnt(9)
    v_mfma_f32_16x16x32_bf16 v[68:71], a[56:59], v[168:171], v[68:71]
    ds_read_b64_tr_b16 v[148:149], v16 offset:0
    ds_read_b64_tr_b16 v[150:151], v16 offset:512
    v_mfma_f32_16x16x32_bf16 v[72:75], a[56:59], v[172:175], v[72:75]
    ds_read_b64_tr_b16 v[152:153], v17 offset:0
    ds_read_b64_tr_b16 v[154:155], v17 offset:512
    v_mfma_f32_16x16x32_bf16 v[76:79], a[56:59], v[176:179], v[76:79]
    ds_read_b64_tr_b16 v[156:157], v18 offset:0
    ds_read_b64_tr_b16 v[158:159], v18 offset:512
    v_mfma_f32_16x16x32_bf16 v[80:83], a[56:59], v[180:183], v[80:83]
    ds_read_b64_tr_b16 v[160:161], v19 offset:0
    ds_read_b64_tr_b16 v[162:163], v19 offset:512
    v_mfma_f32_16x16x32_bf16 v[84:87], v[184:187], v[168:171], v[84:87]
    ds_read_b128 v[164:167], v27 offset:16384
    buffer_load_dwordx4 a[208:211], v6, s[8:11], s62 offen offset:2048
    v_mfma_f32_16x16x32_bf16 v[116:119], v[124:127], v[168:171], v[116:119]
    v_mfma_f32_16x16x32_bf16 v[120:123], v[168:171], v[168:171], v[120:123]
    s_waitcnt lgkmcnt(9)
    v_mfma_f32_16x16x32_bf16 v[68:71], a[60:63], v[128:131], v[68:71]
    ds_read_b64_tr_b16 v[168:169], v16 offset:4096
    ds_read_b64_tr_b16 v[170:171], v16 offset:4608
    v_mfma_f32_16x16x32_bf16 v[72:75], a[60:63], v[132:135], v[72:75]
    ds_read_b64_tr_b16 v[172:173], v17 offset:4096
    ds_read_b64_tr_b16 v[174:175], v17 offset:4608
    v_mfma_f32_16x16x32_bf16 v[76:79], a[60:63], v[136:139], v[76:79]
    ds_read_b64_tr_b16 v[176:177], v18 offset:4096
    ds_read_b64_tr_b16 v[178:179], v18 offset:4608
    v_mfma_f32_16x16x32_bf16 v[80:83], a[60:63], v[140:143], v[80:83]
    ds_read_b64_tr_b16 v[180:181], v19 offset:4096
    ds_read_b64_tr_b16 v[182:183], v19 offset:4608
    v_mfma_f32_16x16x32_bf16 v[84:87], v[144:147], v[128:131], v[84:87]
    ds_read_b128 v[184:187], v27 offset:17408
    buffer_load_dwordx4 a[216:219], v6, s[8:11], s62 offen offset:3072
    v_mfma_f32_16x16x32_bf16 v[116:119], v[124:127], v[128:131], v[116:119]
    v_mfma_f32_16x16x32_bf16 v[120:123], v[128:131], v[128:131], v[120:123]
    s_waitcnt lgkmcnt(9)
    v_mfma_f32_16x16x32_bf16 v[68:71], a[64:67], v[148:151], v[68:71]
    ds_read_b64_tr_b16 v[128:129], v16 offset:8192
    ds_read_b64_tr_b16 v[130:131], v16 offset:8704
    v_mfma_f32_16x16x32_bf16 v[72:75], a[64:67], v[152:155], v[72:75]
    ds_read_b64_tr_b16 v[132:133], v17 offset:8192
    ds_read_b64_tr_b16 v[134:135], v17 offset:8704
    v_mfma_f32_16x16x32_bf16 v[76:79], a[64:67], v[156:159], v[76:79]
    ds_read_b64_tr_b16 v[136:137], v18 offset:8192
    ds_read_b64_tr_b16 v[138:139], v18 offset:8704
    v_mfma_f32_16x16x32_bf16 v[80:83], a[64:67], v[160:163], v[80:83]
    ds_read_b64_tr_b16 v[140:141], v19 offset:8192
    ds_read_b64_tr_b16 v[142:143], v19 offset:8704
    v_mfma_f32_16x16x32_bf16 v[84:87], v[164:167], v[148:151], v[84:87]
    ds_read_b128 v[144:147], v27 offset:18432
    s_add_u32 s62, s24, 9572352
    v_mfma_f32_16x16x32_bf16 v[116:119], v[124:127], v[148:151], v[116:119]
    buffer_load_dwordx4 a[224:227], v6, s[8:11], s62 offen offset:0
    v_mfma_f32_16x16x32_bf16 v[120:123], v[148:151], v[148:151], v[120:123]
    s_waitcnt lgkmcnt(9)
    v_mfma_f32_16x16x32_bf16 v[68:71], a[68:71], v[168:171], v[68:71]
    ds_read_b64_tr_b16 v[148:149], v16 offset:12288
    ds_read_b64_tr_b16 v[150:151], v16 offset:12800
    v_mfma_f32_16x16x32_bf16 v[72:75], a[68:71], v[172:175], v[72:75]
    ds_read_b64_tr_b16 v[152:153], v17 offset:12288
    ds_read_b64_tr_b16 v[154:155], v17 offset:12800
    v_mfma_f32_16x16x32_bf16 v[76:79], a[68:71], v[176:179], v[76:79]
    ds_read_b64_tr_b16 v[156:157], v18 offset:12288
    ds_read_b64_tr_b16 v[158:159], v18 offset:12800
    v_mfma_f32_16x16x32_bf16 v[80:83], a[68:71], v[180:183], v[80:83]
    ds_read_b64_tr_b16 v[160:161], v19 offset:12288
    ds_read_b64_tr_b16 v[162:163], v19 offset:12800
    v_mfma_f32_16x16x32_bf16 v[84:87], v[184:187], v[168:171], v[84:87]
    ds_read_b128 v[164:167], v27 offset:19456
    buffer_load_dwordx4 a[232:235], v6, s[8:11], s62 offen offset:1024
    v_mfma_f32_16x16x32_bf16 v[116:119], v[124:127], v[168:171], v[116:119]
    v_mfma_f32_16x16x32_bf16 v[120:123], v[168:171], v[168:171], v[120:123]
    s_waitcnt lgkmcnt(9)
    v_mfma_f32_16x16x32_bf16 v[68:71], a[72:75], v[128:131], v[68:71]
    v_mfma_f32_16x16x32_bf16 v[72:75], a[72:75], v[132:135], v[72:75]
    v_mfma_f32_16x16x32_bf16 v[76:79], a[72:75], v[136:139], v[76:79]
    v_mfma_f32_16x16x32_bf16 v[80:83], a[72:75], v[140:143], v[80:83]
    v_mfma_f32_16x16x32_bf16 v[84:87], v[144:147], v[128:131], v[84:87]
    buffer_load_dwordx4 a[240:243], v6, s[8:11], s62 offen offset:2048
    v_mfma_f32_16x16x32_bf16 v[116:119], v[124:127], v[128:131], v[116:119]
    v_mfma_f32_16x16x32_bf16 v[120:123], v[128:131], v[128:131], v[120:123]
    s_waitcnt lgkmcnt(0)
    v_mfma_f32_16x16x32_bf16 v[68:71], a[76:79], v[148:151], v[68:71]
    v_mfma_f32_16x16x32_bf16 v[72:75], a[76:79], v[152:155], v[72:75]
    v_mfma_f32_16x16x32_bf16 v[76:79], a[76:79], v[156:159], v[76:79]
    v_mfma_f32_16x16x32_bf16 v[80:83], a[76:79], v[160:163], v[80:83]
    v_mfma_f32_16x16x32_bf16 v[84:87], v[164:167], v[148:151], v[84:87]
    buffer_load_dwordx4 a[248:251], v6, s[8:11], s62 offen offset:3072
    v_mfma_f32_16x16x32_bf16 v[116:119], v[124:127], v[148:151], v[116:119]
    v_mfma_f32_16x16x32_bf16 v[120:123], v[148:151], v[148:151], v[120:123]
    s_add_u32 s62, s24, 9576448
    buffer_load_dwordx4 v[192:195], v6, s[8:11], s62 offen offset:0
    buffer_load_dwordx4 v[200:203], v6, s[8:11], s62 offen offset:1024
    s_lshl_b32 s59, s6, 12
    v_add_u32 v2, s59, v12
    v_add_u32 v3, s59, v16
    ds_read_b64_tr_b16 v[156:157], v2 offset:0
    ds_read_b64_tr_b16 v[158:159], v2 offset:512
    ds_read_b64_tr_b16 v[160:161], v2 offset:32768
    ds_read_b64_tr_b16 v[162:163], v2 offset:33280
    ds_read_b64_tr_b16 v[164:165], v3 offset:0
    ds_read_b64_tr_b16 v[166:167], v3 offset:512
    s_lshl_b32 s59, s3, 8
    s_add_u32 s59, s59, 81920
    v_lshl_add_u32 v3, v4, 4, s59
    s_mov_b32 s60, 0xf5f000
    s_cmp_lg_u32 s6, 0
    s_cselect_b32 s60, 0x7ff00000, s60
    v_and_b32 v134, 3, v4
    v_cmp_eq_u32 vcc, 1, v134
    s_mov_b32 s46, 0x3acccccd
    s_nop 0
    v_cndmask_b32 v133, v120, v121, vcc
    v_cmp_eq_u32 vcc, 2, v134
    v_mul_f32 v132, s46, v116
    s_nop 0
    v_cndmask_b32 v133, v133, v122, vcc
    v_cmp_eq_u32 vcc, 3, v134
    v_lshrrev_b32 v135, 2, v4
    s_nop 0
    v_cndmask_b32 v133, v133, v123, vcc
    v_mul_f32 v133, s46, v133
    v_fma_f32 v133, -v132, v132, v133
    v_max_f32 v133, 0, v133
    v_mov_b32 v130, v132
    v_mov_b32 v131, v133
    v_cvt_pk_bf16_f32 v134, v130, v131
    v_lshlrev_b32 v130, 16, v134
    v_and_b32 v131, s42, v134
    v_add_f32 v131, 0x3727c5ac, v131
    v_cvt_pk_bf16_f32 v131, v131, v131
    v_and_b32 v131, s42, v131
    v_sqrt_f32 v131, v131
    s_nop 0
    v_cvt_pk_bf16_f32 v131, v131, v131
    v_and_b32 v131, s42, v131
    v_rcp_f32 v131, v131
    v_cmp_eq_u32 vcc, v135, v5
    v_sub_f32 v128, v132, v130
    v_mul_f32 v128, v128, v131
    v_mul_f32 v129, v133, v131
    v_mul_f32 v129, v129, v131
    v_cvt_pk_bf16_f32 v134, v128, v129
    v_lshlrev_b32 v128, 16, v134
    v_and_b32 v129, s42, v134
    v_add_f32 v129, 0x3727c5ac, v129
    v_cvt_pk_bf16_f32 v129, v129, v129
    v_and_b32 v129, s42, v129
    v_sqrt_f32 v129, v129
    s_nop 0
    v_cvt_pk_bf16_f32 v129, v129, v129
    v_and_b32 v129, s42, v129
    v_rcp_f32 v134, v129
    s_nop 0
    v_mul_f32 v129, v128, v134
    v_mul_f32 v128, v131, v134
    v_fma_f32 v129, v130, v128, v129
    s_and_saveexec_b64 s[44:45], vcc
    ds_write_b128 v3, v[128:131]
    buffer_store_dwordx2 v[130:131], v24, s[8:11], s60 offen sc1
    s_mov_b64 exec, s[44:45]
    v_lshl_add_u32 v25, v5, 8, v23
    s_lshl_b32 s53, s6, 10
    s_add_u32 s53, s53, 0xcdf000
    s_add_u32 s54, s53, 8192
    s_add_u32 s55, s53, 16384
    s_cmp_ge_u32 s6, 4
    s_cselect_b32 s55, 0x7ff00000, s55
    s_waitcnt lgkmcnt(0)
    buffer_store_dwordx4 v[156:159], v25, s[8:11], s53 offen sc1
    buffer_store_dwordx4 v[160:163], v25, s[8:11], s54 offen sc1
    buffer_store_dwordx4 v[164:167], v25, s[8:11], s55 offen sc1
    s_barrier
    s_add_u32 s59, s3, 0
    s_and_b32 s59, s59, 3
    s_mul_i32 s59, s59, 256
    s_add_u32 s59, s59, 81920
    v_lshl_add_u32 v2, v4, 4, s59
    ds_read_b64 v[116:117], v2
    s_add_u32 s59, s3, 1
    s_and_b32 s59, s59, 3
    s_mul_i32 s59, s59, 256
    s_add_u32 s59, s59, 81920
    v_lshl_add_u32 v2, v4, 4, s59
    ds_read_b64 v[118:119], v2
    s_add_u32 s59, s3, 2
    s_and_b32 s59, s59, 3
    s_mul_i32 s59, s59, 256
    s_add_u32 s59, s59, 81920
    v_lshl_add_u32 v2, v4, 4, s59
    ds_read_b64 v[120:121], v2
    s_add_u32 s59, s3, 3
    s_and_b32 s59, s59, 3
    s_mul_i32 s59, s59, 256
    s_add_u32 s59, s59, 81920
    v_lshl_add_u32 v2, v4, 4, s59
    ds_read_b64 v[122:123], v2
    buffer_load_dwordx4 v[208:211], v6, s[8:11], s62 offen offset:2048
    buffer_load_dwordx4 v[216:219], v6, s[8:11], s62 offen offset:3072
    s_add_u32 s57, s30, 0xf63000
    s_add_u32 s58, s31, 0xf63000
    s_waitcnt lgkmcnt(0)
    v_pk_mul_f32 v[128:129], v[40:41], v[116:117] op_sel:[0,1] op_sel_hi:[1,1]
    v_pk_mul_f32 v[130:131], v[42:43], v[116:117] op_sel:[0,1] op_sel_hi:[1,1]
    v_pk_fma_f32 v[68:69], v[68:69], v[116:117], v[128:129] op_sel_hi:[1,0,1] neg_lo:[0,0,1] neg_hi:[0,0,1]
    v_pk_fma_f32 v[70:71], v[70:71], v[116:117], v[130:131] op_sel_hi:[1,0,1] neg_lo:[0,0,1] neg_hi:[0,0,1]
    v_pk_mul_f32 v[128:129], v[68:69], v[68:69]
    v_pk_mul_f32 v[130:131], v[70:71], v[70:71]
    v_pk_fma_f32 v[128:129], v[128:129], v[62:63], v[64:65]
    v_pk_fma_f32 v[130:131], v[130:131], v[62:63], v[64:65]
    v_pk_mul_f32 v[128:129], v[128:129], v[68:69]
    v_pk_mul_f32 v[130:131], v[130:131], v[70:71]
    v_exp_f32 v128, v128
    v_exp_f32 v129, v129
    v_exp_f32 v130, v130
    v_exp_f32 v131, v131
    s_nop 0
    v_pk_add_f32 v[128:129], v[128:129], 1.0 op_sel_hi:[1,0]
    v_pk_add_f32 v[130:131], v[130:131], 1.0 op_sel_hi:[1,0]
    v_rcp_f32 v128, v128
    v_rcp_f32 v129, v129
    v_rcp_f32 v130, v130
    v_rcp_f32 v131, v131
    s_nop 0
    v_pk_mul_f32 v[68:69], v[68:69], v[128:129]
    v_pk_mul_f32 v[70:71], v[70:71], v[130:131]
    v_cvt_pk_bf16_f32 v144, v68, v69
    v_cvt_pk_bf16_f32 v145, v70, v71
    s_add_u32 s62, s24, 9580544
    buffer_load_dwordx4 v[224:227], v6, s[8:11], s62 offen offset:0
    v_pk_mul_f32 v[128:129], v[40:41], v[118:119] op_sel:[0,1] op_sel_hi:[1,1]
    v_pk_mul_f32 v[130:131], v[42:43], v[118:119] op_sel:[0,1] op_sel_hi:[1,1]
    v_pk_fma_f32 v[72:73], v[72:73], v[118:119], v[128:129] op_sel_hi:[1,0,1] neg_lo:[0,0,1] neg_hi:[0,0,1]
    v_pk_fma_f32 v[74:75], v[74:75], v[118:119], v[130:131] op_sel_hi:[1,0,1] neg_lo:[0,0,1] neg_hi:[0,0,1]
    v_pk_mul_f32 v[128:129], v[72:73], v[72:73]
    v_pk_mul_f32 v[130:131], v[74:75], v[74:75]
    v_pk_fma_f32 v[128:129], v[128:129], v[62:63], v[64:65]
    v_pk_fma_f32 v[130:131], v[130:131], v[62:63], v[64:65]
    v_pk_mul_f32 v[128:129], v[128:129], v[72:73]
    v_pk_mul_f32 v[130:131], v[130:131], v[74:75]
    v_exp_f32 v128, v128
    v_exp_f32 v129, v129
    v_exp_f32 v130, v130
    v_exp_f32 v131, v131
    s_nop 0
    v_pk_add_f32 v[128:129], v[128:129], 1.0 op_sel_hi:[1,0]
    v_pk_add_f32 v[130:131], v[130:131], 1.0 op_sel_hi:[1,0]
    v_rcp_f32 v128, v128
    v_rcp_f32 v129, v129
    v_rcp_f32 v130, v130
    v_rcp_f32 v131, v131
    s_nop 0
    v_pk_mul_f32 v[72:73], v[72:73], v[128:129]
    v_pk_mul_f32 v[74:75], v[74:75], v[130:131]
    v_cvt_pk_bf16_f32 v146, v72, v73
    v_cvt_pk_bf16_f32 v147, v74, v75
    buffer_load_dwordx4 v[232:235], v6, s[8:11], s62 offen offset:1024
    s_nop 1
    v_permlane16_swap_b32 v144, v146
    v_permlane16_swap_b32 v145, v147
    buffer_store_dwordx4 v[144:147], v20, s[8:11], s57 offen sc1
    v_pk_mul_f32 v[128:129], v[40:41], v[120:121] op_sel:[0,1] op_sel_hi:[1,1]
    v_pk_mul_f32 v[130:131], v[42:43], v[120:121] op_sel:[0,1] op_sel_hi:[1,1]
    v_pk_fma_f32 v[76:77], v[76:77], v[120:121], v[128:129] op_sel_hi:[1,0,1] neg_lo:[0,0,1] neg_hi:[0,0,1]
    v_pk_fma_f32 v[78:79], v[78:79], v[120:121], v[130:131] op_sel_hi:[1,0,1] neg_lo:[0,0,1] neg_hi:[0,0,1]
    v_pk_mul_f32 v[128:129], v[76:77], v[76:77]
    v_pk_mul_f32 v[130:131], v[78:79], v[78:79]
    v_pk_fma_f32 v[128:129], v[128:129], v[62:63], v[64:65]
    v_pk_fma_f32 v[130:131], v[130:131], v[62:63], v[64:65]
    v_pk_mul_f32 v[128:129], v[128:129], v[76:77]
    v_pk_mul_f32 v[130:131], v[130:131], v[78:79]
    v_exp_f32 v128, v128
    v_exp_f32 v129, v129
    v_exp_f32 v130, v130
    v_exp_f32 v131, v131
    s_nop 0
    v_pk_add_f32 v[128:129], v[128:129], 1.0 op_sel_hi:[1,0]
    v_pk_add_f32 v[130:131], v[130:131], 1.0 op_sel_hi:[1,0]
    v_rcp_f32 v128, v128
    v_rcp_f32 v129, v129
    v_rcp_f32 v130, v130
    v_rcp_f32 v131, v131
    s_nop 0
    v_pk_mul_f32 v[76:77], v[76:77], v[128:129]
    v_pk_mul_f32 v[78:79], v[78:79], v[130:131]
    v_cvt_pk_bf16_f32 v148, v76, v77
    v_cvt_pk_bf16_f32 v149, v78, v79
    buffer_load_dwordx4 v[240:243], v6, s[8:11], s62 offen offset:2048
    v_pk_mul_f32 v[128:129], v[40:41], v[122:123] op_sel:[0,1] op_sel_hi:[1,1]
    v_pk_mul_f32 v[130:131], v[42:43], v[122:123] op_sel:[0,1] op_sel_hi:[1,1]
    v_pk_fma_f32 v[80:81], v[80:81], v[122:123], v[128:129] op_sel_hi:[1,0,1] neg_lo:[0,0,1] neg_hi:[0,0,1]
    v_pk_fma_f32 v[82:83], v[82:83], v[122:123], v[130:131] op_sel_hi:[1,0,1] neg_lo:[0,0,1] neg_hi:[0,0,1]
    v_pk_mul_f32 v[128:129], v[80:81], v[80:81]
    v_pk_mul_f32 v[130:131], v[82:83], v[82:83]
    v_pk_fma_f32 v[128:129], v[128:129], v[62:63], v[64:65]
    v_pk_fma_f32 v[130:131], v[130:131], v[62:63], v[64:65]
    v_pk_mul_f32 v[128:129], v[128:129], v[80:81]
    v_pk_mul_f32 v[130:131], v[130:131], v[82:83]
    v_exp_f32 v128, v128
    v_exp_f32 v129, v129
    v_exp_f32 v130, v130
    v_exp_f32 v131, v131
    s_nop 0
    v_pk_add_f32 v[128:129], v[128:129], 1.0 op_sel_hi:[1,0]
    v_pk_add_f32 v[130:131], v[130:131], 1.0 op_sel_hi:[1,0]
    v_rcp_f32 v128, v128
    v_rcp_f32 v129, v129
    v_rcp_f32 v130, v130
    v_rcp_f32 v131, v131
    s_nop 0
    v_pk_mul_f32 v[80:81], v[80:81], v[128:129]
    v_pk_mul_f32 v[82:83], v[82:83], v[130:131]
    v_cvt_pk_bf16_f32 v150, v80, v81
    v_cvt_pk_bf16_f32 v151, v82, v83
    s_nop 1
    v_permlane16_swap_b32 v148, v150
    v_permlane16_swap_b32 v149, v151
    buffer_store_dwordx4 v[148:151], v21, s[8:11], s57 offen sc1
    v_pk_mul_f32 v[128:129], v[44:45], v[116:117] op_sel:[0,1] op_sel_hi:[1,1]
    v_pk_mul_f32 v[130:131], v[46:47], v[116:117] op_sel:[0,1] op_sel_hi:[1,1]
    v_pk_fma_f32 v[84:85], v[84:85], v[116:117], v[128:129] op_sel_hi:[1,0,1] neg_lo:[0,0,1] neg_hi:[0,0,1]
    v_pk_fma_f32 v[86:87], v[86:87], v[116:117], v[130:131] op_sel_hi:[1,0,1] neg_lo:[0,0,1] neg_hi:[0,0,1]
    v_pk_mul_f32 v[128:129], v[84:85], v[84:85]
    v_pk_mul_f32 v[130:131], v[86:87], v[86:87]
    v_pk_fma_f32 v[128:129], v[128:129], v[62:63], v[64:65]
    v_pk_fma_f32 v[130:131], v[130:131], v[62:63], v[64:65]
    v_pk_mul_f32 v[128:129], v[128:129], v[84:85]
    v_pk_mul_f32 v[130:131], v[130:131], v[86:87]
    v_exp_f32 v128, v128
    v_exp_f32 v129, v129
    v_exp_f32 v130, v130
    v_exp_f32 v131, v131
    s_nop 0
    v_pk_add_f32 v[128:129], v[128:129], 1.0 op_sel_hi:[1,0]
    v_pk_add_f32 v[130:131], v[130:131], 1.0 op_sel_hi:[1,0]
    v_rcp_f32 v128, v128
    v_rcp_f32 v129, v129
    v_rcp_f32 v130, v130
    v_rcp_f32 v131, v131
    s_nop 0
    v_pk_mul_f32 v[84:85], v[84:85], v[128:129]
    v_pk_mul_f32 v[86:87], v[86:87], v[130:131]
    v_cvt_pk_bf16_f32 v152, v84, v85
    v_cvt_pk_bf16_f32 v153, v86, v87
    buffer_store_dwordx2 v[152:153], v22, s[8:11], s58 offen sc1
    v_mov_b32 v68, v20
    v_mov_b32 v69, v21
    v_mov_b32 v70, v22
    v_mov_b32 v71, v25
    s_lshl_b32 s59, s7, 6
    s_lshl_b32 s60, s3, 4
    s_add_u32 s59, s59, s60
    v_add_u32 v128, s59, v4
    s_movk_i32 s60, 20480
    v_add_u32 v129, -1, v128
    v_ashrrev_i32 v130, 4, v129
    v_mul_lo_u32 v8, v130, s60
    v_and_b32 v129, 15, v129
    v_lshl_add_u32 v8, v129, 4, v8
    v_lshl_add_u32 v8, v5, 8, v8
    v_add_u32 v129, 1, v128
    v_ashrrev_i32 v130, 4, v129
    v_mul_lo_u32 v9, v130, s60
    v_and_b32 v129, 15, v129
    v_lshl_add_u32 v9, v129, 4, v9
    v_lshl_add_u32 v9, v5, 8, v9
    v_add_u32 v129, -2, v128
    v_ashrrev_i32 v130, 4, v129
    v_mul_lo_u32 v10, v130, s60
    v_and_b32 v129, 15, v129
    v_lshl_add_u32 v10, v129, 4, v10
    v_lshl_add_u32 v10, v5, 8, v10
    v_add_u32 v129, 2, v128
    v_ashrrev_i32 v130, 4, v129
    v_mul_lo_u32 v11, v130, s60
    v_and_b32 v129, 15, v129
    v_lshl_add_u32 v11, v129, 4, v11
    v_lshl_add_u32 v11, v5, 8, v11
    s_add_u32 s12, s40, 0xf63000
    s_addc_u32 s13, s41, 0
    s_mov_b32 s14, 0x280000
    s_mov_b32 s15, 0x00020000
    s_add_u32 s59, s3, 0
    s_and_b32 s59, s59, 3
    s_mul_i32 s59, s59, 20480
    v_add_u32 v12, s59, v6
    s_add_u32 s59, s3, 1
    s_and_b32 s59, s59, 3
    s_mul_i32 s59, s59, 20480
    v_add_u32 v13, s59, v6
    s_add_u32 s59, s3, 2
    s_and_b32 s59, s59, 3
    s_mul_i32 s59, s59, 20480
    v_add_u32 v14, s59, v6
    s_add_u32 s59, s3, 3
    s_and_b32 s59, s59, 3
    s_mul_i32 s59, s59, 20480
    v_add_u32 v15, s59, v6
    v_and_b32 v130, 1, v5
    s_add_u32 s61, s3, 0
    v_add_u32 v130, s61, v130
    v_and_b32 v130, 3, v130
    s_lshl_b32 s59, s7, 2
    v_add_u32 v128, s59, v130
    v_mul_u32_u24 v20, 20480, v128
    v_lshl_add_u32 v20, v4, 4, v20
    v_lshl_add_u32 v16, v128, 4, v4
    v_lshrrev_b32 v128, 1, v5
    v_lshl_add_u32 v20, v128, 8, v20
    v_and_b32 v130, 1, v5
    s_add_u32 s61, s3, 2
    v_add_u32 v130, s61, v130
    v_and_b32 v130, 3, v130
    s_lshl_b32 s59, s7, 2
    v_add_u32 v128, s59, v130
    v_mul_u32_u24 v21, 20480, v128
    v_lshl_add_u32 v21, v4, 4, v21
    v_lshl_add_u32 v17, v128, 4, v4
    v_lshrrev_b32 v128, 1, v5
    v_lshl_add_u32 v21, v128, 8, v21
    v_mov_b32 v130, s3
    s_lshl_b32 s59, s7, 2
    v_add_u32 v128, s59, v130
    v_mul_u32_u24 v23, 20480, v128
    v_lshl_add_u32 v23, v4, 4, v23
    v_lshl_add_u32 v18, v128, 4, v4
    v_lshrrev_b32 v128, 1, v5
    v_lshl_add_u32 v22, v128, 8, v23
    v_and_b32 v128, 1, v5
    v_lshl_add_u32 v22, v128, 3, v22
    buffer_load_dwordx4 v[248:251], v6, s[8:11], s62 offen offset:3072
    s_add_u32 s62, s24, 9584640
    buffer_load_dwordx4 a[164:167], v6, s[8:11], s62 offen offset:0
    buffer_load_dwordx4 a[172:175], v6, s[8:11], s62 offen offset:1024
    buffer_load_dwordx4 a[180:183], v6, s[8:11], s62 offen offset:2048
    s_waitcnt vmcnt(4)
    s_barrier
    s_cmp_lg_u32 s3, 0
    s_cbranch_scc1 PUB_14
    s_lshl_b32 s56, s7, 8
    s_add_u32 s56, s56, 39168
    v_mov_b32 v2, 0
    v_mov_b32 v3, 1
    s_mov_b64 exec, 1
    buffer_atomic_add v3, v2, s[8:11], s56 offen sc1
    s_mov_b64 exec, -1
PUB_14:
    buffer_load_dword v188, v68, s[8:11], s57 offen offset:0 sc1
    buffer_load_dword v189, v69, s[8:11], s57 offen offset:0 sc1
    buffer_load_dword v188, v70, s[8:11], s58 offen offset:0 sc1
    buffer_load_dwordx4 a[188:191], v6, s[8:11], s62 offen offset:3072
    s_add_u32 s62, s24, 9588736
    buffer_load_dwordx4 a[196:199], v6, s[8:11], s62 offen offset:0
    buffer_load_dwordx4 a[204:207], v6, s[8:11], s62 offen offset:1024
    buffer_load_dwordx4 a[212:215], v6, s[8:11], s62 offen offset:2048
    buffer_load_dwordx4 a[220:223], v6, s[8:11], s62 offen offset:3072
    s_cmp_lg_u32 s3, 0
    s_cbranch_scc1 AW_15
    v_and_b32 v7, 7, v1
    v_min_u32 v7, 5, v7
    s_lshl_b32 s59, s4, 2
    s_add_u32 s59, s59, 152
    v_add_u32 v2, s59, v7
    v_lshlrev_b32 v2, 8, v2
    s_cmp_eq_u32 s7, 0
    s_cselect_b32 s59, 0, 8
    s_cmp_eq_u32 s5, 0
    s_cselect_b32 s59, s59, 0
    s_cmp_eq_u32 s7, 31
    s_cselect_b32 s60, 0, 8
    s_cmp_eq_u32 s5, 3
    s_cselect_b32 s60, s60, 0
    v_mov_b32 v3, 8
    v_cmp_eq_u32 vcc, 0, v7
    v_mov_b32 v128, s59
    v_mov_b32 v129, s60
    v_cndmask_b32 v3, v3, v128, vcc
    v_cmp_eq_u32 vcc, 5, v7
    s_nop 1
    v_cndmask_b32 v3, v3, v129, vcc
    v_cmp_eq_u32 vcc, 0, v3
    v_add_u32 v128, 256, v2
    v_subrev_u32 v129, 256, v2
    v_cmp_eq_u32 s[44:45], 0, v7
    s_nop 1
    v_cndmask_b32 v128, v129, v128, s[44:45]
    v_cndmask_b32 v2, v2, v128, vcc
    s_mov_b32 s63, 20000
POLL_16:
    buffer_load_dword v7, v2, s[8:11], 0 offen sc1
    s_waitcnt vmcnt(0)
    v_cmp_ge_u32 vcc, v7, v3
    s_cmp_eq_u64 vcc, -1
    s_cbranch_scc1 POLLD_17
    s_sleep 2
    s_sub_u32 s63, s63, 1
    s_cmp_lg_u32 s63, 0
    s_cbranch_scc1 POLL_16
POLLD_17:
AW_15:
    s_waitcnt vmcnt(0)
    s_barrier
    s_add_u32 m0, s29, 0
    s_mov_b32 s61, 0x0
    buffer_load_dwordx4 v8, s[12:15], s61 offen offset:0 sc1 lds
    buffer_load_dwordx4 v8, s[12:15], s61 offen offset:1024 sc1 lds
    buffer_load_dwordx4 v8, s[12:15], s61 offen offset:2048 sc1 lds
    buffer_load_dwordx4 v8, s[12:15], s61 offen offset:3072 sc1 lds
    s_add_u32 m0, s29, 4096
    s_mov_b32 s61, 0x1000
    buffer_load_dwordx4 v8, s[12:15], s61 offen offset:0 sc1 lds
    s_add_u32 m0, s29, 5120
    s_mov_b32 s61, 0x1400
    buffer_load_dwordx4 v9, s[12:15], s61 offen offset:0 sc1 lds
    buffer_load_dwordx4 v9, s[12:15], s61 offen offset:1024 sc1 lds
    buffer_load_dwordx4 v9, s[12:15], s61 offen offset:2048 sc1 lds
    buffer_load_dwordx4 v9, s[12:15], s61 offen offset:3072 sc1 lds
    s_add_u32 m0, s29, 9216
    s_mov_b32 s61, 0x2400
    buffer_load_dwordx4 v9, s[12:15], s61 offen offset:0 sc1 lds
    s_waitcnt vmcnt(8)
    s_barrier
    ds_read_b128 v[128:131], v12 offset:0
    ds_read_b128 v[132:135], v13 offset:0
    ds_read_b128 v[136:139], v14 offset:0
    ds_read_b128 v[140:143], v15 offset:0
    ds_read_b128 v[144:147], v27 offset:20480
    ds_read_b128 v[148:151], v12 offset:1024
    ds_read_b128 v[152:155], v13 offset:1024
    ds_read_b128 v[156:159], v14 offset:1024
    ds_read_b128 v[160:163], v15 offset:1024
    ds_read_b128 v[164:167], v27 offset:21504
    s_waitcnt vmcnt(6)
    s_barrier
    s_waitcnt lgkmcnt(5)
    v_mfma_f32_16x16x32_bf16 v[68:71], a[80:83], v[128:131], 0
    ds_read_b128 v[168:171], v12 offset:2048
    s_add_u32 m0, s29, 10240
    v_mfma_f32_16x16x32_bf16 v[72:75], a[80:83], v[132:135], 0
    ds_read_b128 v[172:175], v13 offset:2048
    s_mov_b32 s61, 0x2800
    v_mfma_f32_16x16x32_bf16 v[76:79], a[80:83], v[136:139], 0
    ds_read_b128 v[176:179], v14 offset:2048
    buffer_load_dwordx4 v10, s[12:15], s61 offen offset:0 sc1 lds
    v_mfma_f32_16x16x32_bf16 v[80:83], a[80:83], v[140:143], 0
    ds_read_b128 v[180:183], v15 offset:2048
    buffer_load_dwordx4 v10, s[12:15], s61 offen offset:1024 sc1 lds
    v_mfma_f32_16x16x32_bf16 v[84:87], v[144:147], v[128:131], 0
    ds_read_b128 v[184:187], v27 offset:22528
    s_waitcnt lgkmcnt(5)
    v_mfma_f32_16x16x32_bf16 v[68:71], a[84:87], v[148:151], v[68:71]
    ds_read_b128 v[128:131], v12 offset:3072
    buffer_load_dwordx4 v10, s[12:15], s61 offen offset:2048 sc1 lds
    v_mfma_f32_16x16x32_bf16 v[72:75], a[84:87], v[152:155], v[72:75]
    ds_read_b128 v[132:135], v13 offset:3072
    buffer_load_dwordx4 v10, s[12:15], s61 offen offset:3072 sc1 lds
    v_mfma_f32_16x16x32_bf16 v[76:79], a[84:87], v[156:159], v[76:79]
    ds_read_b128 v[136:139], v14 offset:3072
    s_waitcnt vmcnt(6)
    v_mfma_f32_16x16x32_bf16 v[80:83], a[84:87], v[160:163], v[80:83]
    ds_read_b128 v[140:143], v15 offset:3072
    s_barrier
    v_mfma_f32_16x16x32_bf16 v[84:87], v[164:167], v[148:151], v[84:87]
    ds_read_b128 v[144:147], v27 offset:23552
    s_waitcnt lgkmcnt(5)
    v_mfma_f32_16x16x32_bf16 v[68:71], a[88:91], v[168:171], v[68:71]
    ds_read_b128 v[148:151], v12 offset:4096
    s_add_u32 m0, s29, 14336
    v_mfma_f32_16x16x32_bf16 v[72:75], a[88:91], v[172:175], v[72:75]
    ds_read_b128 v[152:155], v13 offset:4096
    s_mov_b32 s61, 0x3800
    v_mfma_f32_16x16x32_bf16 v[76:79], a[88:91], v[176:179], v[76:79]
    ds_read_b128 v[156:159], v14 offset:4096
    buffer_load_dwordx4 v10, s[12:15], s61 offen offset:0 sc1 lds
    v_mfma_f32_16x16x32_bf16 v[80:83], a[88:91], v[180:183], v[80:83]
    ds_read_b128 v[160:163], v15 offset:4096
    s_add_u32 m0, s29, 15360
    v_mfma_f32_16x16x32_bf16 v[84:87], v[184:187], v[168:171], v[84:87]
    ds_read_b128 v[164:167], v27 offset:24576
    s_mov_b32 s61, 0x3c00
    buffer_load_dwordx4 v11, s[12:15], s61 offen offset:0 sc1 lds
    s_waitcnt lgkmcnt(5)
    v_mfma_f32_16x16x32_bf16 v[68:71], a[92:95], v[128:131], v[68:71]
    ds_read_b128 v[168:171], v12 offset:5120
    buffer_load_dwordx4 v11, s[12:15], s61 offen offset:1024 sc1 lds
    v_mfma_f32_16x16x32_bf16 v[72:75], a[92:95], v[132:135], v[72:75]
    ds_read_b128 v[172:175], v13 offset:5120
    buffer_load_dwordx4 v11, s[12:15], s61 offen offset:2048 sc1 lds
    v_mfma_f32_16x16x32_bf16 v[76:79], a[92:95], v[136:139], v[76:79]
    ds_read_b128 v[176:179], v14 offset:5120
    v_mfma_f32_16x16x32_bf16 v[80:83], a[92:95], v[140:143], v[80:83]
    ds_read_b128 v[180:183], v15 offset:5120
    v_mfma_f32_16x16x32_bf16 v[84:87], v[144:147], v[128:131], v[84:87]
    ds_read_b128 v[184:187], v27 offset:25600
    s_waitcnt lgkmcnt(5)
    v_mfma_f32_16x16x32_bf16 v[68:71], a[96:99], v[148:151], v[68:71]
    ds_read_b128 v[128:131], v12 offset:6144
    buffer_load_dwordx4 v11, s[12:15], s61 offen offset:3072 sc1 lds
    v_mfma_f32_16x16x32_bf16 v[72:75], a[96:99], v[152:155], v[72:75]
    ds_read_b128 v[132:135], v13 offset:6144
    s_add_u32 m0, s29, 19456
    v_mfma_f32_16x16x32_bf16 v[76:79], a[96:99], v[156:159], v[76:79]
    ds_read_b128 v[136:139], v14 offset:6144
    s_mov_b32 s61, 0x4c00
    v_mfma_f32_16x16x32_bf16 v[80:83], a[96:99], v[160:163], v[80:83]
    ds_read_b128 v[140:143], v15 offset:6144
    buffer_load_dwordx4 v11, s[12:15], s61 offen offset:0 sc1 lds
    v_mfma_f32_16x16x32_bf16 v[84:87], v[164:167], v[148:151], v[84:87]
    ds_read_b128 v[144:147], v27 offset:26624
    s_waitcnt lgkmcnt(5)
    s_add_u32 s59, s30, 0xcdf000
    buffer_load_dwordx4 v[40:43], v20, s[8:11], s59 offen sc1
    buffer_load_dwordx4 v[44:47], v21, s[8:11], s59 offen sc1
    s_add_u32 s59, s31, 0xcdf000
    buffer_load_dwordx2 v[48:49], v22, s[8:11], s59 offen sc1
    s_mov_b32 s59, 0xf5f000
    v_lshlrev_b32 v2, 3, v16
    buffer_load_dwordx2 v[116:117], v2, s[8:11], s59 offen sc1
    v_lshlrev_b32 v2, 3, v17
    buffer_load_dwordx2 v[118:119], v2, s[8:11], s59 offen sc1
    v_lshlrev_b32 v2, 3, v18
    buffer_load_dwordx2 v[120:121], v2, s[8:11], s59 offen sc1
    v_mfma_f32_16x16x32_bf16 v[68:71], a[100:103], v[168:171], v[68:71]
    ds_read_b128 v[148:151], v12 offset:7168
    s_waitcnt vmcnt(14)
    v_mfma_f32_16x16x32_bf16 v[72:75], a[100:103], v[172:175], v[72:75]
    ds_read_b128 v[152:155], v13 offset:7168
    s_barrier
    v_mfma_f32_16x16x32_bf16 v[76:79], a[100:103], v[176:179], v[76:79]
    ds_read_b128 v[156:159], v14 offset:7168
    v_mfma_f32_16x16x32_bf16 v[80:83], a[100:103], v[180:183], v[80:83]
    ds_read_b128 v[160:163], v15 offset:7168
    v_mfma_f32_16x16x32_bf16 v[84:87], v[184:187], v[168:171], v[84:87]
    ds_read_b128 v[164:167], v27 offset:27648
    s_waitcnt lgkmcnt(5)
    v_mfma_f32_16x16x32_bf16 v[68:71], a[104:107], v[128:131], v[68:71]
    ds_read_b128 v[168:171], v12 offset:8192
    s_add_u32 s62, s24, 9592832
    v_mfma_f32_16x16x32_bf16 v[72:75], a[104:107], v[132:135], v[72:75]
    ds_read_b128 v[172:175], v13 offset:8192
    buffer_load_dwordx4 a[228:231], v6, s[8:11], s62 offen offset:0
    v_mfma_f32_16x16x32_bf16 v[76:79], a[104:107], v[136:139], v[76:79]
    ds_read_b128 v[176:179], v14 offset:8192
    v_mfma_f32_16x16x32_bf16 v[80:83], a[104:107], v[140:143], v[80:83]
    ds_read_b128 v[180:183], v15 offset:8192
    v_mfma_f32_16x16x32_bf16 v[84:87], v[144:147], v[128:131], v[84:87]
    ds_read_b128 v[184:187], v27 offset:28672
    s_waitcnt lgkmcnt(5)
    v_mfma_f32_16x16x32_bf16 v[68:71], a[108:111], v[148:151], v[68:71]
    ds_read_b128 v[128:131], v12 offset:9216
    buffer_load_dwordx4 a[236:239], v6, s[8:11], s62 offen offset:1024
    v_mfma_f32_16x16x32_bf16 v[72:75], a[108:111], v[152:155], v[72:75]
    ds_read_b128 v[132:135], v13 offset:9216
    v_mfma_f32_16x16x32_bf16 v[76:79], a[108:111], v[156:159], v[76:79]
    ds_read_b128 v[136:139], v14 offset:9216
    v_mfma_f32_16x16x32_bf16 v[80:83], a[108:111], v[160:163], v[80:83]
    ds_read_b128 v[140:143], v15 offset:9216
    v_mfma_f32_16x16x32_bf16 v[84:87], v[164:167], v[148:151], v[84:87]
    ds_read_b128 v[144:147], v27 offset:29696
    s_waitcnt lgkmcnt(5)
    v_mfma_f32_16x16x32_bf16 v[68:71], a[112:115], v[168:171], v[68:71]
    ds_read_b128 v[148:151], v12 offset:10240
    buffer_load_dwordx4 a[244:247], v6, s[8:11], s62 offen offset:2048
    v_mfma_f32_16x16x32_bf16 v[72:75], a[112:115], v[172:175], v[72:75]
    ds_read_b128 v[152:155], v13 offset:10240
    v_mfma_f32_16x16x32_bf16 v[76:79], a[112:115], v[176:179], v[76:79]
    ds_read_b128 v[156:159], v14 offset:10240
    v_mfma_f32_16x16x32_bf16 v[80:83], a[112:115], v[180:183], v[80:83]
    ds_read_b128 v[160:163], v15 offset:10240
    v_mfma_f32_16x16x32_bf16 v[84:87], v[184:187], v[168:171], v[84:87]
    ds_read_b128 v[164:167], v27 offset:30720
    s_waitcnt lgkmcnt(5)
    v_mfma_f32_16x16x32_bf16 v[68:71], a[116:119], v[128:131], v[68:71]
    ds_read_b128 v[168:171], v12 offset:11264
    buffer_load_dwordx4 a[252:255], v6, s[8:11], s62 offen offset:3072
    v_mfma_f32_16x16x32_bf16 v[72:75], a[116:119], v[132:135], v[72:75]
    ds_read_b128 v[172:175], v13 offset:11264
    s_waitcnt vmcnt(14)
    v_mfma_f32_16x16x32_bf16 v[76:79], a[116:119], v[136:139], v[76:79]
    ds_read_b128 v[176:179], v14 offset:11264
    s_barrier
    v_mfma_f32_16x16x32_bf16 v[80:83], a[116:119], v[140:143], v[80:83]
    ds_read_b128 v[180:183], v15 offset:11264
    v_mfma_f32_16x16x32_bf16 v[84:87], v[144:147], v[128:131], v[84:87]
    ds_read_b128 v[184:187], v27 offset:31744
    s_waitcnt lgkmcnt(5)
    v_mfma_f32_16x16x32_bf16 v[68:71], a[120:123], v[148:151], v[68:71]
    ds_read_b128 v[128:131], v12 offset:12288
    s_add_u32 s62, s24, 9596928
    v_mfma_f32_16x16x32_bf16 v[72:75], a[120:123], v[152:155], v[72:75]
    ds_read_b128 v[132:135], v13 offset:12288
    buffer_load_dwordx4 v[196:199], v6, s[8:11], s62 offen offset:0
    v_mfma_f32_16x16x32_bf16 v[76:79], a[120:123], v[156:159], v[76:79]
    ds_read_b128 v[136:139], v14 offset:12288
    v_mfma_f32_16x16x32_bf16 v[80:83], a[120:123], v[160:163], v[80:83]
    ds_read_b128 v[140:143], v15 offset:12288
    v_mfma_f32_16x16x32_bf16 v[84:87], v[164:167], v[148:151], v[84:87]
    ds_read_b128 v[144:147], v27 offset:32768
    s_waitcnt lgkmcnt(5)
    v_mfma_f32_16x16x32_bf16 v[68:71], a[124:127], v[168:171], v[68:71]
    ds_read_b128 v[148:151], v12 offset:13312
    buffer_load_dwordx4 v[204:207], v6, s[8:11], s62 offen offset:1024
    v_mfma_f32_16x16x32_bf16 v[72:75], a[124:127], v[172:175], v[72:75]
    ds_read_b128 v[152:155], v13 offset:13312
    v_mfma_f32_16x16x32_bf16 v[76:79], a[124:127], v[176:179], v[76:79]
    ds_read_b128 v[156:159], v14 offset:13312
    v_mfma_f32_16x16x32_bf16 v[80:83], a[124:127], v[180:183], v[80:83]
    ds_read_b128 v[160:163], v15 offset:13312
    v_mfma_f32_16x16x32_bf16 v[84:87], v[184:187], v[168:171], v[84:87]
    ds_read_b128 v[164:167], v27 offset:33792
    s_waitcnt lgkmcnt(5)
    v_mfma_f32_16x16x32_bf16 v[68:71], a[128:131], v[128:131], v[68:71]
    ds_read_b128 v[168:171], v12 offset:14336
    buffer_load_dwordx4 v[212:215], v6, s[8:11], s62 offen offset:2048
    v_mfma_f32_16x16x32_bf16 v[72:75], a[128:131], v[132:135], v[72:75]
    ds_read_b128 v[172:175], v13 offset:14336
    v_mfma_f32_16x16x32_bf16 v[76:79], a[128:131], v[136:139], v[76:79]
    ds_read_b128 v[176:179], v14 offset:14336
    v_mfma_f32_16x16x32_bf16 v[80:83], a[128:131], v[140:143], v[80:83]
    ds_read_b128 v[180:183], v15 offset:14336
    v_mfma_f32_16x16x32_bf16 v[84:87], v[144:147], v[128:131], v[84:87]
    ds_read_b128 v[184:187], v27 offset:34816
    s_waitcnt lgkmcnt(5)
    v_mfma_f32_16x16x32_bf16 v[68:71], a[132:135], v[148:151], v[68:71]
    ds_read_b128 v[128:131], v12 offset:15360
    buffer_load_dwordx4 v[220:223], v6, s[8:11], s62 offen offset:3072
    v_mfma_f32_16x16x32_bf16 v[72:75], a[132:135], v[152:155], v[72:75]
    ds_read_b128 v[132:135], v13 offset:15360
    s_waitcnt vmcnt(14)
    v_mfma_f32_16x16x32_bf16 v[76:79], a[132:135], v[156:159], v[76:79]
    ds_read_b128 v[136:139], v14 offset:15360
    s_barrier
    v_mfma_f32_16x16x32_bf16 v[80:83], a[132:135], v[160:163], v[80:83]
    ds_read_b128 v[140:143], v15 offset:15360
    v_mfma_f32_16x16x32_bf16 v[84:87], v[164:167], v[148:151], v[84:87]
    ds_read_b128 v[144:147], v27 offset:35840
    s_waitcnt lgkmcnt(5)
    v_mfma_f32_16x16x32_bf16 v[68:71], a[136:139], v[168:171], v[68:71]
    ds_read_b128 v[148:151], v12 offset:16384
    s_add_u32 s62, s24, 9601024
    v_mfma_f32_16x16x32_bf16 v[72:75], a[136:139], v[172:175], v[72:75]
    ds_read_b128 v[152:155], v13 offset:16384
    buffer_load_dwordx4 v[228:231], v6, s[8:11], s62 offen offset:0
    v_mfma_f32_16x16x32_bf16 v[76:79], a[136:139], v[176:179], v[76:79]
    ds_read_b128 v[156:159], v14 offset:16384
    v_mfma_f32_16x16x32_bf16 v[80:83], a[136:139], v[180:183], v[80:83]
    ds_read_b128 v[160:163], v15 offset:16384
    v_mfma_f32_16x16x32_bf16 v[84:87], v[184:187], v[168:171], v[84:87]
    ds_read_b128 v[164:167], v27 offset:36864
    s_waitcnt lgkmcnt(5)
    v_mfma_f32_16x16x32_bf16 v[68:71], a[140:143], v[128:131], v[68:71]
    ds_read_b128 v[168:171], v12 offset:17408
    buffer_load_dwordx4 v[236:239], v6, s[8:11], s62 offen offset:1024
    v_mfma_f32_16x16x32_bf16 v[72:75], a[140:143], v[132:135], v[72:75]
    ds_read_b128 v[172:175], v13 offset:17408
    v_mfma_f32_16x16x32_bf16 v[76:79], a[140:143], v[136:139], v[76:79]
    ds_read_b128 v[176:179], v14 offset:17408
    v_mfma_f32_16x16x32_bf16 v[80:83], a[140:143], v[140:143], v[80:83]
    ds_read_b128 v[180:183], v15 offset:17408
    v_mfma_f32_16x16x32_bf16 v[84:87], v[144:147], v[128:131], v[84:87]
    ds_read_b128 v[184:187], v27 offset:37888
    s_waitcnt lgkmcnt(5)
    v_mfma_f32_16x16x32_bf16 v[68:71], a[144:147], v[148:151], v[68:71]
    ds_read_b128 v[128:131], v12 offset:18432
    buffer_load_dwordx4 v[244:247], v6, s[8:11], s62 offen offset:2048
    v_mfma_f32_16x16x32_bf16 v[72:75], a[144:147], v[152:155], v[72:75]
    ds_read_b128 v[132:135], v13 offset:18432
    v_mfma_f32_16x16x32_bf16 v[76:79], a[144:147], v[156:159], v[76:79]
    ds_read_b128 v[136:139], v14 offset:18432
    v_mfma_f32_16x16x32_bf16 v[80:83], a[144:147], v[160:163], v[80:83]
    ds_read_b128 v[140:143], v15 offset:18432
    v_mfma_f32_16x16x32_bf16 v[84:87], v[164:167], v[148:151], v[84:87]
    ds_read_b128 v[144:147], v27 offset:38912
    s_waitcnt lgkmcnt(5)
    v_mfma_f32_16x16x32_bf16 v[68:71], a[148:151], v[168:171], v[68:71]
    ds_read_b128 v[148:151], v12 offset:19456
    buffer_load_dwordx4 v[252:255], v6, s[8:11], s62 offen offset:3072
    v_mfma_f32_16x16x32_bf16 v[72:75], a[148:151], v[172:175], v[72:75]
    ds_read_b128 v[152:155], v13 offset:19456
    v_mfma_f32_16x16x32_bf16 v[76:79], a[148:151], v[176:179], v[76:79]
    ds_read_b128 v[156:159], v14 offset:19456
    v_mfma_f32_16x16x32_bf16 v[80:83], a[148:151], v[180:183], v[80:83]
    ds_read_b128 v[160:163], v15 offset:19456
    v_mfma_f32_16x16x32_bf16 v[84:87], v[184:187], v[168:171], v[84:87]
    ds_read_b128 v[164:167], v27 offset:39936
    s_waitcnt lgkmcnt(5)
    v_mfma_f32_16x16x32_bf16 v[68:71], a[152:155], v[128:131], v[68:71]
    v_mfma_f32_16x16x32_bf16 v[72:75], a[152:155], v[132:135], v[72:75]
    v_mfma_f32_16x16x32_bf16 v[76:79], a[152:155], v[136:139], v[76:79]
    v_mfma_f32_16x16x32_bf16 v[80:83], a[152:155], v[140:143], v[80:83]
    v_mfma_f32_16x16x32_bf16 v[84:87], v[144:147], v[128:131], v[84:87]
    s_waitcnt lgkmcnt(0)
    v_mfma_f32_16x16x32_bf16 v[68:71], a[156:159], v[148:151], v[68:71]
    v_mfma_f32_16x16x32_bf16 v[72:75], a[156:159], v[152:155], v[72:75]
    v_mfma_f32_16x16x32_bf16 v[76:79], a[156:159], v[156:159], v[76:79]
    v_mfma_f32_16x16x32_bf16 v[80:83], a[156:159], v[160:163], v[80:83]
    v_mfma_f32_16x16x32_bf16 v[84:87], v[164:167], v[148:151], v[84:87]
    s_waitcnt vmcnt(12)
    s_add_u32 s57, s30, 0x11e3000
    s_add_u32 s58, s31, 0x11e3000
    s_add_u32 s62, s25, 9564160
    buffer_load_dwordx4 a[0:3], v6, s[8:11], s62 offen offset:0
    buffer_load_dwordx4 a[4:7], v6, s[8:11], s62 offen offset:1024
    v_lshlrev_b32 v128, 16, v40
    v_and_b32 v129, s42, v40
    v_lshlrev_b32 v130, 16, v41
    v_and_b32 v131, s42, v41
    v_lshlrev_b32 v132, 16, v42
    v_and_b32 v133, s42, v42
    v_lshlrev_b32 v134, 16, v43
    v_and_b32 v135, s42, v43
    v_mov_b32 v136, v117
    v_permlane16_swap_b32 v68, v72
    v_permlane16_swap_b32 v69, v73
    v_permlane16_swap_b32 v70, v74
    v_permlane16_swap_b32 v71, v75
    v_pk_add_f32 v[128:129], v[128:129], v[116:117] op_sel_hi:[1,0] neg_lo:[0,1] neg_hi:[0,1]
    v_pk_add_f32 v[130:131], v[130:131], v[116:117] op_sel_hi:[1,0] neg_lo:[0,1] neg_hi:[0,1]
    v_pk_add_f32 v[132:133], v[132:133], v[116:117] op_sel_hi:[1,0] neg_lo:[0,1] neg_hi:[0,1]
    v_pk_add_f32 v[134:135], v[134:135], v[116:117] op_sel_hi:[1,0] neg_lo:[0,1] neg_hi:[0,1]
    v_pk_fma_f32 v[68:69], v[128:129], v[136:137], v[68:69] op_sel_hi:[1,0,1]
    v_pk_fma_f32 v[70:71], v[130:131], v[136:137], v[70:71] op_sel_hi:[1,0,1]
    v_pk_fma_f32 v[72:73], v[132:133], v[136:137], v[72:73] op_sel_hi:[1,0,1]
    v_pk_fma_f32 v[74:75], v[134:135], v[136:137], v[74:75] op_sel_hi:[1,0,1]
    v_cvt_pk_bf16_f32 v52, v68, v69
    v_cvt_pk_bf16_f32 v53, v70, v71
    v_cvt_pk_bf16_f32 v54, v72, v73
    v_cvt_pk_bf16_f32 v55, v74, v75
    buffer_store_dwordx4 v[52:55], v20, s[8:11], s57 offen sc1
    buffer_load_dwordx4 a[8:11], v6, s[8:11], s62 offen offset:2048
    v_lshlrev_b32 v128, 16, v44
    v_and_b32 v129, s42, v44
    v_lshlrev_b32 v130, 16, v45
    v_and_b32 v131, s42, v45
    v_lshlrev_b32 v132, 16, v46
    v_and_b32 v133, s42, v46
    v_lshlrev_b32 v134, 16, v47
    v_and_b32 v135, s42, v47
    v_mov_b32 v136, v119
    v_permlane16_swap_b32 v76, v80
    v_permlane16_swap_b32 v77, v81
    v_permlane16_swap_b32 v78, v82
    v_permlane16_swap_b32 v79, v83
    v_pk_add_f32 v[128:129], v[128:129], v[118:119] op_sel_hi:[1,0] neg_lo:[0,1] neg_hi:[0,1]
    v_pk_add_f32 v[130:131], v[130:131], v[118:119] op_sel_hi:[1,0] neg_lo:[0,1] neg_hi:[0,1]
    v_pk_add_f32 v[132:133], v[132:133], v[118:119] op_sel_hi:[1,0] neg_lo:[0,1] neg_hi:[0,1]
    v_pk_add_f32 v[134:135], v[134:135], v[118:119] op_sel_hi:[1,0] neg_lo:[0,1] neg_hi:[0,1]
    v_pk_fma_f32 v[76:77], v[128:129], v[136:137], v[76:77] op_sel_hi:[1,0,1]
    v_pk_fma_f32 v[78:79], v[130:131], v[136:137], v[78:79] op_sel_hi:[1,0,1]
    v_pk_fma_f32 v[80:81], v[132:133], v[136:137], v[80:81] op_sel_hi:[1,0,1]
    v_pk_fma_f32 v[82:83], v[134:135], v[136:137], v[82:83] op_sel_hi:[1,0,1]
    v_cvt_pk_bf16_f32 v56, v76, v77
    v_cvt_pk_bf16_f32 v57, v78, v79
    v_cvt_pk_bf16_f32 v58, v80, v81
    v_cvt_pk_bf16_f32 v59, v82, v83
    buffer_store_dwordx4 v[56:59], v21, s[8:11], s57 offen sc1
    buffer_load_dwordx4 a[12:15], v6, s[8:11], s62 offen offset:3072
    v_lshlrev_b32 v128, 16, v48
    v_and_b32 v129, s42, v48
    v_lshlrev_b32 v130, 16, v49
    v_and_b32 v131, s42, v49
    v_mov_b32 v136, v121
    v_pk_add_f32 v[128:129], v[128:129], v[120:121] op_sel_hi:[1,0] neg_lo:[0,1] neg_hi:[0,1]
    v_pk_add_f32 v[130:131], v[130:131], v[120:121] op_sel_hi:[1,0] neg_lo:[0,1] neg_hi:[0,1]
    v_pk_fma_f32 v[84:85], v[128:129], v[136:137], v[84:85] op_sel_hi:[1,0,1]
    v_pk_fma_f32 v[86:87], v[130:131], v[136:137], v[86:87] op_sel_hi:[1,0,1]
    v_cvt_pk_bf16_f32 v60, v84, v85
    v_cvt_pk_bf16_f32 v61, v86, v87
    buffer_store_dwordx2 v[60:61], v22, s[8:11], s58 offen sc1
    v_and_b32 v130, 1, v5
    s_add_u32 s61, s3, 0
    v_add_u32 v130, s61, v130
    v_and_b32 v130, 3, v130
    s_lshl_b32 s59, s7, 2
    v_add_u32 v128, s59, v130
    v_mul_u32_u24 v24, 49152, v128
    v_lshl_add_u32 v24, v4, 4, v24
    v_lshrrev_b32 v128, 1, v5
    v_lshl_add_u32 v24, v128, 8, v24
    v_and_b32 v130, 1, v5
    s_add_u32 s61, s3, 2
    v_add_u32 v130, s61, v130
    v_and_b32 v130, 3, v130
    s_lshl_b32 s59, s7, 2
    v_add_u32 v128, s59, v130
    v_mul_u32_u24 v25, 49152, v128
    v_lshl_add_u32 v25, v4, 4, v25
    v_lshrrev_b32 v128, 1, v5
    v_lshl_add_u32 v25, v128, 8, v25
    s_lshl_b32 s52, s7, 2
    s_add_u32 s52, s52, s3
    s_mul_i32 s53, s52, 49152
    s_mul_i32 s52, s52, 20480
    s_lshl_b32 s54, s22, 9
    s_add_u32 s54, s54, 0x1463000
    s_lshl_b32 s55, s23, 9
    s_add_u32 s55, s55, 0x1463000
    s_add_u32 s62, s25, 9568256
    buffer_load_dwordx4 a[16:19], v6, s[8:11], s62 offen offset:0
    buffer_load_dwordx4 a[20:23], v6, s[8:11], s62 offen offset:1024
    buffer_load_dwordx4 a[24:27], v6, s[8:11], s62 offen offset:2048
    buffer_load_dwordx4 a[28:31], v6, s[8:11], s62 offen offset:3072
    s_waitcnt vmcnt(4)
    s_barrier
    s_cmp_lg_u32 s3, 0
    s_cbranch_scc1 PUB_18
    s_lshl_b32 s56, s7, 8
    s_add_u32 s56, s56, 10240
    v_mov_b32 v2, 0
    v_mov_b32 v3, 1
    s_mov_b64 exec, 1
    buffer_atomic_add v3, v2, s[8:11], s56 offen sc1
    s_mov_b64 exec, -1
PUB_18:
    buffer_load_dword v188, v20, s[8:11], s57 offen offset:0 sc1
    buffer_load_dword v189, v21, s[8:11], s57 offen offset:0 sc1
    buffer_load_dword v188, v22, s[8:11], s58 offen offset:0 sc1
    s_add_u32 s62, s25, 9572352
    buffer_load_dwordx4 a[32:35], v6, s[8:11], s62 offen offset:0
    buffer_load_dwordx4 a[36:39], v6, s[8:11], s62 offen offset:1024
    buffer_load_dwordx4 a[40:43], v6, s[8:11], s62 offen offset:2048
    buffer_load_dwordx4 a[44:47], v6, s[8:11], s62 offen offset:3072
    v_lshlrev_b32 v128, 16, v52
    v_and_b32 v129, s42, v52
    v_lshlrev_b32 v130, 16, v53
    v_and_b32 v131, s42, v53
    v_lshlrev_b32 v132, 16, v54
    v_and_b32 v133, s42, v54
    v_lshlrev_b32 v134, 16, v55
    v_and_b32 v135, s42, v55
    v_lshlrev_b32 v136, 16, v56
    v_and_b32 v137, s42, v56
    v_lshlrev_b32 v138, 16, v57
    v_and_b32 v139, s42, v57
    v_lshlrev_b32 v140, 16, v58
    v_and_b32 v141, s42, v58
    v_lshlrev_b32 v142, 16, v59
    v_and_b32 v143, s42, v59
    v_lshlrev_b32 v144, 16, v60
    v_and_b32 v145, s42, v60
    v_lshlrev_b32 v146, 16, v61
    v_and_b32 v147, s42, v61
    v_lshlrev_b32 v148, 16, v40
    v_and_b32 v149, s42, v40
    v_lshlrev_b32 v150, 16, v41
    v_and_b32 v151, s42, v41
    v_lshlrev_b32 v152, 16, v42
    v_and_b32 v153, s42, v42
    v_lshlrev_b32 v154, 16, v43
    v_and_b32 v155, s42, v43
    v_lshlrev_b32 v156, 16, v44
    v_and_b32 v157, s42, v44
    v_lshlrev_b32 v158, 16, v45
    v_and_b32 v159, s42, v45
    v_lshlrev_b32 v160, 16, v46
    v_and_b32 v161, s42, v46
    v_lshlrev_b32 v162, 16, v47
    v_and_b32 v163, s42, v47
    v_lshlrev_b32 v164, 16, v48
    v_and_b32 v165, s42, v48
    v_lshlrev_b32 v166, 16, v49
    v_and_b32 v167, s42, v49
    v_pk_add_f32 v[40:41], v[128:129], v[148:149]
    v_pk_add_f32 v[42:43], v[130:131], v[150:151]
    v_pk_add_f32 v[44:45], v[132:133], v[152:153]
    v_pk_add_f32 v[46:47], v[134:135], v[154:155]
    v_pk_add_f32 v[48:49], v[136:137], v[156:157]
    v_pk_add_f32 v[50:51], v[138:139], v[158:159]
    v_pk_add_f32 v[52:53], v[140:141], v[160:161]
    v_pk_add_f32 v[54:55], v[142:143], v[162:163]
    v_pk_add_f32 v[56:57], v[144:145], v[164:165]
    v_pk_add_f32 v[58:59], v[146:147], v[166:167]
    v_mul_u32_u24 v8, 1280, v16
    v_lshrrev_b32 v128, 1, v5
    v_lshl_add_u32 v8, v128, 4, v8
    v_mul_u32_u24 v9, 1280, v17
    v_lshrrev_b32 v128, 1, v5
    v_lshl_add_u32 v9, v128, 4, v9
    v_mul_u32_u24 v10, 1280, v18
    v_lshl_add_u32 v10, v5, 3, v10
    s_mov_b32 s12, s48
    s_mov_b32 s13, s49
    s_mov_b32 s14, 0x280000
    s_mov_b32 s15, 0x00020000
    v_mfma_f32_16x16x32_bf16 v[28:31], a[160:163], v[124:127], 0
    v_mfma_f32_16x16x32_bf16 v[32:35], a[164:167], v[124:127], 0
    v_mfma_f32_16x16x32_bf16 v[28:31], a[168:171], v[124:127], v[28:31]
    v_mfma_f32_16x16x32_bf16 v[32:35], a[172:175], v[124:127], v[32:35]
    v_mfma_f32_16x16x32_bf16 v[28:31], a[176:179], v[124:127], v[28:31]
    v_mfma_f32_16x16x32_bf16 v[32:35], a[180:183], v[124:127], v[32:35]
    v_mfma_f32_16x16x32_bf16 v[28:31], a[184:187], v[124:127], v[28:31]
    v_mfma_f32_16x16x32_bf16 v[32:35], a[188:191], v[124:127], v[32:35]
    v_mfma_f32_16x16x32_bf16 v[28:31], a[192:195], v[124:127], v[28:31]
    v_mfma_f32_16x16x32_bf16 v[32:35], a[196:199], v[124:127], v[32:35]
    v_mfma_f32_16x16x32_bf16 v[28:31], a[200:203], v[124:127], v[28:31]
    v_mfma_f32_16x16x32_bf16 v[32:35], a[204:207], v[124:127], v[32:35]
    s_cmp_lg_u32 s3, 0
    s_cbranch_scc1 AW_20
    s_lshl_b32 s59, s7, 8
    s_add_u32 s59, s59, 10240
    v_mov_b32 v2, s59
    v_mov_b32 v3, 8
    buffer_load_dword v7, v2, s[8:11], 0 offen sc1
AW_20:
    v_mfma_f32_16x16x32_bf16 v[28:31], a[208:211], v[124:127], v[28:31]
    v_mfma_f32_16x16x32_bf16 v[32:35], a[212:215], v[124:127], v[32:35]
    v_mfma_f32_16x16x32_bf16 v[28:31], a[216:219], v[124:127], v[28:31]
    v_mfma_f32_16x16x32_bf16 v[32:35], a[220:223], v[124:127], v[32:35]
    v_mfma_f32_16x16x32_bf16 v[28:31], a[224:227], v[124:127], v[28:31]
    v_mfma_f32_16x16x32_bf16 v[32:35], a[228:231], v[124:127], v[32:35]
    v_mfma_f32_16x16x32_bf16 v[28:31], a[232:235], v[124:127], v[28:31]
    v_mfma_f32_16x16x32_bf16 v[32:35], a[236:239], v[124:127], v[32:35]
    v_mfma_f32_16x16x32_bf16 v[28:31], a[240:243], v[124:127], v[28:31]
    v_mfma_f32_16x16x32_bf16 v[32:35], a[244:247], v[124:127], v[32:35]
    v_mfma_f32_16x16x32_bf16 v[28:31], a[248:251], v[124:127], v[28:31]
    v_mfma_f32_16x16x32_bf16 v[32:35], a[252:255], v[124:127], v[32:35]
    v_mfma_f32_16x16x32_bf16 v[28:31], v[192:195], v[124:127], v[28:31]
    v_mfma_f32_16x16x32_bf16 v[32:35], v[196:199], v[124:127], v[32:35]
    v_mfma_f32_16x16x32_bf16 v[28:31], v[200:203], v[124:127], v[28:31]
    v_mfma_f32_16x16x32_bf16 v[32:35], v[204:207], v[124:127], v[32:35]
    v_mfma_f32_16x16x32_bf16 v[28:31], v[208:211], v[124:127], v[28:31]
    v_mfma_f32_16x16x32_bf16 v[32:35], v[212:215], v[124:127], v[32:35]
    v_mfma_f32_16x16x32_bf16 v[28:31], v[216:219], v[124:127], v[28:31]
    v_mfma_f32_16x16x32_bf16 v[32:35], v[220:223], v[124:127], v[32:35]
    v_mfma_f32_16x16x32_bf16 v[28:31], v[224:227], v[124:127], v[28:31]
    v_mfma_f32_16x16x32_bf16 v[32:35], v[228:231], v[124:127], v[32:35]
    v_mfma_f32_16x16x32_bf16 v[28:31], v[232:235], v[124:127], v[28:31]
    v_mfma_f32_16x16x32_bf16 v[32:35], v[236:239], v[124:127], v[32:35]
    v_mfma_f32_16x16x32_bf16 v[28:31], v[240:243], v[124:127], v[28:31]
    v_mfma_f32_16x16x32_bf16 v[32:35], v[244:247], v[124:127], v[32:35]
    v_mfma_f32_16x16x32_bf16 v[28:31], v[248:251], v[124:127], v[28:31]
    v_mfma_f32_16x16x32_bf16 v[32:35], v[252:255], v[124:127], v[32:35]
    s_waitcnt vmcnt(0)
    s_cmp_lg_u32 s3, 0
    s_cbranch_scc1 AW_19
    v_cmp_ge_u32 vcc, v7, v3
    s_cmp_eq_u64 vcc, -1
    s_cbranch_scc1 POLLD_22
    s_mov_b32 s63, 20000
POLL_21:
    buffer_load_dword v7, v2, s[8:11], 0 offen sc1
    s_waitcnt vmcnt(0)
    v_cmp_ge_u32 vcc, v7, v3
    s_cmp_eq_u64 vcc, -1
    s_cbranch_scc1 POLLD_22
    s_sleep 2
    s_sub_u32 s63, s63, 1
    s_cmp_lg_u32 s63, 0
    s_cbranch_scc1 POLL_21
POLLD_22:
AW_19:
    s_waitcnt vmcnt(0)
    s_barrier
    s_add_u32 m0, s29, 0
    s_add_u32 s61, s52, 0x11e3000
    buffer_load_dwordx4 v6, s[8:11], s61 offen offset:0 sc1 lds
    buffer_load_dwordx4 v6, s[8:11], s61 offen offset:1024 sc1 lds
    buffer_load_dwordx4 v6, s[8:11], s61 offen offset:2048 sc1 lds
    buffer_load_dwordx4 v6, s[8:11], s61 offen offset:3072 sc1 lds
    s_add_u32 m0, s29, 4096
    s_add_u32 s61, s52, 0x11e4000
    buffer_load_dwordx4 v6, s[8:11], s61 offen offset:0 sc1 lds
    buffer_load_dwordx4 v6, s[8:11], s61 offen offset:1024 sc1 lds
    buffer_load_dwordx4 v6, s[8:11], s61 offen offset:2048 sc1 lds
    buffer_load_dwordx4 v6, s[8:11], s61 offen offset:3072 sc1 lds
    s_waitcnt vmcnt(6)
    s_barrier
    ds_read_b128 v[128:131], v12 offset:0
    ds_read_b128 v[132:135], v13 offset:0
    ds_read_b128 v[136:139], v14 offset:0
    ds_read_b128 v[140:143], v15 offset:0
    ds_read_b128 v[148:151], v12 offset:1024
    ds_read_b128 v[152:155], v13 offset:1024
    ds_read_b128 v[156:159], v14 offset:1024
    ds_read_b128 v[160:163], v15 offset:1024
    s_waitcnt vmcnt(4)
    s_barrier
    s_waitcnt lgkmcnt(4)
    v_mfma_f32_16x16x32_bf16 v[68:71], a[160:163], v[128:131], 0
    ds_read_b128 v[168:171], v12 offset:2048
    s_add_u32 m0, s29, 8192
    v_mfma_f32_16x16x32_bf16 v[72:75], a[160:163], v[132:135], 0
    ds_read_b128 v[172:175], v13 offset:2048
    s_add_u32 s61, s52, 0x11e5000
    v_mfma_f32_16x16x32_bf16 v[76:79], a[160:163], v[136:139], 0
    ds_read_b128 v[176:179], v14 offset:2048
    buffer_load_dwordx4 v6, s[8:11], s61 offen offset:0 sc1 lds
    v_mfma_f32_16x16x32_bf16 v[80:83], a[160:163], v[140:143], 0
    ds_read_b128 v[180:183], v15 offset:2048
    buffer_load_dwordx4 v6, s[8:11], s61 offen offset:1024 sc1 lds
    v_mfma_f32_16x16x32_bf16 v[84:87], a[164:167], v[128:131], 0
    v_mfma_f32_16x16x32_bf16 v[88:91], a[164:167], v[132:135], 0
    v_mfma_f32_16x16x32_bf16 v[92:95], a[164:167], v[136:139], 0
    v_mfma_f32_16x16x32_bf16 v[96:99], a[164:167], v[140:143], 0
    v_mfma_f32_16x16x32_bf16 v[116:119], v[124:127], v[128:131], 0
    v_mfma_f32_16x16x32_bf16 v[120:123], v[128:131], v[128:131], 0
    s_waitcnt lgkmcnt(4)
    v_mfma_f32_16x16x32_bf16 v[68:71], a[168:171], v[148:151], v[68:71]
    ds_read_b128 v[128:131], v12 offset:3072
    buffer_load_dwordx4 v6, s[8:11], s61 offen offset:2048 sc1 lds
    v_mfma_f32_16x16x32_bf16 v[72:75], a[168:171], v[152:155], v[72:75]
    ds_read_b128 v[132:135], v13 offset:3072
    buffer_load_dwordx4 v6, s[8:11], s61 offen offset:3072 sc1 lds
    v_mfma_f32_16x16x32_bf16 v[76:79], a[168:171], v[156:159], v[76:79]
    ds_read_b128 v[136:139], v14 offset:3072
    s_waitcnt vmcnt(4)
    v_mfma_f32_16x16x32_bf16 v[80:83], a[168:171], v[160:163], v[80:83]
    ds_read_b128 v[140:143], v15 offset:3072
    s_barrier
    v_mfma_f32_16x16x32_bf16 v[84:87], a[172:175], v[148:151], v[84:87]
    v_mfma_f32_16x16x32_bf16 v[88:91], a[172:175], v[152:155], v[88:91]
    v_mfma_f32_16x16x32_bf16 v[92:95], a[172:175], v[156:159], v[92:95]
    v_mfma_f32_16x16x32_bf16 v[96:99], a[172:175], v[160:163], v[96:99]
    v_mfma_f32_16x16x32_bf16 v[116:119], v[124:127], v[148:151], v[116:119]
    v_mfma_f32_16x16x32_bf16 v[120:123], v[148:151], v[148:151], v[120:123]
    s_waitcnt lgkmcnt(4)
    v_mfma_f32_16x16x32_bf16 v[68:71], a[176:179], v[168:171], v[68:71]
    ds_read_b128 v[148:151], v12 offset:4096
    s_add_u32 m0, s29, 12288
    v_mfma_f32_16x16x32_bf16 v[72:75], a[176:179], v[172:175], v[72:75]
    ds_read_b128 v[152:155], v13 offset:4096
    s_add_u32 s61, s52, 0x11e6000
    v_mfma_f32_16x16x32_bf16 v[76:79], a[176:179], v[176:179], v[76:79]
    ds_read_b128 v[156:159], v14 offset:4096
    buffer_load_dwordx4 v6, s[8:11], s61 offen offset:0 sc1 lds
    v_mfma_f32_16x16x32_bf16 v[80:83], a[176:179], v[180:183], v[80:83]
    ds_read_b128 v[160:163], v15 offset:4096
    buffer_load_dwordx4 v6, s[8:11], s61 offen offset:1024 sc1 lds
    v_mfma_f32_16x16x32_bf16 v[84:87], a[180:183], v[168:171], v[84:87]
    v_mfma_f32_16x16x32_bf16 v[88:91], a[180:183], v[172:175], v[88:91]
    v_mfma_f32_16x16x32_bf16 v[92:95], a[180:183], v[176:179], v[92:95]
    v_mfma_f32_16x16x32_bf16 v[96:99], a[180:183], v[180:183], v[96:99]
    v_mfma_f32_16x16x32_bf16 v[116:119], v[124:127], v[168:171], v[116:119]
    v_mfma_f32_16x16x32_bf16 v[120:123], v[168:171], v[168:171], v[120:123]
    s_waitcnt lgkmcnt(4)
    v_mfma_f32_16x16x32_bf16 v[68:71], a[184:187], v[128:131], v[68:71]
    ds_read_b128 v[168:171], v12 offset:5120
    buffer_load_dwordx4 v6, s[8:11], s61 offen offset:2048 sc1 lds
    v_mfma_f32_16x16x32_bf16 v[72:75], a[184:187], v[132:135], v[72:75]
    ds_read_b128 v[172:175], v13 offset:5120
    buffer_load_dwordx4 v6, s[8:11], s61 offen offset:3072 sc1 lds
    v_mfma_f32_16x16x32_bf16 v[76:79], a[184:187], v[136:139], v[76:79]
    ds_read_b128 v[176:179], v14 offset:5120
    v_mfma_f32_16x16x32_bf16 v[80:83], a[184:187], v[140:143], v[80:83]
    ds_read_b128 v[180:183], v15 offset:5120
    v_mfma_f32_16x16x32_bf16 v[84:87], a[188:191], v[128:131], v[84:87]
    v_mfma_f32_16x16x32_bf16 v[88:91], a[188:191], v[132:135], v[88:91]
    v_mfma_f32_16x16x32_bf16 v[92:95], a[188:191], v[136:139], v[92:95]
    v_mfma_f32_16x16x32_bf16 v[96:99], a[188:191], v[140:143], v[96:99]
    v_mfma_f32_16x16x32_bf16 v[116:119], v[124:127], v[128:131], v[116:119]
    v_mfma_f32_16x16x32_bf16 v[120:123], v[128:131], v[128:131], v[120:123]
    s_waitcnt lgkmcnt(4)
    v_mfma_f32_16x16x32_bf16 v[68:71], a[192:195], v[148:151], v[68:71]
    ds_read_b128 v[128:131], v12 offset:6144
    s_add_u32 m0, s29, 16384
    v_mfma_f32_16x16x32_bf16 v[72:75], a[192:195], v[152:155], v[72:75]
    ds_read_b128 v[132:135], v13 offset:6144
    s_add_u32 s61, s52, 0x11e7000
    v_mfma_f32_16x16x32_bf16 v[76:79], a[192:195], v[156:159], v[76:79]
    ds_read_b128 v[136:139], v14 offset:6144
    buffer_load_dwordx4 v6, s[8:11], s61 offen offset:0 sc1 lds
    v_mfma_f32_16x16x32_bf16 v[80:83], a[192:195], v[160:163], v[80:83]
    ds_read_b128 v[140:143], v15 offset:6144
    buffer_load_dwordx4 v6, s[8:11], s61 offen offset:1024 sc1 lds
    v_mfma_f32_16x16x32_bf16 v[84:87], a[196:199], v[148:151], v[84:87]
    v_mfma_f32_16x16x32_bf16 v[88:91], a[196:199], v[152:155], v[88:91]
    v_mfma_f32_16x16x32_bf16 v[92:95], a[196:199], v[156:159], v[92:95]
    v_mfma_f32_16x16x32_bf16 v[96:99], a[196:199], v[160:163], v[96:99]
    v_mfma_f32_16x16x32_bf16 v[116:119], v[124:127], v[148:151], v[116:119]
    v_mfma_f32_16x16x32_bf16 v[120:123], v[148:151], v[148:151], v[120:123]
    s_waitcnt lgkmcnt(4)
    v_mfma_f32_16x16x32_bf16 v[68:71], a[200:203], v[168:171], v[68:71]
    ds_read_b128 v[148:151], v12 offset:7168
    buffer_load_dwordx4 v6, s[8:11], s61 offen offset:2048 sc1 lds
    v_mfma_f32_16x16x32_bf16 v[72:75], a[200:203], v[172:175], v[72:75]
    ds_read_b128 v[152:155], v13 offset:7168
    buffer_load_dwordx4 v6, s[8:11], s61 offen offset:3072 sc1 lds
    v_mfma_f32_16x16x32_bf16 v[76:79], a[200:203], v[176:179], v[76:79]
    ds_read_b128 v[156:159], v14 offset:7168
    s_waitcnt vmcnt(8)
    v_mfma_f32_16x16x32_bf16 v[80:83], a[200:203], v[180:183], v[80:83]
    ds_read_b128 v[160:163], v15 offset:7168
    s_barrier
    v_mfma_f32_16x16x32_bf16 v[84:87], a[204:207], v[168:171], v[84:87]
    v_mfma_f32_16x16x32_bf16 v[88:91], a[204:207], v[172:175], v[88:91]
    v_mfma_f32_16x16x32_bf16 v[92:95], a[204:207], v[176:179], v[92:95]
    v_mfma_f32_16x16x32_bf16 v[96:99], a[204:207], v[180:183], v[96:99]
    v_mfma_f32_16x16x32_bf16 v[116:119], v[124:127], v[168:171], v[116:119]
    v_mfma_f32_16x16x32_bf16 v[120:123], v[168:171], v[168:171], v[120:123]
    s_waitcnt lgkmcnt(4)
    v_mfma_f32_16x16x32_bf16 v[68:71], a[208:211], v[128:131], v[68:71]
    ds_read_b128 v[168:171], v12 offset:8192
    s_add_u32 s62, s25, 9576448
    v_mfma_f32_16x16x32_bf16 v[72:75], a[208:211], v[132:135], v[72:75]
    ds_read_b128 v[172:175], v13 offset:8192
    buffer_load_dwordx4 a[48:51], v6, s[8:11], s62 offen offset:0
    v_mfma_f32_16x16x32_bf16 v[76:79], a[208:211], v[136:139], v[76:79]
    ds_read_b128 v[176:179], v14 offset:8192
    buffer_load_dwordx4 a[52:55], v6, s[8:11], s62 offen offset:1024
    v_mfma_f32_16x16x32_bf16 v[80:83], a[208:211], v[140:143], v[80:83]
    ds_read_b128 v[180:183], v15 offset:8192
    v_mfma_f32_16x16x32_bf16 v[84:87], a[212:215], v[128:131], v[84:87]
    v_mfma_f32_16x16x32_bf16 v[88:91], a[212:215], v[132:135], v[88:91]
    v_mfma_f32_16x16x32_bf16 v[92:95], a[212:215], v[136:139], v[92:95]
    v_mfma_f32_16x16x32_bf16 v[96:99], a[212:215], v[140:143], v[96:99]
    v_mfma_f32_16x16x32_bf16 v[116:119], v[124:127], v[128:131], v[116:119]
    v_mfma_f32_16x16x32_bf16 v[120:123], v[128:131], v[128:131], v[120:123]
    s_waitcnt lgkmcnt(4)
    v_mfma_f32_16x16x32_bf16 v[68:71], a[216:219], v[148:151], v[68:71]
    ds_read_b128 v[128:131], v12 offset:9216
    buffer_load_dwordx4 a[56:59], v6, s[8:11], s62 offen offset:2048
    v_mfma_f32_16x16x32_bf16 v[72:75], a[216:219], v[152:155], v[72:75]
    ds_read_b128 v[132:135], v13 offset:9216
    buffer_load_dwordx4 a[60:63], v6, s[8:11], s62 offen offset:3072
    v_mfma_f32_16x16x32_bf16 v[76:79], a[216:219], v[156:159], v[76:79]
    ds_read_b128 v[136:139], v14 offset:9216
    v_mfma_f32_16x16x32_bf16 v[80:83], a[216:219], v[160:163], v[80:83]
    ds_read_b128 v[140:143], v15 offset:9216
    v_mfma_f32_16x16x32_bf16 v[84:87], a[220:223], v[148:151], v[84:87]
    v_mfma_f32_16x16x32_bf16 v[88:91], a[220:223], v[152:155], v[88:91]
    v_mfma_f32_16x16x32_bf16 v[92:95], a[220:223], v[156:159], v[92:95]
    v_mfma_f32_16x16x32_bf16 v[96:99], a[220:223], v[160:163], v[96:99]
    v_mfma_f32_16x16x32_bf16 v[116:119], v[124:127], v[148:151], v[116:119]
    v_mfma_f32_16x16x32_bf16 v[120:123], v[148:151], v[148:151], v[120:123]
    s_waitcnt lgkmcnt(4)
    v_mfma_f32_16x16x32_bf16 v[68:71], a[224:227], v[168:171], v[68:71]
    ds_read_b128 v[148:151], v12 offset:10240
    s_add_u32 s62, s25, 9580544
    v_mfma_f32_16x16x32_bf16 v[72:75], a[224:227], v[172:175], v[72:75]
    ds_read_b128 v[152:155], v13 offset:10240
    buffer_load_dwordx4 a[64:67], v6, s[8:11], s62 offen offset:0
    v_mfma_f32_16x16x32_bf16 v[76:79], a[224:227], v[176:179], v[76:79]
    ds_read_b128 v[156:159], v14 offset:10240
    buffer_load_dwordx4 a[68:71], v6, s[8:11], s62 offen offset:1024
    v_mfma_f32_16x16x32_bf16 v[80:83], a[224:227], v[180:183], v[80:83]
    ds_read_b128 v[160:163], v15 offset:10240
    v_mfma_f32_16x16x32_bf16 v[84:87], a[228:231], v[168:171], v[84:87]
    v_mfma_f32_16x16x32_bf16 v[88:91], a[228:231], v[172:175], v[88:91]
    v_mfma_f32_16x16x32_bf16 v[92:95], a[228:231], v[176:179], v[92:95]
    v_mfma_f32_16x16x32_bf16 v[96:99], a[228:231], v[180:183], v[96:99]
    v_mfma_f32_16x16x32_bf16 v[116:119], v[124:127], v[168:171], v[116:119]
    v_mfma_f32_16x16x32_bf16 v[120:123], v[168:171], v[168:171], v[120:123]
    s_waitcnt lgkmcnt(4)
    v_mfma_f32_16x16x32_bf16 v[68:71], a[232:235], v[128:131], v[68:71]
    ds_read_b128 v[168:171], v12 offset:11264
    buffer_load_dwordx4 a[72:75], v6, s[8:11], s62 offen offset:2048
    v_mfma_f32_16x16x32_bf16 v[72:75], a[232:235], v[132:135], v[72:75]
    ds_read_b128 v[172:175], v13 offset:11264
    buffer_load_dwordx4 a[76:79], v6, s[8:11], s62 offen offset:3072
    v_mfma_f32_16x16x32_bf16 v[76:79], a[232:235], v[136:139], v[76:79]
    ds_read_b128 v[176:179], v14 offset:11264
    s_waitcnt vmcnt(12)
    v_mfma_f32_16x16x32_bf16 v[80:83], a[232:235], v[140:143], v[80:83]
    ds_read_b128 v[180:183], v15 offset:11264
    s_barrier
    v_mfma_f32_16x16x32_bf16 v[84:87], a[236:239], v[128:131], v[84:87]
    v_mfma_f32_16x16x32_bf16 v[88:91], a[236:239], v[132:135], v[88:91]
    v_mfma_f32_16x16x32_bf16 v[92:95], a[236:239], v[136:139], v[92:95]
    v_mfma_f32_16x16x32_bf16 v[96:99], a[236:239], v[140:143], v[96:99]
    v_mfma_f32_16x16x32_bf16 v[116:119], v[124:127], v[128:131], v[116:119]
    v_mfma_f32_16x16x32_bf16 v[120:123], v[128:131], v[128:131], v[120:123]
    s_waitcnt lgkmcnt(4)
    v_mfma_f32_16x16x32_bf16 v[68:71], a[240:243], v[148:151], v[68:71]
    ds_read_b128 v[128:131], v12 offset:12288
    s_add_u32 s62, s26, 11530240
    v_mfma_f32_16x16x32_bf16 v[72:75], a[240:243], v[152:155], v[72:75]
    ds_read_b128 v[132:135], v13 offset:12288
    buffer_load_dwordx4 a[80:83], v6, s[8:11], s62 offen offset:0
    v_mfma_f32_16x16x32_bf16 v[76:79], a[240:243], v[156:159], v[76:79]
    ds_read_b128 v[136:139], v14 offset:12288
    buffer_load_dwordx4 a[84:87], v6, s[8:11], s62 offen offset:1024
    v_mfma_f32_16x16x32_bf16 v[80:83], a[240:243], v[160:163], v[80:83]
    ds_read_b128 v[140:143], v15 offset:12288
    v_mfma_f32_16x16x32_bf16 v[84:87], a[244:247], v[148:151], v[84:87]
    v_mfma_f32_16x16x32_bf16 v[88:91], a[244:247], v[152:155], v[88:91]
    v_mfma_f32_16x16x32_bf16 v[92:95], a[244:247], v[156:159], v[92:95]
    v_mfma_f32_16x16x32_bf16 v[96:99], a[244:247], v[160:163], v[96:99]
    v_mfma_f32_16x16x32_bf16 v[116:119], v[124:127], v[148:151], v[116:119]
    v_mfma_f32_16x16x32_bf16 v[120:123], v[148:151], v[148:151], v[120:123]
    s_waitcnt lgkmcnt(4)
    v_mfma_f32_16x16x32_bf16 v[68:71], a[248:251], v[168:171], v[68:71]
    ds_read_b128 v[148:151], v12 offset:13312
    buffer_load_dwordx4 a[88:91], v6, s[8:11], s62 offen offset:2048
    v_mfma_f32_16x16x32_bf16 v[72:75], a[248:251], v[172:175], v[72:75]
    ds_read_b128 v[152:155], v13 offset:13312
    buffer_load_dwordx4 a[92:95], v6, s[8:11], s62 offen offset:3072
    v_mfma_f32_16x16x32_bf16 v[76:79], a[248:251], v[176:179], v[76:79]
    ds_read_b128 v[156:159], v14 offset:13312
    v_mfma_f32_16x16x32_bf16 v[80:83], a[248:251], v[180:183], v[80:83]
    ds_read_b128 v[160:163], v15 offset:13312
    v_mfma_f32_16x16x32_bf16 v[84:87], a[252:255], v[168:171], v[84:87]
    v_mfma_f32_16x16x32_bf16 v[88:91], a[252:255], v[172:175], v[88:91]
    v_mfma_f32_16x16x32_bf16 v[92:95], a[252:255], v[176:179], v[92:95]
    v_mfma_f32_16x16x32_bf16 v[96:99], a[252:255], v[180:183], v[96:99]
    v_mfma_f32_16x16x32_bf16 v[116:119], v[124:127], v[168:171], v[116:119]
    v_mfma_f32_16x16x32_bf16 v[120:123], v[168:171], v[168:171], v[120:123]
    s_waitcnt lgkmcnt(4)
    v_mfma_f32_16x16x32_bf16 v[68:71], v[192:195], v[128:131], v[68:71]
    ds_read_b128 v[168:171], v12 offset:14336
    s_add_u32 s62, s26, 11534336
    v_mfma_f32_16x16x32_bf16 v[72:75], v[192:195], v[132:135], v[72:75]
    ds_read_b128 v[172:175], v13 offset:14336
    buffer_load_dwordx4 a[96:99], v6, s[8:11], s62 offen offset:2048
    v_mfma_f32_16x16x32_bf16 v[76:79], v[192:195], v[136:139], v[76:79]
    ds_read_b128 v[176:179], v14 offset:14336
    buffer_load_dwordx4 a[100:103], v6, s[8:11], s62 offen offset:3072
    v_mfma_f32_16x16x32_bf16 v[80:83], v[192:195], v[140:143], v[80:83]
    ds_read_b128 v[180:183], v15 offset:14336
    v_mfma_f32_16x16x32_bf16 v[84:87], v[196:199], v[128:131], v[84:87]
    v_mfma_f32_16x16x32_bf16 v[88:91], v[196:199], v[132:135], v[88:91]
    v_mfma_f32_16x16x32_bf16 v[92:95], v[196:199], v[136:139], v[92:95]
    v_mfma_f32_16x16x32_bf16 v[96:99], v[196:199], v[140:143], v[96:99]
    v_mfma_f32_16x16x32_bf16 v[116:119], v[124:127], v[128:131], v[116:119]
    v_mfma_f32_16x16x32_bf16 v[120:123], v[128:131], v[128:131], v[120:123]
    s_waitcnt lgkmcnt(4)
    v_mfma_f32_16x16x32_bf16 v[68:71], v[200:203], v[148:151], v[68:71]
    ds_read_b128 v[128:131], v12 offset:15360
    s_add_u32 s62, s26, 11538432
    v_mfma_f32_16x16x32_bf16 v[72:75], v[200:203], v[152:155], v[72:75]
    ds_read_b128 v[132:135], v13 offset:15360
    buffer_load_dwordx4 a[104:107], v6, s[8:11], s62 offen offset:0
    v_mfma_f32_16x16x32_bf16 v[76:79], v[200:203], v[156:159], v[76:79]
    ds_read_b128 v[136:139], v14 offset:15360
    buffer_load_dwordx4 a[108:111], v6, s[8:11], s62 offen offset:1024
    v_mfma_f32_16x16x32_bf16 v[80:83], v[200:203], v[160:163], v[80:83]
    ds_read_b128 v[140:143], v15 offset:15360
    s_waitcnt vmcnt(16)
    v_mfma_f32_16x16x32_bf16 v[84:87], v[204:207], v[148:151], v[84:87]
    s_barrier
    v_mfma_f32_16x16x32_bf16 v[88:91], v[204:207], v[152:155], v[88:91]
    v_mfma_f32_16x16x32_bf16 v[92:95], v[204:207], v[156:159], v[92:95]
    v_mfma_f32_16x16x32_bf16 v[96:99], v[204:207], v[160:163], v[96:99]
    v_mfma_f32_16x16x32_bf16 v[116:119], v[124:127], v[148:151], v[116:119]
    v_mfma_f32_16x16x32_bf16 v[120:123], v[148:151], v[148:151], v[120:123]
    s_waitcnt lgkmcnt(4)
    v_mfma_f32_16x16x32_bf16 v[68:71], v[208:211], v[168:171], v[68:71]
    ds_read_b128 v[148:151], v12 offset:16384
    s_add_u32 s62, s26, 11542528
    v_mfma_f32_16x16x32_bf16 v[72:75], v[208:211], v[172:175], v[72:75]
    ds_read_b128 v[152:155], v13 offset:16384
    buffer_load_dwordx4 a[112:115], v6, s[8:11], s62 offen offset:0
    v_mfma_f32_16x16x32_bf16 v[76:79], v[208:211], v[176:179], v[76:79]
    ds_read_b128 v[156:159], v14 offset:16384
    buffer_load_dwordx4 a[116:119], v6, s[8:11], s62 offen offset:1024
    v_mfma_f32_16x16x32_bf16 v[80:83], v[208:211], v[180:183], v[80:83]
    ds_read_b128 v[160:163], v15 offset:16384
    v_mfma_f32_16x16x32_bf16 v[84:87], v[212:215], v[168:171], v[84:87]
    v_mfma_f32_16x16x32_bf16 v[88:91], v[212:215], v[172:175], v[88:91]
    v_mfma_f32_16x16x32_bf16 v[92:95], v[212:215], v[176:179], v[92:95]
    v_mfma_f32_16x16x32_bf16 v[96:99], v[212:215], v[180:183], v[96:99]
    v_mfma_f32_16x16x32_bf16 v[116:119], v[124:127], v[168:171], v[116:119]
    v_mfma_f32_16x16x32_bf16 v[120:123], v[168:171], v[168:171], v[120:123]
    s_waitcnt lgkmcnt(4)
    v_mfma_f32_16x16x32_bf16 v[68:71], v[216:219], v[128:131], v[68:71]
    ds_read_b128 v[168:171], v12 offset:17408
    buffer_load_dwordx4 a[120:123], v6, s[8:11], s62 offen offset:2048
    v_mfma_f32_16x16x32_bf16 v[72:75], v[216:219], v[132:135], v[72:75]
    ds_read_b128 v[172:175], v13 offset:17408
    buffer_load_dwordx4 a[124:127], v6, s[8:11], s62 offen offset:3072
    v_mfma_f32_16x16x32_bf16 v[76:79], v[216:219], v[136:139], v[76:79]
    ds_read_b128 v[176:179], v14 offset:17408
    v_mfma_f32_16x16x32_bf16 v[80:83], v[216:219], v[140:143], v[80:83]
    ds_read_b128 v[180:183], v15 offset:17408
    v_mfma_f32_16x16x32_bf16 v[84:87], v[220:223], v[128:131], v[84:87]
    v_mfma_f32_16x16x32_bf16 v[88:91], v[220:223], v[132:135], v[88:91]
    v_mfma_f32_16x16x32_bf16 v[92:95], v[220:223], v[136:139], v[92:95]
    v_mfma_f32_16x16x32_bf16 v[96:99], v[220:223], v[140:143], v[96:99]
    v_mfma_f32_16x16x32_bf16 v[116:119], v[124:127], v[128:131], v[116:119]
    v_mfma_f32_16x16x32_bf16 v[120:123], v[128:131], v[128:131], v[120:123]
    s_waitcnt lgkmcnt(4)
    v_mfma_f32_16x16x32_bf16 v[68:71], v[224:227], v[148:151], v[68:71]
    ds_read_b128 v[128:131], v12 offset:18432
    s_add_u32 s62, s26, 11546624
    v_mfma_f32_16x16x32_bf16 v[72:75], v[224:227], v[152:155], v[72:75]
    ds_read_b128 v[132:135], v13 offset:18432
    buffer_load_dwordx4 a[128:131], v6, s[8:11], s62 offen offset:2048
    v_mfma_f32_16x16x32_bf16 v[76:79], v[224:227], v[156:159], v[76:79]
    ds_read_b128 v[136:139], v14 offset:18432
    buffer_load_dwordx4 a[132:135], v6, s[8:11], s62 offen offset:3072
    v_mfma_f32_16x16x32_bf16 v[80:83], v[224:227], v[160:163], v[80:83]
    ds_read_b128 v[140:143], v15 offset:18432
    v_mfma_f32_16x16x32_bf16 v[84:87], v[228:231], v[148:151], v[84:87]
    v_mfma_f32_16x16x32_bf16 v[88:91], v[228:231], v[152:155], v[88:91]
    v_mfma_f32_16x16x32_bf16 v[92:95], v[228:231], v[156:159], v[92:95]
    v_mfma_f32_16x16x32_bf16 v[96:99], v[228:231], v[160:163], v[96:99]
    v_mfma_f32_16x16x32_bf16 v[116:119], v[124:127], v[148:151], v[116:119]
    v_mfma_f32_16x16x32_bf16 v[120:123], v[148:151], v[148:151], v[120:123]
    s_waitcnt lgkmcnt(4)
    v_mfma_f32_16x16x32_bf16 v[68:71], v[232:235], v[168:171], v[68:71]
    ds_read_b128 v[148:151], v12 offset:19456
    s_add_u32 s62, s26, 11550720
    v_mfma_f32_16x16x32_bf16 v[72:75], v[232:235], v[172:175], v[72:75]
    ds_read_b128 v[152:155], v13 offset:19456
    buffer_load_dwordx4 a[136:139], v6, s[8:11], s62 offen offset:0
    v_mfma_f32_16x16x32_bf16 v[76:79], v[232:235], v[176:179], v[76:79]
    ds_read_b128 v[156:159], v14 offset:19456
    buffer_load_dwordx4 a[140:143], v6, s[8:11], s62 offen offset:1024
    v_mfma_f32_16x16x32_bf16 v[80:83], v[232:235], v[180:183], v[80:83]
    ds_read_b128 v[160:163], v15 offset:19456
    v_mfma_f32_16x16x32_bf16 v[84:87], v[236:239], v[168:171], v[84:87]
    v_mfma_f32_16x16x32_bf16 v[88:91], v[236:239], v[172:175], v[88:91]
    v_mfma_f32_16x16x32_bf16 v[92:95], v[236:239], v[176:179], v[92:95]
    v_mfma_f32_16x16x32_bf16 v[96:99], v[236:239], v[180:183], v[96:99]
    v_mfma_f32_16x16x32_bf16 v[116:119], v[124:127], v[168:171], v[116:119]
    v_mfma_f32_16x16x32_bf16 v[120:123], v[168:171], v[168:171], v[120:123]
    s_waitcnt lgkmcnt(4)
    v_mfma_f32_16x16x32_bf16 v[68:71], v[240:243], v[128:131], v[68:71]
    s_add_u32 s62, s26, 11554816
    v_mfma_f32_16x16x32_bf16 v[72:75], v[240:243], v[132:135], v[72:75]
    buffer_load_dwordx4 a[144:147], v6, s[8:11], s62 offen offset:0
    v_mfma_f32_16x16x32_bf16 v[76:79], v[240:243], v[136:139], v[76:79]
    buffer_load_dwordx4 a[148:151], v6, s[8:11], s62 offen offset:1024
    v_mfma_f32_16x16x32_bf16 v[80:83], v[240:243], v[140:143], v[80:83]
    v_mfma_f32_16x16x32_bf16 v[84:87], v[244:247], v[128:131], v[84:87]
    v_mfma_f32_16x16x32_bf16 v[88:91], v[244:247], v[132:135], v[88:91]
    v_mfma_f32_16x16x32_bf16 v[92:95], v[244:247], v[136:139], v[92:95]
    v_mfma_f32_16x16x32_bf16 v[96:99], v[244:247], v[140:143], v[96:99]
    v_mfma_f32_16x16x32_bf16 v[116:119], v[124:127], v[128:131], v[116:119]
    v_mfma_f32_16x16x32_bf16 v[120:123], v[128:131], v[128:131], v[120:123]
    s_waitcnt lgkmcnt(0)
    v_mfma_f32_16x16x32_bf16 v[68:71], v[248:251], v[148:151], v[68:71]
    buffer_load_dwordx4 a[152:155], v6, s[8:11], s62 offen offset:2048
    v_mfma_f32_16x16x32_bf16 v[72:75], v[248:251], v[152:155], v[72:75]
    buffer_load_dwordx4 a[156:159], v6, s[8:11], s62 offen offset:3072
    v_mfma_f32_16x16x32_bf16 v[76:79], v[248:251], v[156:159], v[76:79]
    v_mfma_f32_16x16x32_bf16 v[80:83], v[248:251], v[160:163], v[80:83]
    v_mfma_f32_16x16x32_bf16 v[84:87], v[252:255], v[148:151], v[84:87]
    v_mfma_f32_16x16x32_bf16 v[88:91], v[252:255], v[152:155], v[88:91]
    v_mfma_f32_16x16x32_bf16 v[92:95], v[252:255], v[156:159], v[92:95]
    v_mfma_f32_16x16x32_bf16 v[96:99], v[252:255], v[160:163], v[96:99]
    v_mfma_f32_16x16x32_bf16 v[116:119], v[124:127], v[148:151], v[116:119]
    v_mfma_f32_16x16x32_bf16 v[120:123], v[148:151], v[148:151], v[120:123]
    s_lshl_b32 s59, s3, 8
    s_add_u32 s59, s59, 81920
    v_lshl_add_u32 v3, v4, 4, s59
    s_nop 5
    v_and_b32 v134, 3, v4
    v_cmp_eq_u32 vcc, 1, v134
    s_mov_b32 s46, 0x3acccccd
    s_nop 0
    v_cndmask_b32 v133, v120, v121, vcc
    v_cmp_eq_u32 vcc, 2, v134
    v_mul_f32 v132, s46, v116
    s_nop 0
    v_cndmask_b32 v133, v133, v122, vcc
    v_cmp_eq_u32 vcc, 3, v134
    v_lshrrev_b32 v135, 2, v4
    s_nop 0
    v_cndmask_b32 v133, v133, v123, vcc
    v_mul_f32 v133, s46, v133
    v_fma_f32 v133, -v132, v132, v133
    v_max_f32 v133, 0, v133
    v_mov_b32 v130, v132
    v_mov_b32 v131, v133
    v_cvt_pk_bf16_f32 v134, v130, v131
    v_lshlrev_b32 v130, 16, v134
    v_and_b32 v131, s42, v134
    v_add_f32 v131, 0x3727c5ac, v131
    v_cvt_pk_bf16_f32 v131, v131, v131
    v_and_b32 v131, s42, v131
    v_sqrt_f32 v131, v131
    s_nop 0
    v_cvt_pk_bf16_f32 v131, v131, v131
    v_and_b32 v131, s42, v131
    v_rcp_f32 v131, v131
    v_cmp_eq_u32 vcc, v135, v5
    v_mov_b32 v128, v131
    v_mul_f32 v129, v130, v131
    s_and_saveexec_b64 s[44:45], vcc
    ds_write_b128 v3, v[128:131]
    s_mov_b64 exec, s[44:45]
    s_waitcnt lgkmcnt(0)
    s_barrier
    s_add_u32 s59, s3, 0
    s_and_b32 s59, s59, 3
    s_mul_i32 s59, s59, 256
    s_add_u32 s59, s59, 81920
    v_lshl_add_u32 v2, v4, 4, s59
    ds_read_b64 v[116:117], v2
    s_add_u32 s59, s3, 1
    s_and_b32 s59, s59, 3
    s_mul_i32 s59, s59, 256
    s_add_u32 s59, s59, 81920
    v_lshl_add_u32 v2, v4, 4, s59
    ds_read_b64 v[118:119], v2
    s_add_u32 s59, s3, 2
    s_and_b32 s59, s59, 3
    s_mul_i32 s59, s59, 256
    s_add_u32 s59, s59, 81920
    v_lshl_add_u32 v2, v4, 4, s59
    ds_read_b64 v[120:121], v2
    s_add_u32 s59, s3, 3
    s_and_b32 s59, s59, 3
    s_mul_i32 s59, s59, 256
    s_add_u32 s59, s59, 81920
    v_lshl_add_u32 v2, v4, 4, s59
    ds_read_b64 v[122:123], v2
    s_waitcnt lgkmcnt(0)
    s_add_u32 m0, s28, 98304
    s_add_u32 s61, s27, 11530240
    buffer_load_dwordx4 v6, s[8:11], s61 offen offset:0 lds
    buffer_load_dwordx4 v6, s[8:11], s61 offen offset:1024 lds
    v_pk_mul_f32 v[128:129], v[28:29], v[116:117] op_sel:[0,1] op_sel_hi:[1,1]
    v_pk_mul_f32 v[130:131], v[30:31], v[116:117] op_sel:[0,1] op_sel_hi:[1,1]
    v_pk_fma_f32 v[68:69], v[68:69], v[116:117], v[128:129] op_sel_hi:[1,0,1] neg_lo:[0,0,1] neg_hi:[0,0,1]
    v_pk_fma_f32 v[70:71], v[70:71], v[116:117], v[130:131] op_sel_hi:[1,0,1] neg_lo:[0,0,1] neg_hi:[0,0,1]
    v_pk_mul_f32 v[128:129], v[68:69], v[68:69]
    v_pk_mul_f32 v[130:131], v[70:71], v[70:71]
    v_pk_fma_f32 v[128:129], v[128:129], v[62:63], v[64:65]
    v_pk_fma_f32 v[130:131], v[130:131], v[62:63], v[64:65]
    v_pk_mul_f32 v[128:129], v[128:129], v[68:69]
    v_pk_mul_f32 v[130:131], v[130:131], v[70:71]
    v_exp_f32 v128, v128
    v_exp_f32 v129, v129
    v_exp_f32 v130, v130
    v_exp_f32 v131, v131
    s_nop 0
    v_pk_add_f32 v[128:129], v[128:129], 1.0 op_sel_hi:[1,0]
    v_pk_add_f32 v[130:131], v[130:131], 1.0 op_sel_hi:[1,0]
    v_rcp_f32 v128, v128
    v_rcp_f32 v129, v129
    v_rcp_f32 v130, v130
    v_rcp_f32 v131, v131
    s_nop 0
    v_pk_mul_f32 v[68:69], v[68:69], v[128:129]
    v_pk_mul_f32 v[70:71], v[70:71], v[130:131]
    v_cvt_pk_bf16_f32 v144, v68, v69
    v_cvt_pk_bf16_f32 v145, v70, v71
    buffer_load_dwordx4 v6, s[8:11], s61 offen offset:2048 lds
    buffer_load_dwordx4 v6, s[8:11], s61 offen offset:3072 lds
    v_pk_mul_f32 v[128:129], v[28:29], v[118:119] op_sel:[0,1] op_sel_hi:[1,1]
    v_pk_mul_f32 v[130:131], v[30:31], v[118:119] op_sel:[0,1] op_sel_hi:[1,1]
    v_pk_fma_f32 v[72:73], v[72:73], v[118:119], v[128:129] op_sel_hi:[1,0,1] neg_lo:[0,0,1] neg_hi:[0,0,1]
    v_pk_fma_f32 v[74:75], v[74:75], v[118:119], v[130:131] op_sel_hi:[1,0,1] neg_lo:[0,0,1] neg_hi:[0,0,1]
    v_pk_mul_f32 v[128:129], v[72:73], v[72:73]
    v_pk_mul_f32 v[130:131], v[74:75], v[74:75]
    v_pk_fma_f32 v[128:129], v[128:129], v[62:63], v[64:65]
    v_pk_fma_f32 v[130:131], v[130:131], v[62:63], v[64:65]
    v_pk_mul_f32 v[128:129], v[128:129], v[72:73]
    v_pk_mul_f32 v[130:131], v[130:131], v[74:75]
    v_exp_f32 v128, v128
    v_exp_f32 v129, v129
    v_exp_f32 v130, v130
    v_exp_f32 v131, v131
    s_nop 0
    v_pk_add_f32 v[128:129], v[128:129], 1.0 op_sel_hi:[1,0]
    v_pk_add_f32 v[130:131], v[130:131], 1.0 op_sel_hi:[1,0]
    v_rcp_f32 v128, v128
    v_rcp_f32 v129, v129
    v_rcp_f32 v130, v130
    v_rcp_f32 v131, v131
    s_nop 0
    v_pk_mul_f32 v[72:73], v[72:73], v[128:129]
    v_pk_mul_f32 v[74:75], v[74:75], v[130:131]
    v_cvt_pk_bf16_f32 v146, v72, v73
    v_cvt_pk_bf16_f32 v147, v74, v75
    s_nop 1
    v_permlane16_swap_b32 v144, v146
    v_permlane16_swap_b32 v145, v147
    buffer_store_dwordx4 v[144:147], v24, s[8:11], s54 offen offset:0 sc1
    s_add_u32 m0, s28, 102400
    s_add_u32 s61, s27, 11534336
    buffer_load_dwordx4 v6, s[8:11], s61 offen offset:0 lds
    buffer_load_dwordx4 v6, s[8:11], s61 offen offset:1024 lds
    v_pk_mul_f32 v[128:129], v[28:29], v[120:121] op_sel:[0,1] op_sel_hi:[1,1]
    v_pk_mul_f32 v[130:131], v[30:31], v[120:121] op_sel:[0,1] op_sel_hi:[1,1]
    v_pk_fma_f32 v[76:77], v[76:77], v[120:121], v[128:129] op_sel_hi:[1,0,1] neg_lo:[0,0,1] neg_hi:[0,0,1]
    v_pk_fma_f32 v[78:79], v[78:79], v[120:121], v[130:131] op_sel_hi:[1,0,1] neg_lo:[0,0,1] neg_hi:[0,0,1]
    v_pk_mul_f32 v[128:129], v[76:77], v[76:77]
    v_pk_mul_f32 v[130:131], v[78:79], v[78:79]
    v_pk_fma_f32 v[128:129], v[128:129], v[62:63], v[64:65]
    v_pk_fma_f32 v[130:131], v[130:131], v[62:63], v[64:65]
    v_pk_mul_f32 v[128:129], v[128:129], v[76:77]
    v_pk_mul_f32 v[130:131], v[130:131], v[78:79]
    v_exp_f32 v128, v128
    v_exp_f32 v129, v129
    v_exp_f32 v130, v130
    v_exp_f32 v131, v131
    s_nop 0
    v_pk_add_f32 v[128:129], v[128:129], 1.0 op_sel_hi:[1,0]
    v_pk_add_f32 v[130:131], v[130:131], 1.0 op_sel_hi:[1,0]
    v_rcp_f32 v128, v128
    v_rcp_f32 v129, v129
    v_rcp_f32 v130, v130
    v_rcp_f32 v131, v131
    s_nop 0
    v_pk_mul_f32 v[76:77], v[76:77], v[128:129]
    v_pk_mul_f32 v[78:79], v[78:79], v[130:131]
    v_cvt_pk_bf16_f32 v148, v76, v77
    v_cvt_pk_bf16_f32 v149, v78, v79
    buffer_load_dwordx4 v6, s[8:11], s61 offen offset:2048 lds
    buffer_load_dwordx4 v6, s[8:11], s61 offen offset:3072 lds
    v_pk_mul_f32 v[128:129], v[28:29], v[122:123] op_sel:[0,1] op_sel_hi:[1,1]
    v_pk_mul_f32 v[130:131], v[30:31], v[122:123] op_sel:[0,1] op_sel_hi:[1,1]
    v_pk_fma_f32 v[80:81], v[80:81], v[122:123], v[128:129] op_sel_hi:[1,0,1] neg_lo:[0,0,1] neg_hi:[0,0,1]
    v_pk_fma_f32 v[82:83], v[82:83], v[122:123], v[130:131] op_sel_hi:[1,0,1] neg_lo:[0,0,1] neg_hi:[0,0,1]
    v_pk_mul_f32 v[128:129], v[80:81], v[80:81]
    v_pk_mul_f32 v[130:131], v[82:83], v[82:83]
    v_pk_fma_f32 v[128:129], v[128:129], v[62:63], v[64:65]
    v_pk_fma_f32 v[130:131], v[130:131], v[62:63], v[64:65]
    v_pk_mul_f32 v[128:129], v[128:129], v[80:81]
    v_pk_mul_f32 v[130:131], v[130:131], v[82:83]
    v_exp_f32 v128, v128
    v_exp_f32 v129, v129
    v_exp_f32 v130, v130
    v_exp_f32 v131, v131
    s_nop 0
    v_pk_add_f32 v[128:129], v[128:129], 1.0 op_sel_hi:[1,0]
    v_pk_add_f32 v[130:131], v[130:131], 1.0 op_sel_hi:[1,0]
    v_rcp_f32 v128, v128
    v_rcp_f32 v129, v129
    v_rcp_f32 v130, v130
    v_rcp_f32 v131, v131
    s_nop 0
    v_pk_mul_f32 v[80:81], v[80:81], v[128:129]
    v_pk_mul_f32 v[82:83], v[82:83], v[130:131]
    v_cvt_pk_bf16_f32 v150, v80, v81
    v_cvt_pk_bf16_f32 v151, v82, v83
    s_nop 1
    v_permlane16_swap_b32 v148, v150
    v_permlane16_swap_b32 v149, v151
    buffer_store_dwordx4 v[148:151], v25, s[8:11], s54 offen offset:0 sc1
    s_add_u32 m0, s28, 106496
    s_add_u32 s61, s27, 11538432
    buffer_load_dwordx4 v6, s[8:11], s61 offen offset:0 lds
    buffer_load_dwordx4 v6, s[8:11], s61 offen offset:1024 lds
    v_pk_mul_f32 v[128:129], v[32:33], v[116:117] op_sel:[0,1] op_sel_hi:[1,1]
    v_pk_mul_f32 v[130:131], v[34:35], v[116:117] op_sel:[0,1] op_sel_hi:[1,1]
    v_pk_fma_f32 v[84:85], v[84:85], v[116:117], v[128:129] op_sel_hi:[1,0,1] neg_lo:[0,0,1] neg_hi:[0,0,1]
    v_pk_fma_f32 v[86:87], v[86:87], v[116:117], v[130:131] op_sel_hi:[1,0,1] neg_lo:[0,0,1] neg_hi:[0,0,1]
    v_pk_mul_f32 v[128:129], v[84:85], v[84:85]
    v_pk_mul_f32 v[130:131], v[86:87], v[86:87]
    v_pk_fma_f32 v[128:129], v[128:129], v[62:63], v[64:65]
    v_pk_fma_f32 v[130:131], v[130:131], v[62:63], v[64:65]
    v_pk_mul_f32 v[128:129], v[128:129], v[84:85]
    v_pk_mul_f32 v[130:131], v[130:131], v[86:87]
    v_exp_f32 v128, v128
    v_exp_f32 v129, v129
    v_exp_f32 v130, v130
    v_exp_f32 v131, v131
    s_nop 0
    v_pk_add_f32 v[128:129], v[128:129], 1.0 op_sel_hi:[1,0]
    v_pk_add_f32 v[130:131], v[130:131], 1.0 op_sel_hi:[1,0]
    v_rcp_f32 v128, v128
    v_rcp_f32 v129, v129
    v_rcp_f32 v130, v130
    v_rcp_f32 v131, v131
    s_nop 0
    v_pk_mul_f32 v[84:85], v[84:85], v[128:129]
    v_pk_mul_f32 v[86:87], v[86:87], v[130:131]
    v_cvt_pk_bf16_f32 v144, v84, v85
    v_cvt_pk_bf16_f32 v145, v86, v87
    buffer_load_dwordx4 v6, s[8:11], s61 offen offset:2048 lds
    buffer_load_dwordx4 v6, s[8:11], s61 offen offset:3072 lds
    v_pk_mul_f32 v[128:129], v[32:33], v[118:119] op_sel:[0,1] op_sel_hi:[1,1]
    v_pk_mul_f32 v[130:131], v[34:35], v[118:119] op_sel:[0,1] op_sel_hi:[1,1]
    v_pk_fma_f32 v[88:89], v[88:89], v[118:119], v[128:129] op_sel_hi:[1,0,1] neg_lo:[0,0,1] neg_hi:[0,0,1]
    v_pk_fma_f32 v[90:91], v[90:91], v[118:119], v[130:131] op_sel_hi:[1,0,1] neg_lo:[0,0,1] neg_hi:[0,0,1]
    v_pk_mul_f32 v[128:129], v[88:89], v[88:89]
    v_pk_mul_f32 v[130:131], v[90:91], v[90:91]
    v_pk_fma_f32 v[128:129], v[128:129], v[62:63], v[64:65]
    v_pk_fma_f32 v[130:131], v[130:131], v[62:63], v[64:65]
    v_pk_mul_f32 v[128:129], v[128:129], v[88:89]
    v_pk_mul_f32 v[130:131], v[130:131], v[90:91]
    v_exp_f32 v128, v128
    v_exp_f32 v129, v129
    v_exp_f32 v130, v130
    v_exp_f32 v131, v131
    s_nop 0
    v_pk_add_f32 v[128:129], v[128:129], 1.0 op_sel_hi:[1,0]
    v_pk_add_f32 v[130:131], v[130:131], 1.0 op_sel_hi:[1,0]
    v_rcp_f32 v128, v128
    v_rcp_f32 v129, v129
    v_rcp_f32 v130, v130
    v_rcp_f32 v131, v131
    s_nop 0
    v_pk_mul_f32 v[88:89], v[88:89], v[128:129]
    v_pk_mul_f32 v[90:91], v[90:91], v[130:131]
    v_cvt_pk_bf16_f32 v146, v88, v89
    v_cvt_pk_bf16_f32 v147, v90, v91
    s_nop 1
    v_permlane16_swap_b32 v144, v146
    v_permlane16_swap_b32 v145, v147
    buffer_store_dwordx4 v[144:147], v24, s[8:11], s54 offen offset:512 sc1
    s_add_u32 s62, s26, 11558912
    buffer_load_dwordx4 a[160:163], v6, s[8:11], s62 offen offset:2048
    buffer_load_dwordx4 a[164:167], v6, s[8:11], s62 offen offset:3072
    v_pk_mul_f32 v[128:129], v[32:33], v[120:121] op_sel:[0,1] op_sel_hi:[1,1]
    v_pk_mul_f32 v[130:131], v[34:35], v[120:121] op_sel:[0,1] op_sel_hi:[1,1]
    v_pk_fma_f32 v[92:93], v[92:93], v[120:121], v[128:129] op_sel_hi:[1,0,1] neg_lo:[0,0,1] neg_hi:[0,0,1]
    v_pk_fma_f32 v[94:95], v[94:95], v[120:121], v[130:131] op_sel_hi:[1,0,1] neg_lo:[0,0,1] neg_hi:[0,0,1]
    v_pk_mul_f32 v[128:129], v[92:93], v[92:93]
    v_pk_mul_f32 v[130:131], v[94:95], v[94:95]
    v_pk_fma_f32 v[128:129], v[128:129], v[62:63], v[64:65]
    v_pk_fma_f32 v[130:131], v[130:131], v[62:63], v[64:65]
    v_pk_mul_f32 v[128:129], v[128:129], v[92:93]
    v_pk_mul_f32 v[130:131], v[130:131], v[94:95]
    v_exp_f32 v128, v128
    v_exp_f32 v129, v129
    v_exp_f32 v130, v130
    v_exp_f32 v131, v131
    s_nop 0
    v_pk_add_f32 v[128:129], v[128:129], 1.0 op_sel_hi:[1,0]
    v_pk_add_f32 v[130:131], v[130:131], 1.0 op_sel_hi:[1,0]
    v_rcp_f32 v128, v128
    v_rcp_f32 v129, v129
    v_rcp_f32 v130, v130
    v_rcp_f32 v131, v131
    s_nop 0
    v_pk_mul_f32 v[92:93], v[92:93], v[128:129]
    v_pk_mul_f32 v[94:95], v[94:95], v[130:131]
    v_cvt_pk_bf16_f32 v148, v92, v93
    v_cvt_pk_bf16_f32 v149, v94, v95
    s_add_u32 s62, s26, 11563008
    buffer_load_dwordx4 a[168:171], v6, s[8:11], s62 offen offset:0
    buffer_load_dwordx4 a[172:175], v6, s[8:11], s62 offen offset:1024
    v_pk_mul_f32 v[128:129], v[32:33], v[122:123] op_sel:[0,1] op_sel_hi:[1,1]
    v_pk_mul_f32 v[130:131], v[34:35], v[122:123] op_sel:[0,1] op_sel_hi:[1,1]
    v_pk_fma_f32 v[96:97], v[96:97], v[122:123], v[128:129] op_sel_hi:[1,0,1] neg_lo:[0,0,1] neg_hi:[0,0,1]
    v_pk_fma_f32 v[98:99], v[98:99], v[122:123], v[130:131] op_sel_hi:[1,0,1] neg_lo:[0,0,1] neg_hi:[0,0,1]
    v_pk_mul_f32 v[128:129], v[96:97], v[96:97]
    v_pk_mul_f32 v[130:131], v[98:99], v[98:99]
    v_pk_fma_f32 v[128:129], v[128:129], v[62:63], v[64:65]
    v_pk_fma_f32 v[130:131], v[130:131], v[62:63], v[64:65]
    v_pk_mul_f32 v[128:129], v[128:129], v[96:97]
    v_pk_mul_f32 v[130:131], v[130:131], v[98:99]
    v_exp_f32 v128, v128
    v_exp_f32 v129, v129
    v_exp_f32 v130, v130
    v_exp_f32 v131, v131
    s_nop 0
    v_pk_add_f32 v[128:129], v[128:129], 1.0 op_sel_hi:[1,0]
    v_pk_add_f32 v[130:131], v[130:131], 1.0 op_sel_hi:[1,0]
    v_rcp_f32 v128, v128
    v_rcp_f32 v129, v129
    v_rcp_f32 v130, v130
    v_rcp_f32 v131, v131
    s_nop 0
    v_pk_mul_f32 v[96:97], v[96:97], v[128:129]
    v_pk_mul_f32 v[98:99], v[98:99], v[130:131]
    v_cvt_pk_bf16_f32 v150, v96, v97
    v_cvt_pk_bf16_f32 v151, v98, v99
    s_nop 1
    v_permlane16_swap_b32 v148, v150
    v_permlane16_swap_b32 v149, v151
    buffer_store_dwordx4 v[148:151], v25, s[8:11], s54 offen offset:512 sc1
    s_nop 1
    ds_read_b128 v[128:131], v12 offset:0
    ds_read_b128 v[132:135], v13 offset:0
    ds_read_b128 v[136:139], v14 offset:0
    ds_read_b128 v[140:143], v15 offset:0
    ds_read_b128 v[148:151], v12 offset:1024
    ds_read_b128 v[152:155], v13 offset:1024
    ds_read_b128 v[156:159], v14 offset:1024
    ds_read_b128 v[160:163], v15 offset:1024
    s_waitcnt lgkmcnt(4)
    v_mfma_f32_16x16x32_bf16 v[100:103], a[0:3], v[128:131], 0
    ds_read_b128 v[168:171], v12 offset:2048
    s_add_u32 s62, s26, 11567104
    buffer_load_dwordx4 a[176:179], v6, s[8:11], s62 offen offset:0
    v_mfma_f32_16x16x32_bf16 v[104:107], a[0:3], v[132:135], 0
    ds_read_b128 v[172:175], v13 offset:2048
    v_mfma_f32_16x16x32_bf16 v[108:111], a[0:3], v[136:139], 0
    ds_read_b128 v[176:179], v14 offset:2048
    v_mfma_f32_16x16x32_bf16 v[112:115], a[0:3], v[140:143], 0
    ds_read_b128 v[180:183], v15 offset:2048
    v_mfma_f32_16x16x32_bf16 v[36:39], a[0:3], v[124:127], 0
    s_waitcnt lgkmcnt(4)
    v_mfma_f32_16x16x32_bf16 v[100:103], a[4:7], v[148:151], v[100:103]
    ds_read_b128 v[128:131], v12 offset:3072
    buffer_load_dwordx4 a[180:183], v6, s[8:11], s62 offen offset:1024
    v_mfma_f32_16x16x32_bf16 v[104:107], a[4:7], v[152:155], v[104:107]
    ds_read_b128 v[132:135], v13 offset:3072
    v_mfma_f32_16x16x32_bf16 v[108:111], a[4:7], v[156:159], v[108:111]
    ds_read_b128 v[136:139], v14 offset:3072
    v_mfma_f32_16x16x32_bf16 v[112:115], a[4:7], v[160:163], v[112:115]
    ds_read_b128 v[140:143], v15 offset:3072
    v_mfma_f32_16x16x32_bf16 v[36:39], a[4:7], v[124:127], v[36:39]
    s_waitcnt lgkmcnt(4)
    v_mfma_f32_16x16x32_bf16 v[100:103], a[8:11], v[168:171], v[100:103]
    ds_read_b128 v[148:151], v12 offset:4096
    buffer_load_dwordx4 a[184:187], v6, s[8:11], s62 offen offset:2048
    v_mfma_f32_16x16x32_bf16 v[104:107], a[8:11], v[172:175], v[104:107]
    ds_read_b128 v[152:155], v13 offset:4096
    v_mfma_f32_16x16x32_bf16 v[108:111], a[8:11], v[176:179], v[108:111]
    ds_read_b128 v[156:159], v14 offset:4096
    v_mfma_f32_16x16x32_bf16 v[112:115], a[8:11], v[180:183], v[112:115]
    ds_read_b128 v[160:163], v15 offset:4096
    v_mfma_f32_16x16x32_bf16 v[36:39], a[8:11], v[124:127], v[36:39]
    s_waitcnt lgkmcnt(4)
    v_mfma_f32_16x16x32_bf16 v[100:103], a[12:15], v[128:131], v[100:103]
    ds_read_b128 v[168:171], v12 offset:5120
    buffer_load_dwordx4 a[188:191], v6, s[8:11], s62 offen offset:3072
    v_mfma_f32_16x16x32_bf16 v[104:107], a[12:15], v[132:135], v[104:107]
    ds_read_b128 v[172:175], v13 offset:5120
    v_mfma_f32_16x16x32_bf16 v[108:111], a[12:15], v[136:139], v[108:111]
    ds_read_b128 v[176:179], v14 offset:5120
    v_mfma_f32_16x16x32_bf16 v[112:115], a[12:15], v[140:143], v[112:115]
    ds_read_b128 v[180:183], v15 offset:5120
    v_mfma_f32_16x16x32_bf16 v[36:39], a[12:15], v[124:127], v[36:39]
    s_waitcnt lgkmcnt(4)
    v_mfma_f32_16x16x32_bf16 v[100:103], a[16:19], v[148:151], v[100:103]
    ds_read_b128 v[128:131], v12 offset:6144
    s_add_u32 s62, s26, 11571200
    buffer_load_dwordx4 a[192:195], v6, s[8:11], s62 offen offset:2048
    v_mfma_f32_16x16x32_bf16 v[104:107], a[16:19], v[152:155], v[104:107]
    ds_read_b128 v[132:135], v13 offset:6144
    v_mfma_f32_16x16x32_bf16 v[108:111], a[16:19], v[156:159], v[108:111]
    ds_read_b128 v[136:139], v14 offset:6144
    v_mfma_f32_16x16x32_bf16 v[112:115], a[16:19], v[160:163], v[112:115]
    ds_read_b128 v[140:143], v15 offset:6144
    v_mfma_f32_16x16x32_bf16 v[36:39], a[16:19], v[124:127], v[36:39]
    s_waitcnt lgkmcnt(4)
    v_mfma_f32_16x16x32_bf16 v[100:103], a[20:23], v[168:171], v[100:103]
    ds_read_b128 v[148:151], v12 offset:7168
    buffer_load_dwordx4 a[196:199], v6, s[8:11], s62 offen offset:3072
    v_mfma_f32_16x16x32_bf16 v[104:107], a[20:23], v[172:175], v[104:107]
    ds_read_b128 v[152:155], v13 offset:7168
    v_mfma_f32_16x16x32_bf16 v[108:111], a[20:23], v[176:179], v[108:111]
    ds_read_b128 v[156:159], v14 offset:7168
    v_mfma_f32_16x16x32_bf16 v[112:115], a[20:23], v[180:183], v[112:115]
    ds_read_b128 v[160:163], v15 offset:7168
    v_mfma_f32_16x16x32_bf16 v[36:39], a[20:23], v[124:127], v[36:39]
    s_waitcnt lgkmcnt(4)
    v_mfma_f32_16x16x32_bf16 v[100:103], a[24:27], v[128:131], v[100:103]
    ds_read_b128 v[168:171], v12 offset:8192
    s_add_u32 s62, s26, 11575296
    buffer_load_dwordx4 a[200:203], v6, s[8:11], s62 offen offset:0
    v_mfma_f32_16x16x32_bf16 v[104:107], a[24:27], v[132:135], v[104:107]
    ds_read_b128 v[172:175], v13 offset:8192
    v_mfma_f32_16x16x32_bf16 v[108:111], a[24:27], v[136:139], v[108:111]
    ds_read_b128 v[176:179], v14 offset:8192
    v_mfma_f32_16x16x32_bf16 v[112:115], a[24:27], v[140:143], v[112:115]
    ds_read_b128 v[180:183], v15 offset:8192
    v_mfma_f32_16x16x32_bf16 v[36:39], a[24:27], v[124:127], v[36:39]
    s_waitcnt lgkmcnt(4)
    v_mfma_f32_16x16x32_bf16 v[100:103], a[28:31], v[148:151], v[100:103]
    ds_read_b128 v[128:131], v12 offset:9216
    buffer_load_dwordx4 a[204:207], v6, s[8:11], s62 offen offset:1024
    v_mfma_f32_16x16x32_bf16 v[104:107], a[28:31], v[152:155], v[104:107]
    ds_read_b128 v[132:135], v13 offset:9216
    v_mfma_f32_16x16x32_bf16 v[108:111], a[28:31], v[156:159], v[108:111]
    ds_read_b128 v[136:139], v14 offset:9216
    v_mfma_f32_16x16x32_bf16 v[112:115], a[28:31], v[160:163], v[112:115]
    ds_read_b128 v[140:143], v15 offset:9216
    v_mfma_f32_16x16x32_bf16 v[36:39], a[28:31], v[124:127], v[36:39]
    s_waitcnt lgkmcnt(4)
    v_mfma_f32_16x16x32_bf16 v[100:103], a[32:35], v[168:171], v[100:103]
    ds_read_b128 v[148:151], v12 offset:10240
    s_add_u32 s62, s26, 11534336
    buffer_load_dwordx4 a[208:211], v6, s[8:11], s62 offen offset:0
    v_mfma_f32_16x16x32_bf16 v[104:107], a[32:35], v[172:175], v[104:107]
    ds_read_b128 v[152:155], v13 offset:10240
    v_mfma_f32_16x16x32_bf16 v[108:111], a[32:35], v[176:179], v[108:111]
    ds_read_b128 v[156:159], v14 offset:10240
    v_mfma_f32_16x16x32_bf16 v[112:115], a[32:35], v[180:183], v[112:115]
    ds_read_b128 v[160:163], v15 offset:10240
    v_mfma_f32_16x16x32_bf16 v[36:39], a[32:35], v[124:127], v[36:39]
    s_waitcnt lgkmcnt(4)
    s_waitcnt vmcnt(9)
    s_barrier
    s_cmp_lg_u32 s3, 0
    s_cbranch_scc1 PUB_23
    s_lshl_b32 s56, s7, 8
    s_add_u32 s56, s56, 18432
    v_mov_b32 v2, 0
    v_mov_b32 v3, 1
    s_mov_b64 exec, 1
    buffer_atomic_add v3, v2, s[8:11], s56 offen sc1
    s_mov_b64 exec, -1
PUB_23:
    buffer_load_dword v188, v24, s[8:11], s54 offen offset:0 sc1
    buffer_load_dword v189, v25, s[8:11], s54 offen offset:0 sc1
    buffer_load_dword v188, v24, s[8:11], s54 offen offset:512 sc1
    buffer_load_dword v189, v25, s[8:11], s54 offen offset:512 sc1
    v_mfma_f32_16x16x32_bf16 v[100:103], a[36:39], v[128:131], v[100:103]
    ds_read_b128 v[168:171], v12 offset:11264
    buffer_load_dwordx4 a[212:215], v6, s[8:11], s62 offen offset:1024
    v_mfma_f32_16x16x32_bf16 v[104:107], a[36:39], v[132:135], v[104:107]
    ds_read_b128 v[172:175], v13 offset:11264
    v_mfma_f32_16x16x32_bf16 v[108:111], a[36:39], v[136:139], v[108:111]
    ds_read_b128 v[176:179], v14 offset:11264
    v_mfma_f32_16x16x32_bf16 v[112:115], a[36:39], v[140:143], v[112:115]
    ds_read_b128 v[180:183], v15 offset:11264
    v_mfma_f32_16x16x32_bf16 v[36:39], a[36:39], v[124:127], v[36:39]
    s_waitcnt lgkmcnt(4)
    v_mfma_f32_16x16x32_bf16 v[100:103], a[40:43], v[148:151], v[100:103]
    ds_read_b128 v[128:131], v12 offset:12288
    s_add_u32 s62, s26, 11538432
    buffer_load_dwordx4 a[216:219], v6, s[8:11], s62 offen offset:2048
    v_mfma_f32_16x16x32_bf16 v[104:107], a[40:43], v[152:155], v[104:107]
    ds_read_b128 v[132:135], v13 offset:12288
    v_mfma_f32_16x16x32_bf16 v[108:111], a[40:43], v[156:159], v[108:111]
    ds_read_b128 v[136:139], v14 offset:12288
    v_mfma_f32_16x16x32_bf16 v[112:115], a[40:43], v[160:163], v[112:115]
    ds_read_b128 v[140:143], v15 offset:12288
    v_mfma_f32_16x16x32_bf16 v[36:39], a[40:43], v[124:127], v[36:39]
    s_waitcnt lgkmcnt(4)
    v_mfma_f32_16x16x32_bf16 v[100:103], a[44:47], v[168:171], v[100:103]
    ds_read_b128 v[148:151], v12 offset:13312
    buffer_load_dwordx4 a[220:223], v6, s[8:11], s62 offen offset:3072
    v_mfma_f32_16x16x32_bf16 v[104:107], a[44:47], v[172:175], v[104:107]
    ds_read_b128 v[152:155], v13 offset:13312
    v_mfma_f32_16x16x32_bf16 v[108:111], a[44:47], v[176:179], v[108:111]
    ds_read_b128 v[156:159], v14 offset:13312
    v_mfma_f32_16x16x32_bf16 v[112:115], a[44:47], v[180:183], v[112:115]
    ds_read_b128 v[160:163], v15 offset:13312
    v_mfma_f32_16x16x32_bf16 v[36:39], a[44:47], v[124:127], v[36:39]
    s_waitcnt lgkmcnt(4)
    v_mfma_f32_16x16x32_bf16 v[100:103], a[48:51], v[128:131], v[100:103]
    ds_read_b128 v[168:171], v12 offset:14336
    v_mfma_f32_16x16x32_bf16 v[104:107], a[48:51], v[132:135], v[104:107]
    ds_read_b128 v[172:175], v13 offset:14336
    v_mfma_f32_16x16x32_bf16 v[108:111], a[48:51], v[136:139], v[108:111]
    ds_read_b128 v[176:179], v14 offset:14336
    v_mfma_f32_16x16x32_bf16 v[112:115], a[48:51], v[140:143], v[112:115]
    ds_read_b128 v[180:183], v15 offset:14336
    v_mfma_f32_16x16x32_bf16 v[36:39], a[48:51], v[124:127], v[36:39]
    s_waitcnt lgkmcnt(4)
    v_mfma_f32_16x16x32_bf16 v[100:103], a[52:55], v[148:151], v[100:103]
    ds_read_b128 v[128:131], v12 offset:15360
    v_mfma_f32_16x16x32_bf16 v[104:107], a[52:55], v[152:155], v[104:107]
    ds_read_b128 v[132:135], v13 offset:15360
    v_mfma_f32_16x16x32_bf16 v[108:111], a[52:55], v[156:159], v[108:111]
    ds_read_b128 v[136:139], v14 offset:15360
    v_mfma_f32_16x16x32_bf16 v[112:115], a[52:55], v[160:163], v[112:115]
    ds_read_b128 v[140:143], v15 offset:15360
    v_mfma_f32_16x16x32_bf16 v[36:39], a[52:55], v[124:127], v[36:39]
    s_waitcnt lgkmcnt(4)
    v_mfma_f32_16x16x32_bf16 v[100:103], a[56:59], v[168:171], v[100:103]
    ds_read_b128 v[148:151], v12 offset:16384
    v_mfma_f32_16x16x32_bf16 v[104:107], a[56:59], v[172:175], v[104:107]
    ds_read_b128 v[152:155], v13 offset:16384
    v_mfma_f32_16x16x32_bf16 v[108:111], a[56:59], v[176:179], v[108:111]
    ds_read_b128 v[156:159], v14 offset:16384
    v_mfma_f32_16x16x32_bf16 v[112:115], a[56:59], v[180:183], v[112:115]
    ds_read_b128 v[160:163], v15 offset:16384
    v_mfma_f32_16x16x32_bf16 v[36:39], a[56:59], v[124:127], v[36:39]
    s_waitcnt lgkmcnt(4)
    v_mfma_f32_16x16x32_bf16 v[100:103], a[60:63], v[128:131], v[100:103]
    ds_read_b128 v[168:171], v12 offset:17408
    v_mfma_f32_16x16x32_bf16 v[104:107], a[60:63], v[132:135], v[104:107]
    ds_read_b128 v[172:175], v13 offset:17408
    v_mfma_f32_16x16x32_bf16 v[108:111], a[60:63], v[136:139], v[108:111]
    ds_read_b128 v[176:179], v14 offset:17408
    v_mfma_f32_16x16x32_bf16 v[112:115], a[60:63], v[140:143], v[112:115]
    ds_read_b128 v[180:183], v15 offset:17408
    v_mfma_f32_16x16x32_bf16 v[36:39], a[60:63], v[124:127], v[36:39]
    s_waitcnt lgkmcnt(4)
    v_mfma_f32_16x16x32_bf16 v[100:103], a[64:67], v[148:151], v[100:103]
    ds_read_b128 v[128:131], v12 offset:18432
    v_mfma_f32_16x16x32_bf16 v[104:107], a[64:67], v[152:155], v[104:107]
    ds_read_b128 v[132:135], v13 offset:18432
    v_mfma_f32_16x16x32_bf16 v[108:111], a[64:67], v[156:159], v[108:111]
    ds_read_b128 v[136:139], v14 offset:18432
    v_mfma_f32_16x16x32_bf16 v[112:115], a[64:67], v[160:163], v[112:115]
    ds_read_b128 v[140:143], v15 offset:18432
    v_mfma_f32_16x16x32_bf16 v[36:39], a[64:67], v[124:127], v[36:39]
    s_waitcnt lgkmcnt(4)
    v_mfma_f32_16x16x32_bf16 v[100:103], a[68:71], v[168:171], v[100:103]
    ds_read_b128 v[148:151], v12 offset:19456
    v_mfma_f32_16x16x32_bf16 v[104:107], a[68:71], v[172:175], v[104:107]
    ds_read_b128 v[152:155], v13 offset:19456
    v_mfma_f32_16x16x32_bf16 v[108:111], a[68:71], v[176:179], v[108:111]
    ds_read_b128 v[156:159], v14 offset:19456
    v_mfma_f32_16x16x32_bf16 v[112:115], a[68:71], v[180:183], v[112:115]
    ds_read_b128 v[160:163], v15 offset:19456
    v_mfma_f32_16x16x32_bf16 v[36:39], a[68:71], v[124:127], v[36:39]
    s_waitcnt lgkmcnt(4)
    v_mfma_f32_16x16x32_bf16 v[100:103], a[72:75], v[128:131], v[100:103]
    v_mfma_f32_16x16x32_bf16 v[104:107], a[72:75], v[132:135], v[104:107]
    v_mfma_f32_16x16x32_bf16 v[108:111], a[72:75], v[136:139], v[108:111]
    v_mfma_f32_16x16x32_bf16 v[112:115], a[72:75], v[140:143], v[112:115]
    v_mfma_f32_16x16x32_bf16 v[36:39], a[72:75], v[124:127], v[36:39]
    s_waitcnt lgkmcnt(0)
    v_mfma_f32_16x16x32_bf16 v[100:103], a[76:79], v[148:151], v[100:103]
    v_mfma_f32_16x16x32_bf16 v[104:107], a[76:79], v[152:155], v[104:107]
    v_mfma_f32_16x16x32_bf16 v[108:111], a[76:79], v[156:159], v[108:111]
    v_mfma_f32_16x16x32_bf16 v[112:115], a[76:79], v[160:163], v[112:115]
    v_mfma_f32_16x16x32_bf16 v[36:39], a[76:79], v[124:127], v[36:39]
    s_cmp_lg_u32 s3, 0
    s_cbranch_scc1 AW_24
    s_lshl_b32 s59, s7, 8
    s_add_u32 s59, s59, 18432
    v_mov_b32 v2, s59
    v_mov_b32 v3, 8
    s_mov_b32 s63, 20000
POLL_25:
    buffer_load_dword v7, v2, s[8:11], 0 offen sc1
    s_waitcnt vmcnt(0)
    v_cmp_ge_u32 vcc, v7, v3
    s_cmp_eq_u64 vcc, -1
    s_cbranch_scc1 POLLD_26
    s_sleep 2
    s_sub_u32 s63, s63, 1
    s_cmp_lg_u32 s63, 0
    s_cbranch_scc1 POLL_25
POLLD_26:
AW_24:
    s_waitcnt vmcnt(0)
    s_barrier
    s_add_u32 m0, s29, 0
    s_add_u32 s61, s53, 0x1463000
    buffer_load_dwordx4 v6, s[8:11], s61 offen offset:0 sc1 lds
    buffer_load_dwordx4 v6, s[8:11], s61 offen offset:1024 sc1 lds
    buffer_load_dwordx4 v6, s[8:11], s61 offen offset:2048 sc1 lds
    buffer_load_dwordx4 v6, s[8:11], s61 offen offset:3072 sc1 lds
    s_add_u32 m0, s29, 4096
    s_add_u32 s61, s53, 0x1464800
    buffer_load_dwordx4 v6, s[8:11], s61 offen offset:0 sc1 lds
    buffer_load_dwordx4 v6, s[8:11], s61 offen offset:1024 sc1 lds
    buffer_load_dwordx4 v6, s[8:11], s61 offen offset:2048 sc1 lds
    buffer_load_dwordx4 v6, s[8:11], s61 offen offset:3072 sc1 lds
    s_add_u32 m0, s29, 8192
    s_add_u32 s61, s53, 0x1466000
    buffer_load_dwordx4 v6, s[8:11], s61 offen offset:0 sc1 lds
    buffer_load_dwordx4 v6, s[8:11], s61 offen offset:1024 sc1 lds
    buffer_load_dwordx4 v6, s[8:11], s61 offen offset:2048 sc1 lds
    buffer_load_dwordx4 v6, s[8:11], s61 offen offset:3072 sc1 lds
    v_pk_mul_f32 v[128:129], v[36:37], v[116:117] op_sel:[0,1] op_sel_hi:[1,1]
    v_pk_mul_f32 v[130:131], v[38:39], v[116:117] op_sel:[0,1] op_sel_hi:[1,1]
    v_pk_fma_f32 v[100:101], v[100:101], v[116:117], v[128:129] op_sel_hi:[1,0,1] neg_lo:[0,0,1] neg_hi:[0,0,1]
    v_pk_fma_f32 v[102:103], v[102:103], v[116:117], v[130:131] op_sel_hi:[1,0,1] neg_lo:[0,0,1] neg_hi:[0,0,1]
    v_pk_mul_f32 v[128:129], v[100:101], v[100:101]
    v_pk_mul_f32 v[130:131], v[102:103], v[102:103]
    v_pk_fma_f32 v[128:129], v[128:129], v[62:63], v[64:65]
    v_pk_fma_f32 v[130:131], v[130:131], v[62:63], v[64:65]
    v_pk_mul_f32 v[128:129], v[128:129], v[100:101]
    v_pk_mul_f32 v[130:131], v[130:131], v[102:103]
    v_exp_f32 v128, v128
    v_exp_f32 v129, v129
    v_exp_f32 v130, v130
    v_exp_f32 v131, v131
    s_nop 0
    v_pk_add_f32 v[128:129], v[128:129], 1.0 op_sel_hi:[1,0]
    v_pk_add_f32 v[130:131], v[130:131], 1.0 op_sel_hi:[1,0]
    v_rcp_f32 v128, v128
    v_rcp_f32 v129, v129
    v_rcp_f32 v130, v130
    v_rcp_f32 v131, v131
    s_nop 0
    v_pk_mul_f32 v[100:101], v[100:101], v[128:129]
    v_pk_mul_f32 v[102:103], v[102:103], v[130:131]
    v_cvt_pk_bf16_f32 v144, v100, v101
    v_cvt_pk_bf16_f32 v145, v102, v103
    v_pk_mul_f32 v[128:129], v[36:37], v[118:119] op_sel:[0,1] op_sel_hi:[1,1]
    v_pk_mul_f32 v[130:131], v[38:39], v[118:119] op_sel:[0,1] op_sel_hi:[1,1]
    v_pk_fma_f32 v[104:105], v[104:105], v[118:119], v[128:129] op_sel_hi:[1,0,1] neg_lo:[0,0,1] neg_hi:[0,0,1]
    v_pk_fma_f32 v[106:107], v[106:107], v[118:119], v[130:131] op_sel_hi:[1,0,1] neg_lo:[0,0,1] neg_hi:[0,0,1]
    v_pk_mul_f32 v[128:129], v[104:105], v[104:105]
    v_pk_mul_f32 v[130:131], v[106:107], v[106:107]
    v_pk_fma_f32 v[128:129], v[128:129], v[62:63], v[64:65]
    v_pk_fma_f32 v[130:131], v[130:131], v[62:63], v[64:65]
    v_pk_mul_f32 v[128:129], v[128:129], v[104:105]
    v_pk_mul_f32 v[130:131], v[130:131], v[106:107]
    v_exp_f32 v128, v128
    v_exp_f32 v129, v129
    v_exp_f32 v130, v130
    v_exp_f32 v131, v131
    s_nop 0
    v_pk_add_f32 v[128:129], v[128:129], 1.0 op_sel_hi:[1,0]
    v_pk_add_f32 v[130:131], v[130:131], 1.0 op_sel_hi:[1,0]
    v_rcp_f32 v128, v128
    v_rcp_f32 v129, v129
    v_rcp_f32 v130, v130
    v_rcp_f32 v131, v131
    s_nop 0
    v_pk_mul_f32 v[104:105], v[104:105], v[128:129]
    v_pk_mul_f32 v[106:107], v[106:107], v[130:131]
    v_cvt_pk_bf16_f32 v146, v104, v105
    v_cvt_pk_bf16_f32 v147, v106, v107
    s_nop 1
    v_permlane16_swap_b32 v144, v146
    v_permlane16_swap_b32 v145, v147
    buffer_store_dwordx4 v[144:147], v24, s[8:11], s55 offen sc1
    v_pk_mul_f32 v[128:129], v[36:37], v[120:121] op_sel:[0,1] op_sel_hi:[1,1]
    v_pk_mul_f32 v[130:131], v[38:39], v[120:121] op_sel:[0,1] op_sel_hi:[1,1]
    v_pk_fma_f32 v[108:109], v[108:109], v[120:121], v[128:129] op_sel_hi:[1,0,1] neg_lo:[0,0,1] neg_hi:[0,0,1]
    v_pk_fma_f32 v[110:111], v[110:111], v[120:121], v[130:131] op_sel_hi:[1,0,1] neg_lo:[0,0,1] neg_hi:[0,0,1]
    v_pk_mul_f32 v[128:129], v[108:109], v[108:109]
    v_pk_mul_f32 v[130:131], v[110:111], v[110:111]
    v_pk_fma_f32 v[128:129], v[128:129], v[62:63], v[64:65]
    v_pk_fma_f32 v[130:131], v[130:131], v[62:63], v[64:65]
    v_pk_mul_f32 v[128:129], v[128:129], v[108:109]
    v_pk_mul_f32 v[130:131], v[130:131], v[110:111]
    v_exp_f32 v128, v128
    v_exp_f32 v129, v129
    v_exp_f32 v130, v130
    v_exp_f32 v131, v131
    s_nop 0
    v_pk_add_f32 v[128:129], v[128:129], 1.0 op_sel_hi:[1,0]
    v_pk_add_f32 v[130:131], v[130:131], 1.0 op_sel_hi:[1,0]
    v_rcp_f32 v128, v128
    v_rcp_f32 v129, v129
    v_rcp_f32 v130, v130
    v_rcp_f32 v131, v131
    s_nop 0
    v_pk_mul_f32 v[108:109], v[108:109], v[128:129]
    v_pk_mul_f32 v[110:111], v[110:111], v[130:131]
    v_cvt_pk_bf16_f32 v148, v108, v109
    v_cvt_pk_bf16_f32 v149, v110, v111
    v_pk_mul_f32 v[128:129], v[36:37], v[122:123] op_sel:[0,1] op_sel_hi:[1,1]
    v_pk_mul_f32 v[130:131], v[38:39], v[122:123] op_sel:[0,1] op_sel_hi:[1,1]
    v_pk_fma_f32 v[112:113], v[112:113], v[122:123], v[128:129] op_sel_hi:[1,0,1] neg_lo:[0,0,1] neg_hi:[0,0,1]
    v_pk_fma_f32 v[114:115], v[114:115], v[122:123], v[130:131] op_sel_hi:[1,0,1] neg_lo:[0,0,1] neg_hi:[0,0,1]
    v_pk_mul_f32 v[128:129], v[112:113], v[112:113]
    v_pk_mul_f32 v[130:131], v[114:115], v[114:115]
    v_pk_fma_f32 v[128:129], v[128:129], v[62:63], v[64:65]
    v_pk_fma_f32 v[130:131], v[130:131], v[62:63], v[64:65]
    v_pk_mul_f32 v[128:129], v[128:129], v[112:113]
    v_pk_mul_f32 v[130:131], v[130:131], v[114:115]
    v_exp_f32 v128, v128
    v_exp_f32 v129, v129
    v_exp_f32 v130, v130
    v_exp_f32 v131, v131
    s_nop 0
    v_pk_add_f32 v[128:129], v[128:129], 1.0 op_sel_hi:[1,0]
    v_pk_add_f32 v[130:131], v[130:131], 1.0 op_sel_hi:[1,0]
    v_rcp_f32 v128, v128
    v_rcp_f32 v129, v129
    v_rcp_f32 v130, v130
    v_rcp_f32 v131, v131
    s_nop 0
    v_pk_mul_f32 v[112:113], v[112:113], v[128:129]
    v_pk_mul_f32 v[114:115], v[114:115], v[130:131]
    v_cvt_pk_bf16_f32 v150, v112, v113
    v_cvt_pk_bf16_f32 v151, v114, v115
    s_nop 1
    v_permlane16_swap_b32 v148, v150
    v_permlane16_swap_b32 v149, v151
    buffer_store_dwordx4 v[148:151], v25, s[8:11], s55 offen sc1
    s_waitcnt vmcnt(12)
    s_barrier
    ds_read_b128 v[128:131], v12 offset:0
    ds_read_b128 v[132:135], v13 offset:0
    ds_read_b128 v[136:139], v14 offset:0
    ds_read_b128 v[140:143], v15 offset:0
    ds_read_b128 v[144:147], v27 offset:0
    ds_read_b128 v[148:151], v12 offset:1024
    ds_read_b128 v[152:155], v13 offset:1024
    ds_read_b128 v[156:159], v14 offset:1024
    ds_read_b128 v[160:163], v15 offset:1024
    ds_read_b128 v[164:167], v27 offset:1024
    s_waitcnt vmcnt(10)
    s_barrier
    s_waitcnt lgkmcnt(5)
    v_mfma_f32_16x16x32_bf16 v[68:71], a[80:83], v[128:131], 0
    ds_read_b128 v[168:171], v12 offset:2048
    s_add_u32 m0, s29, 12288
    v_mfma_f32_16x16x32_bf16 v[72:75], a[80:83], v[132:135], 0
    ds_read_b128 v[172:175], v13 offset:2048
    s_add_u32 s61, s53, 0x1467800
    v_mfma_f32_16x16x32_bf16 v[76:79], a[80:83], v[136:139], 0
    ds_read_b128 v[176:179], v14 offset:2048
    buffer_load_dwordx4 v6, s[8:11], s61 offen offset:0 sc1 lds
    v_mfma_f32_16x16x32_bf16 v[80:83], a[80:83], v[140:143], 0
    ds_read_b128 v[180:183], v15 offset:2048
    buffer_load_dwordx4 v6, s[8:11], s61 offen offset:1024 sc1 lds
    v_mfma_f32_16x16x32_bf16 v[84:87], v[144:147], v[128:131], 0
    ds_read_b128 v[184:187], v27 offset:2048
    s_waitcnt lgkmcnt(5)
    v_mfma_f32_16x16x32_bf16 v[68:71], a[84:87], v[148:151], v[68:71]
    ds_read_b128 v[128:131], v12 offset:3072
    buffer_load_dwordx4 v6, s[8:11], s61 offen offset:2048 sc1 lds
    v_mfma_f32_16x16x32_bf16 v[72:75], a[84:87], v[152:155], v[72:75]
    ds_read_b128 v[132:135], v13 offset:3072
    buffer_load_dwordx4 v6, s[8:11], s61 offen offset:3072 sc1 lds
    v_mfma_f32_16x16x32_bf16 v[76:79], a[84:87], v[156:159], v[76:79]
    ds_read_b128 v[136:139], v14 offset:3072
    s_waitcnt vmcnt(10)
    v_mfma_f32_16x16x32_bf16 v[80:83], a[84:87], v[160:163], v[80:83]
    ds_read_b128 v[140:143], v15 offset:3072
    s_barrier
    v_mfma_f32_16x16x32_bf16 v[84:87], v[164:167], v[148:151], v[84:87]
    ds_read_b128 v[144:147], v27 offset:3072
    s_waitcnt lgkmcnt(5)
    v_mfma_f32_16x16x32_bf16 v[68:71], a[88:91], v[168:171], v[68:71]
    ds_read_b128 v[148:151], v12 offset:4096
    s_add_u32 m0, s29, 16384
    v_mfma_f32_16x16x32_bf16 v[72:75], a[88:91], v[172:175], v[72:75]
    ds_read_b128 v[152:155], v13 offset:4096
    s_add_u32 s61, s53, 0x1469000
    v_mfma_f32_16x16x32_bf16 v[76:79], a[88:91], v[176:179], v[76:79]
    ds_read_b128 v[156:159], v14 offset:4096
    buffer_load_dwordx4 v6, s[8:11], s61 offen offset:0 sc1 lds
    v_mfma_f32_16x16x32_bf16 v[80:83], a[88:91], v[180:183], v[80:83]
    ds_read_b128 v[160:163], v15 offset:4096
    buffer_load_dwordx4 v6, s[8:11], s61 offen offset:1024 sc1 lds
    v_mfma_f32_16x16x32_bf16 v[84:87], v[184:187], v[168:171], v[84:87]
    ds_read_b128 v[164:167], v27 offset:6144
    s_waitcnt lgkmcnt(5)
    v_mfma_f32_16x16x32_bf16 v[68:71], a[92:95], v[128:131], v[68:71]
    ds_read_b128 v[168:171], v12 offset:5120
    buffer_load_dwordx4 v6, s[8:11], s61 offen offset:2048 sc1 lds
    v_mfma_f32_16x16x32_bf16 v[72:75], a[92:95], v[132:135], v[72:75]
    ds_read_b128 v[172:175], v13 offset:5120
    buffer_load_dwordx4 v6, s[8:11], s61 offen offset:3072 sc1 lds
    v_mfma_f32_16x16x32_bf16 v[76:79], a[92:95], v[136:139], v[76:79]
    ds_read_b128 v[176:179], v14 offset:5120
    v_mfma_f32_16x16x32_bf16 v[80:83], a[92:95], v[140:143], v[80:83]
    ds_read_b128 v[180:183], v15 offset:5120
    v_mfma_f32_16x16x32_bf16 v[84:87], v[144:147], v[128:131], v[84:87]
    ds_read_b128 v[184:187], v27 offset:7168
    s_waitcnt lgkmcnt(5)
    v_mfma_f32_16x16x32_bf16 v[68:71], a[96:99], v[148:151], v[68:71]
    ds_read_b128 v[128:131], v12 offset:6144
    s_add_u32 m0, s29, 0
    v_mfma_f32_16x16x32_bf16 v[72:75], a[96:99], v[152:155], v[72:75]
    ds_read_b128 v[132:135], v13 offset:6144
    s_add_u32 s61, s53, 0x146a800
    v_mfma_f32_16x16x32_bf16 v[76:79], a[96:99], v[156:159], v[76:79]
    ds_read_b128 v[136:139], v14 offset:6144
    buffer_load_dwordx4 v6, s[8:11], s61 offen offset:0 sc1 lds
    v_mfma_f32_16x16x32_bf16 v[80:83], a[96:99], v[160:163], v[80:83]
    ds_read_b128 v[140:143], v15 offset:6144
    v_mfma_f32_16x16x32_bf16 v[84:87], v[164:167], v[148:151], v[84:87]
    ds_read_b128 v[144:147], v27 offset:8192
    s_waitcnt lgkmcnt(5)
    v_mfma_f32_16x16x32_bf16 v[68:71], a[100:103], v[168:171], v[68:71]
    ds_read_b128 v[148:151], v12 offset:7168
    buffer_load_dwordx4 v6, s[8:11], s61 offen offset:1024 sc1 lds
    v_mfma_f32_16x16x32_bf16 v[72:75], a[100:103], v[172:175], v[72:75]
    ds_read_b128 v[152:155], v13 offset:7168
    s_waitcnt vmcnt(12)
    v_mfma_f32_16x16x32_bf16 v[76:79], a[100:103], v[176:179], v[76:79]
    ds_read_b128 v[156:159], v14 offset:7168
    s_barrier
    v_mfma_f32_16x16x32_bf16 v[80:83], a[100:103], v[180:183], v[80:83]
    ds_read_b128 v[160:163], v15 offset:7168
    v_mfma_f32_16x16x32_bf16 v[84:87], v[184:187], v[168:171], v[84:87]
    ds_read_b128 v[164:167], v27 offset:9216
    s_waitcnt lgkmcnt(5)
    s_waitcnt vmcnt(10)
    s_barrier
    s_cmp_lg_u32 s3, 0
    s_cbranch_scc1 G3B_PUB
    s_lshl_b32 s56, s7, 8
    s_add_u32 s56, s56, 26624
    v_mov_b32 v2, 0
    v_mov_b32 v3, 1
    s_mov_b64 exec, 1
    buffer_atomic_add v3, v2, s[8:11], s56 offen sc1
    s_mov_b64 exec, -1
G3B_PUB:
    s_lshl_b32 s59, s7, 8
    s_add_u32 s59, s59, 26624
    v_mov_b32 v2, s59
    v_mov_b32 v3, 8
    v_mfma_f32_16x16x32_bf16 v[68:71], a[104:107], v[128:131], v[68:71]
    ds_read_b128 v[168:171], v12 offset:8192
    buffer_load_dword v188, v24, s[8:11], s55 offen sc1
    v_mfma_f32_16x16x32_bf16 v[72:75], a[104:107], v[132:135], v[72:75]
    ds_read_b128 v[172:175], v13 offset:8192
    buffer_load_dword v189, v25, s[8:11], s55 offen sc1
    v_mfma_f32_16x16x32_bf16 v[76:79], a[104:107], v[136:139], v[76:79]
    ds_read_b128 v[176:179], v14 offset:8192
    buffer_load_dwordx4 v6, s[8:11], s61 offen offset:2048 sc1 lds
    v_mfma_f32_16x16x32_bf16 v[80:83], a[104:107], v[140:143], v[80:83]
    ds_read_b128 v[180:183], v15 offset:8192
    v_mfma_f32_16x16x32_bf16 v[84:87], v[144:147], v[128:131], v[84:87]
    ds_read_b128 v[184:187], v27 offset:12288
    s_waitcnt lgkmcnt(5)
    v_mfma_f32_16x16x32_bf16 v[68:71], a[108:111], v[148:151], v[68:71]
    ds_read_b128 v[128:131], v12 offset:9216
    buffer_load_dwordx4 v6, s[8:11], s61 offen offset:3072 sc1 lds
    v_mfma_f32_16x16x32_bf16 v[72:75], a[108:111], v[152:155], v[72:75]
    ds_read_b128 v[132:135], v13 offset:9216
    v_mfma_f32_16x16x32_bf16 v[76:79], a[108:111], v[156:159], v[76:79]
    ds_read_b128 v[136:139], v14 offset:9216
    v_mfma_f32_16x16x32_bf16 v[80:83], a[108:111], v[160:163], v[80:83]
    ds_read_b128 v[140:143], v15 offset:9216
    v_mfma_f32_16x16x32_bf16 v[84:87], v[164:167], v[148:151], v[84:87]
    ds_read_b128 v[144:147], v27 offset:13312
    s_waitcnt lgkmcnt(5)
    v_mfma_f32_16x16x32_bf16 v[68:71], a[112:115], v[168:171], v[68:71]
    ds_read_b128 v[148:151], v12 offset:10240
    s_add_u32 m0, s29, 4096
    v_mfma_f32_16x16x32_bf16 v[72:75], a[112:115], v[172:175], v[72:75]
    ds_read_b128 v[152:155], v13 offset:10240
    s_add_u32 s61, s53, 0x146c000
    v_mfma_f32_16x16x32_bf16 v[76:79], a[112:115], v[176:179], v[76:79]
    ds_read_b128 v[156:159], v14 offset:10240
    buffer_load_dwordx4 v6, s[8:11], s61 offen offset:0 sc1 lds
    v_mfma_f32_16x16x32_bf16 v[80:83], a[112:115], v[180:183], v[80:83]
    ds_read_b128 v[160:163], v15 offset:10240
    v_mfma_f32_16x16x32_bf16 v[84:87], v[184:187], v[168:171], v[84:87]
    ds_read_b128 v[164:167], v27 offset:14336
    s_waitcnt lgkmcnt(5)
    v_mfma_f32_16x16x32_bf16 v[68:71], a[116:119], v[128:131], v[68:71]
    ds_read_b128 v[168:171], v12 offset:11264
    buffer_load_dwordx4 v6, s[8:11], s61 offen offset:1024 sc1 lds
    v_mfma_f32_16x16x32_bf16 v[72:75], a[116:119], v[132:135], v[72:75]
    ds_read_b128 v[172:175], v13 offset:11264
    s_waitcnt vmcnt(12)
    v_mfma_f32_16x16x32_bf16 v[76:79], a[116:119], v[136:139], v[76:79]
    ds_read_b128 v[176:179], v14 offset:11264
    s_barrier
    v_mfma_f32_16x16x32_bf16 v[80:83], a[116:119], v[140:143], v[80:83]
    ds_read_b128 v[180:183], v15 offset:11264
    v_mfma_f32_16x16x32_bf16 v[84:87], v[144:147], v[128:131], v[84:87]
    ds_read_b128 v[184:187], v27 offset:15360
    s_waitcnt lgkmcnt(5)
    v_mfma_f32_16x16x32_bf16 v[68:71], a[120:123], v[148:151], v[68:71]
    ds_read_b128 v[128:131], v12 offset:12288
    buffer_load_dwordx4 v6, s[8:11], s61 offen offset:2048 sc1 lds
    v_mfma_f32_16x16x32_bf16 v[72:75], a[120:123], v[152:155], v[72:75]
    ds_read_b128 v[132:135], v13 offset:12288
    v_mfma_f32_16x16x32_bf16 v[76:79], a[120:123], v[156:159], v[76:79]
    ds_read_b128 v[136:139], v14 offset:12288
    v_mfma_f32_16x16x32_bf16 v[80:83], a[120:123], v[160:163], v[80:83]
    ds_read_b128 v[140:143], v15 offset:12288
    v_mfma_f32_16x16x32_bf16 v[84:87], v[164:167], v[148:151], v[84:87]
    ds_read_b128 v[144:147], v27 offset:18432
    s_waitcnt lgkmcnt(5)
    v_mfma_f32_16x16x32_bf16 v[68:71], a[124:127], v[168:171], v[68:71]
    ds_read_b128 v[148:151], v12 offset:13312
    buffer_load_dwordx4 v6, s[8:11], s61 offen offset:3072 sc1 lds
    v_mfma_f32_16x16x32_bf16 v[72:75], a[124:127], v[172:175], v[72:75]
    ds_read_b128 v[152:155], v13 offset:13312
    v_mfma_f32_16x16x32_bf16 v[76:79], a[124:127], v[176:179], v[76:79]
    ds_read_b128 v[156:159], v14 offset:13312
    v_mfma_f32_16x16x32_bf16 v[80:83], a[124:127], v[180:183], v[80:83]
    ds_read_b128 v[160:163], v15 offset:13312
    v_mfma_f32_16x16x32_bf16 v[84:87], v[184:187], v[168:171], v[84:87]
    ds_read_b128 v[164:167], v27 offset:19456
    s_waitcnt lgkmcnt(5)
    v_mfma_f32_16x16x32_bf16 v[68:71], a[128:131], v[128:131], v[68:71]
    ds_read_b128 v[168:171], v12 offset:14336
    s_add_u32 m0, s29, 8192
    v_mfma_f32_16x16x32_bf16 v[72:75], a[128:131], v[132:135], v[72:75]
    ds_read_b128 v[172:175], v13 offset:14336
    s_add_u32 s61, s53, 0x146d800
    v_mfma_f32_16x16x32_bf16 v[76:79], a[128:131], v[136:139], v[76:79]
    ds_read_b128 v[176:179], v14 offset:14336
    buffer_load_dwordx4 v6, s[8:11], s61 offen offset:0 sc1 lds
    v_mfma_f32_16x16x32_bf16 v[80:83], a[128:131], v[140:143], v[80:83]
    ds_read_b128 v[180:183], v15 offset:14336
    v_mfma_f32_16x16x32_bf16 v[84:87], v[144:147], v[128:131], v[84:87]
    ds_read_b128 v[184:187], v27 offset:20480
    s_waitcnt lgkmcnt(5)
    v_mfma_f32_16x16x32_bf16 v[68:71], a[132:135], v[148:151], v[68:71]
    ds_read_b128 v[128:131], v12 offset:15360
    buffer_load_dword v7, v2, s[8:11], 0 offen sc1
    v_mfma_f32_16x16x32_bf16 v[72:75], a[132:135], v[152:155], v[72:75]
    ds_read_b128 v[132:135], v13 offset:15360
    buffer_load_dwordx4 v6, s[8:11], s61 offen offset:1024 sc1 lds
    v_mfma_f32_16x16x32_bf16 v[76:79], a[132:135], v[156:159], v[76:79]
    ds_read_b128 v[136:139], v14 offset:15360
    s_waitcnt vmcnt(13)
    v_mfma_f32_16x16x32_bf16 v[80:83], a[132:135], v[160:163], v[80:83]
    ds_read_b128 v[140:143], v15 offset:15360
    s_barrier
    v_mfma_f32_16x16x32_bf16 v[84:87], v[164:167], v[148:151], v[84:87]
    ds_read_b128 v[144:147], v27 offset:21504
    s_waitcnt lgkmcnt(5)
    v_mfma_f32_16x16x32_bf16 v[68:71], a[136:139], v[168:171], v[68:71]
    ds_read_b128 v[148:151], v12 offset:16384
    buffer_load_dwordx4 v6, s[8:11], s61 offen offset:2048 sc1 lds
    v_mfma_f32_16x16x32_bf16 v[72:75], a[136:139], v[172:175], v[72:75]
    ds_read_b128 v[152:155], v13 offset:16384
    v_mfma_f32_16x16x32_bf16 v[76:79], a[136:139], v[176:179], v[76:79]
    ds_read_b128 v[156:159], v14 offset:16384
    v_mfma_f32_16x16x32_bf16 v[80:83], a[136:139], v[180:183], v[80:83]
    ds_read_b128 v[160:163], v15 offset:16384
    v_mfma_f32_16x16x32_bf16 v[84:87], v[184:187], v[168:171], v[84:87]
    ds_read_b128 v[164:167], v27 offset:24576
    s_waitcnt lgkmcnt(5)
    v_mfma_f32_16x16x32_bf16 v[68:71], a[140:143], v[128:131], v[68:71]
    ds_read_b128 v[168:171], v12 offset:17408
    buffer_load_dwordx4 v6, s[8:11], s61 offen offset:3072 sc1 lds
    v_mfma_f32_16x16x32_bf16 v[72:75], a[140:143], v[132:135], v[72:75]
    ds_read_b128 v[172:175], v13 offset:17408
    v_mfma_f32_16x16x32_bf16 v[76:79], a[140:143], v[136:139], v[76:79]
    ds_read_b128 v[176:179], v14 offset:17408
    v_mfma_f32_16x16x32_bf16 v[80:83], a[140:143], v[140:143], v[80:83]
    ds_read_b128 v[180:183], v15 offset:17408
    v_mfma_f32_16x16x32_bf16 v[84:87], v[144:147], v[128:131], v[84:87]
    ds_read_b128 v[184:187], v27 offset:25600
    s_waitcnt lgkmcnt(5)
    s_waitcnt vmcnt(3)
    v_cmp_ge_u32 vcc, v7, v3
    s_cmp_eq_u64 vcc, -1
    s_cbranch_scc1 POLLD_28
    s_mov_b32 s63, 20000
POLL_27:
    buffer_load_dword v7, v2, s[8:11], 0 offen sc1
    s_waitcnt vmcnt(0)
    v_cmp_ge_u32 vcc, v7, v3
    s_cmp_eq_u64 vcc, -1
    s_cbranch_scc1 POLLD_28
    s_sleep 2
    s_sub_u32 s63, s63, 1
    s_cmp_lg_u32 s63, 0
    s_cbranch_scc1 POLL_27
POLLD_28:
    v_mfma_f32_16x16x32_bf16 v[68:71], a[144:147], v[148:151], v[68:71]
    ds_read_b128 v[128:131], v12 offset:18432
    s_add_u32 m0, s29, 12288
    v_mfma_f32_16x16x32_bf16 v[72:75], a[144:147], v[152:155], v[72:75]
    ds_read_b128 v[132:135], v13 offset:18432
    s_add_u32 s61, s53, 0x1464000
    v_mfma_f32_16x16x32_bf16 v[76:79], a[144:147], v[156:159], v[76:79]
    ds_read_b128 v[136:139], v14 offset:18432
    buffer_load_dwordx4 v6, s[8:11], s61 offen offset:0 sc1 lds
    v_mfma_f32_16x16x32_bf16 v[80:83], a[144:147], v[160:163], v[80:83]
    ds_read_b128 v[140:143], v15 offset:18432
    v_mfma_f32_16x16x32_bf16 v[84:87], v[164:167], v[148:151], v[84:87]
    ds_read_b128 v[144:147], v27 offset:26624
    s_waitcnt lgkmcnt(5)
    v_mfma_f32_16x16x32_bf16 v[68:71], a[148:151], v[168:171], v[68:71]
    ds_read_b128 v[148:151], v12 offset:19456
    s_add_u32 s62, s26, 11546624
    v_mfma_f32_16x16x32_bf16 v[72:75], a[148:151], v[172:175], v[72:75]
    ds_read_b128 v[152:155], v13 offset:19456
    buffer_load_dwordx4 a[224:227], v6, s[8:11], s62 offen offset:0
    v_mfma_f32_16x16x32_bf16 v[76:79], a[148:151], v[176:179], v[76:79]
    ds_read_b128 v[156:159], v14 offset:19456
    buffer_load_dwordx4 v6, s[8:11], s61 offen offset:1024 sc1 lds
    v_mfma_f32_16x16x32_bf16 v[80:83], a[148:151], v[180:183], v[80:83]
    ds_read_b128 v[160:163], v15 offset:19456
    s_waitcnt vmcnt(12)
    v_mfma_f32_16x16x32_bf16 v[84:87], v[184:187], v[168:171], v[84:87]
    ds_read_b128 v[164:167], v27 offset:27648
    s_barrier
    s_waitcnt lgkmcnt(5)
    v_mfma_f32_16x16x32_bf16 v[68:71], a[152:155], v[128:131], v[68:71]
    ds_read_b128 v[168:171], v12 offset:0
    buffer_load_dwordx4 a[228:231], v6, s[8:11], s62 offen offset:1024
    v_mfma_f32_16x16x32_bf16 v[72:75], a[152:155], v[132:135], v[72:75]
    ds_read_b128 v[172:175], v13 offset:0
    s_add_u32 m0, s29, 14336
    v_mfma_f32_16x16x32_bf16 v[76:79], a[152:155], v[136:139], v[76:79]
    ds_read_b128 v[176:179], v14 offset:0
    s_add_u32 s61, s53, 0x1465800
    v_mfma_f32_16x16x32_bf16 v[80:83], a[152:155], v[140:143], v[80:83]
    ds_read_b128 v[180:183], v15 offset:0
    buffer_load_dwordx4 v6, s[8:11], s61 offen offset:0 sc1 lds
    v_mfma_f32_16x16x32_bf16 v[84:87], v[144:147], v[128:131], v[84:87]
    ds_read_b128 v[184:187], v27 offset:30720
    s_waitcnt lgkmcnt(5)
    v_mfma_f32_16x16x32_bf16 v[68:71], a[156:159], v[148:151], v[68:71]
    ds_read_b128 v[128:131], v12 offset:1024
    s_add_u32 s62, s26, 11550720
    v_mfma_f32_16x16x32_bf16 v[72:75], a[156:159], v[152:155], v[72:75]
    ds_read_b128 v[132:135], v13 offset:1024
    buffer_load_dwordx4 a[232:235], v6, s[8:11], s62 offen offset:2048
    v_mfma_f32_16x16x32_bf16 v[76:79], a[156:159], v[156:159], v[76:79]
    ds_read_b128 v[136:139], v14 offset:1024
    buffer_load_dwordx4 v6, s[8:11], s61 offen offset:1024 sc1 lds
    v_mfma_f32_16x16x32_bf16 v[80:83], a[156:159], v[160:163], v[80:83]
    ds_read_b128 v[140:143], v15 offset:1024
    v_mfma_f32_16x16x32_bf16 v[84:87], v[164:167], v[148:151], v[84:87]
    ds_read_b128 v[144:147], v27 offset:31744
    s_waitcnt lgkmcnt(5)
    v_mfma_f32_16x16x32_bf16 v[68:71], a[160:163], v[168:171], v[68:71]
    ds_read_b128 v[148:151], v12 offset:2048
    buffer_load_dwordx4 a[236:239], v6, s[8:11], s62 offen offset:3072
    v_mfma_f32_16x16x32_bf16 v[72:75], a[160:163], v[172:175], v[72:75]
    ds_read_b128 v[152:155], v13 offset:2048
    s_add_u32 m0, s29, 16384
    v_mfma_f32_16x16x32_bf16 v[76:79], a[160:163], v[176:179], v[76:79]
    ds_read_b128 v[156:159], v14 offset:2048
    s_add_u32 s61, s53, 0x1467000
    v_mfma_f32_16x16x32_bf16 v[80:83], a[160:163], v[180:183], v[80:83]
    ds_read_b128 v[160:163], v15 offset:2048
    buffer_load_dwordx4 v6, s[8:11], s61 offen offset:0 sc1 lds
    v_mfma_f32_16x16x32_bf16 v[84:87], v[184:187], v[168:171], v[84:87]
    ds_read_b128 v[164:167], v27 offset:32768
    s_waitcnt lgkmcnt(5)
    v_mfma_f32_16x16x32_bf16 v[68:71], a[164:167], v[128:131], v[68:71]
    ds_read_b128 v[168:171], v12 offset:3072
    s_add_u32 s62, s26, 11558912
    v_mfma_f32_16x16x32_bf16 v[72:75], a[164:167], v[132:135], v[72:75]
    ds_read_b128 v[172:175], v13 offset:3072
    buffer_load_dwordx4 a[240:243], v6, s[8:11], s62 offen offset:0
    v_mfma_f32_16x16x32_bf16 v[76:79], a[164:167], v[136:139], v[76:79]
    ds_read_b128 v[176:179], v14 offset:3072
    buffer_load_dwordx4 v6, s[8:11], s61 offen offset:1024 sc1 lds
    v_mfma_f32_16x16x32_bf16 v[80:83], a[164:167], v[140:143], v[80:83]
    ds_read_b128 v[180:183], v15 offset:3072
    s_waitcnt vmcnt(16)
    v_mfma_f32_16x16x32_bf16 v[84:87], v[144:147], v[128:131], v[84:87]
    ds_read_b128 v[184:187], v27 offset:33792
    s_barrier
    s_waitcnt lgkmcnt(5)
    v_mfma_f32_16x16x32_bf16 v[68:71], a[168:171], v[148:151], v[68:71]
    ds_read_b128 v[128:131], v12 offset:4096
    buffer_load_dwordx4 a[244:247], v6, s[8:11], s62 offen offset:1024
    v_mfma_f32_16x16x32_bf16 v[72:75], a[168:171], v[152:155], v[72:75]
    ds_read_b128 v[132:135], v13 offset:4096
    s_add_u32 m0, s29, 18432
    v_mfma_f32_16x16x32_bf16 v[76:79], a[168:171], v[156:159], v[76:79]
    ds_read_b128 v[136:139], v14 offset:4096
    s_add_u32 s61, s53, 0x1468800
    v_mfma_f32_16x16x32_bf16 v[80:83], a[168:171], v[160:163], v[80:83]
    ds_read_b128 v[140:143], v15 offset:4096
    buffer_load_dwordx4 v6, s[8:11], s61 offen offset:0 sc1 lds
    v_mfma_f32_16x16x32_bf16 v[84:87], v[164:167], v[148:151], v[84:87]
    ds_read_b128 v[144:147], v27 offset:36864
    s_waitcnt lgkmcnt(5)
    v_mfma_f32_16x16x32_bf16 v[68:71], a[172:175], v[168:171], v[68:71]
    ds_read_b128 v[148:151], v12 offset:5120
    s_add_u32 s62, s26, 11563008
    v_mfma_f32_16x16x32_bf16 v[72:75], a[172:175], v[172:175], v[72:75]
    ds_read_b128 v[152:155], v13 offset:5120
    buffer_load_dwordx4 a[248:251], v6, s[8:11], s62 offen offset:2048
    v_mfma_f32_16x16x32_bf16 v[76:79], a[172:175], v[176:179], v[76:79]
    ds_read_b128 v[156:159], v14 offset:5120
    buffer_load_dwordx4 v6, s[8:11], s61 offen offset:1024 sc1 lds
    v_mfma_f32_16x16x32_bf16 v[80:83], a[172:175], v[180:183], v[80:83]
    ds_read_b128 v[160:163], v15 offset:5120
    v_mfma_f32_16x16x32_bf16 v[84:87], v[184:187], v[168:171], v[84:87]
    ds_read_b128 v[164:167], v27 offset:37888
    s_waitcnt lgkmcnt(5)
    v_mfma_f32_16x16x32_bf16 v[68:71], a[176:179], v[128:131], v[68:71]
    ds_read_b128 v[168:171], v12 offset:6144
    buffer_load_dwordx4 a[252:255], v6, s[8:11], s62 offen offset:3072
    v_mfma_f32_16x16x32_bf16 v[72:75], a[176:179], v[132:135], v[72:75]
    ds_read_b128 v[172:175], v13 offset:6144
    s_add_u32 m0, s29, 0
    v_mfma_f32_16x16x32_bf16 v[76:79], a[176:179], v[136:139], v[76:79]
    ds_read_b128 v[176:179], v14 offset:6144
    s_add_u32 s61, s53, 0x146a000
    v_mfma_f32_16x16x32_bf16 v[80:83], a[176:179], v[140:143], v[80:83]
    ds_read_b128 v[180:183], v15 offset:6144
    buffer_load_dwordx4 v6, s[8:11], s61 offen offset:0 sc1 lds
    v_mfma_f32_16x16x32_bf16 v[84:87], v[144:147], v[128:131], v[84:87]
    ds_read_b128 v[184:187], v27 offset:38912
    s_waitcnt lgkmcnt(5)
    v_mfma_f32_16x16x32_bf16 v[68:71], a[180:183], v[148:151], v[68:71]
    ds_read_b128 v[128:131], v12 offset:7168
    s_add_u32 s62, s26, 11571200
    v_mfma_f32_16x16x32_bf16 v[72:75], a[180:183], v[152:155], v[72:75]
    ds_read_b128 v[132:135], v13 offset:7168
    buffer_load_dwordx4 v[192:195], v6, s[8:11], s62 offen offset:0
    v_mfma_f32_16x16x32_bf16 v[76:79], a[180:183], v[156:159], v[76:79]
    ds_read_b128 v[136:139], v14 offset:7168
    buffer_load_dwordx4 v6, s[8:11], s61 offen offset:1024 sc1 lds
    v_mfma_f32_16x16x32_bf16 v[80:83], a[180:183], v[160:163], v[80:83]
    ds_read_b128 v[140:143], v15 offset:7168
    s_waitcnt vmcnt(19)
    v_mfma_f32_16x16x32_bf16 v[84:87], v[164:167], v[148:151], v[84:87]
    ds_read_b128 v[144:147], v27 offset:39936
    s_barrier
    s_waitcnt lgkmcnt(5)
    v_mfma_f32_16x16x32_bf16 v[68:71], a[184:187], v[168:171], v[68:71]
    ds_read_b128 v[148:151], v12 offset:8192
    buffer_load_dwordx4 v[196:199], v6, s[8:11], s62 offen offset:1024
    v_mfma_f32_16x16x32_bf16 v[72:75], a[184:187], v[172:175], v[72:75]
    ds_read_b128 v[152:155], v13 offset:8192
    s_add_u32 m0, s29, 2048
    v_mfma_f32_16x16x32_bf16 v[76:79], a[184:187], v[176:179], v[76:79]
    ds_read_b128 v[156:159], v14 offset:8192
    s_add_u32 s61, s53, 0x146b800
    v_mfma_f32_16x16x32_bf16 v[80:83], a[184:187], v[180:183], v[80:83]
    ds_read_b128 v[160:163], v15 offset:8192
    buffer_load_dwordx4 v6, s[8:11], s61 offen offset:0 sc1 lds
    v_mfma_f32_16x16x32_bf16 v[84:87], v[184:187], v[168:171], v[84:87]
    ds_read_b128 v[164:167], v27 offset:43008
    s_waitcnt lgkmcnt(5)
    v_mfma_f32_16x16x32_bf16 v[68:71], a[188:191], v[128:131], v[68:71]
    ds_read_b128 v[168:171], v12 offset:9216
    s_add_u32 s62, s26, 11575296
    v_mfma_f32_16x16x32_bf16 v[72:75], a[188:191], v[132:135], v[72:75]
    ds_read_b128 v[172:175], v13 offset:9216
    buffer_load_dwordx4 v[200:203], v6, s[8:11], s62 offen offset:2048
    v_mfma_f32_16x16x32_bf16 v[76:79], a[188:191], v[136:139], v[76:79]
    ds_read_b128 v[176:179], v14 offset:9216
    buffer_load_dwordx4 v6, s[8:11], s61 offen offset:1024 sc1 lds
    v_mfma_f32_16x16x32_bf16 v[80:83], a[188:191], v[140:143], v[80:83]
    ds_read_b128 v[180:183], v15 offset:9216
    v_mfma_f32_16x16x32_bf16 v[84:87], v[144:147], v[128:131], v[84:87]
    ds_read_b128 v[184:187], v27 offset:44032
    s_waitcnt lgkmcnt(5)
    v_mfma_f32_16x16x32_bf16 v[68:71], a[192:195], v[148:151], v[68:71]
    ds_read_b128 v[128:131], v12 offset:10240
    buffer_load_dwordx4 v[204:207], v6, s[8:11], s62 offen offset:3072
    v_mfma_f32_16x16x32_bf16 v[72:75], a[192:195], v[152:155], v[72:75]
    ds_read_b128 v[132:135], v13 offset:10240
    s_add_u32 m0, s29, 4096
    v_mfma_f32_16x16x32_bf16 v[76:79], a[192:195], v[156:159], v[76:79]
    ds_read_b128 v[136:139], v14 offset:10240
    s_add_u32 s61, s53, 0x146d000
    v_mfma_f32_16x16x32_bf16 v[80:83], a[192:195], v[160:163], v[80:83]
    ds_read_b128 v[140:143], v15 offset:10240
    buffer_load_dwordx4 v6, s[8:11], s61 offen offset:0 sc1 lds
    v_mfma_f32_16x16x32_bf16 v[84:87], v[164:167], v[148:151], v[84:87]
    ds_read_b128 v[144:147], v27 offset:45056
    s_waitcnt lgkmcnt(5)
    v_mfma_f32_16x16x32_bf16 v[68:71], a[196:199], v[168:171], v[68:71]
    ds_read_b128 v[148:151], v12 offset:11264
    buffer_load_dwordx4 v6, s[8:11], s61 offen offset:1024 sc1 lds
    v_mfma_f32_16x16x32_bf16 v[72:75], a[196:199], v[172:175], v[72:75]
    ds_read_b128 v[152:155], v13 offset:11264
    s_waitcnt vmcnt(19)
    v_mfma_f32_16x16x32_bf16 v[76:79], a[196:199], v[176:179], v[76:79]
    ds_read_b128 v[156:159], v14 offset:11264
    s_barrier
    v_mfma_f32_16x16x32_bf16 v[80:83], a[196:199], v[180:183], v[80:83]
    ds_read_b128 v[160:163], v15 offset:11264
    v_mfma_f32_16x16x32_bf16 v[84:87], v[184:187], v[168:171], v[84:87]
    ds_read_b128 v[164:167], v27 offset:46080
    s_waitcnt lgkmcnt(5)
    v_mfma_f32_16x16x32_bf16 v[68:71], a[200:203], v[128:131], v[68:71]
    ds_read_b128 v[168:171], v12 offset:12288
    s_add_u32 m0, s29, 6144
    v_mfma_f32_16x16x32_bf16 v[72:75], a[200:203], v[132:135], v[72:75]
    ds_read_b128 v[172:175], v13 offset:12288
    s_add_u32 s61, s53, 0x146e800
    v_mfma_f32_16x16x32_bf16 v[76:79], a[200:203], v[136:139], v[76:79]
    ds_read_b128 v[176:179], v14 offset:12288
    buffer_load_dwordx4 v6, s[8:11], s61 offen offset:0 sc1 lds
    v_mfma_f32_16x16x32_bf16 v[80:83], a[200:203], v[140:143], v[80:83]
    ds_read_b128 v[180:183], v15 offset:12288
    v_mfma_f32_16x16x32_bf16 v[84:87], v[144:147], v[128:131], v[84:87]
    ds_read_b128 v[184:187], v27 offset:4096
    s_waitcnt lgkmcnt(5)
    v_mfma_f32_16x16x32_bf16 v[68:71], a[204:207], v[148:151], v[68:71]
    ds_read_b128 v[128:131], v12 offset:13312
    buffer_load_dwordx4 v6, s[8:11], s61 offen offset:1024 sc1 lds
    v_mfma_f32_16x16x32_bf16 v[72:75], a[204:207], v[152:155], v[72:75]
    ds_read_b128 v[132:135], v13 offset:13312
    v_mfma_f32_16x16x32_bf16 v[76:79], a[204:207], v[156:159], v[76:79]
    ds_read_b128 v[136:139], v14 offset:13312
    v_mfma_f32_16x16x32_bf16 v[80:83], a[204:207], v[160:163], v[80:83]
    ds_read_b128 v[140:143], v15 offset:13312
    v_mfma_f32_16x16x32_bf16 v[84:87], v[164:167], v[148:151], v[84:87]
    ds_read_b128 v[144:147], v27 offset:5120
    s_waitcnt lgkmcnt(5)
    v_mfma_f32_16x16x32_bf16 v[68:71], a[208:211], v[168:171], v[68:71]
    ds_read_b128 v[148:151], v12 offset:14336
    v_mfma_f32_16x16x32_bf16 v[72:75], a[208:211], v[172:175], v[72:75]
    ds_read_b128 v[152:155], v13 offset:14336
    v_mfma_f32_16x16x32_bf16 v[76:79], a[208:211], v[176:179], v[76:79]
    ds_read_b128 v[156:159], v14 offset:14336
    v_mfma_f32_16x16x32_bf16 v[80:83], a[208:211], v[180:183], v[80:83]
    ds_read_b128 v[160:163], v15 offset:14336
    v_mfma_f32_16x16x32_bf16 v[84:87], v[184:187], v[168:171], v[84:87]
    ds_read_b128 v[164:167], v27 offset:10240
    s_waitcnt lgkmcnt(5)
    v_mfma_f32_16x16x32_bf16 v[68:71], a[212:215], v[128:131], v[68:71]
    ds_read_b128 v[168:171], v12 offset:15360
    s_waitcnt vmcnt(13)
    v_mfma_f32_16x16x32_bf16 v[72:75], a[212:215], v[132:135], v[72:75]
    ds_read_b128 v[172:175], v13 offset:15360
    s_barrier
    v_mfma_f32_16x16x32_bf16 v[76:79], a[212:215], v[136:139], v[76:79]
    ds_read_b128 v[176:179], v14 offset:15360
    v_mfma_f32_16x16x32_bf16 v[80:83], a[212:215], v[140:143], v[80:83]
    ds_read_b128 v[180:183], v15 offset:15360
    v_mfma_f32_16x16x32_bf16 v[84:87], v[144:147], v[128:131], v[84:87]
    ds_read_b128 v[184:187], v27 offset:11264
    s_waitcnt lgkmcnt(5)
    v_mfma_f32_16x16x32_bf16 v[68:71], a[216:219], v[148:151], v[68:71]
    ds_read_b128 v[128:131], v12 offset:16384
    v_mfma_f32_16x16x32_bf16 v[72:75], a[216:219], v[152:155], v[72:75]
    ds_read_b128 v[132:135], v13 offset:16384
    v_mfma_f32_16x16x32_bf16 v[76:79], a[216:219], v[156:159], v[76:79]
    ds_read_b128 v[136:139], v14 offset:16384
    v_mfma_f32_16x16x32_bf16 v[80:83], a[216:219], v[160:163], v[80:83]
    ds_read_b128 v[140:143], v15 offset:16384
    v_mfma_f32_16x16x32_bf16 v[84:87], v[164:167], v[148:151], v[84:87]
    ds_read_b128 v[144:147], v27 offset:16384
    s_waitcnt lgkmcnt(5)
    v_mfma_f32_16x16x32_bf16 v[68:71], a[220:223], v[168:171], v[68:71]
    ds_read_b128 v[148:151], v12 offset:17408
    v_mfma_f32_16x16x32_bf16 v[72:75], a[220:223], v[172:175], v[72:75]
    ds_read_b128 v[152:155], v13 offset:17408
    v_mfma_f32_16x16x32_bf16 v[76:79], a[220:223], v[176:179], v[76:79]
    ds_read_b128 v[156:159], v14 offset:17408
    v_mfma_f32_16x16x32_bf16 v[80:83], a[220:223], v[180:183], v[80:83]
    ds_read_b128 v[160:163], v15 offset:17408
    v_mfma_f32_16x16x32_bf16 v[84:87], v[184:187], v[168:171], v[84:87]
    ds_read_b128 v[164:167], v27 offset:17408
    s_waitcnt lgkmcnt(5)
    v_mfma_f32_16x16x32_bf16 v[68:71], a[224:227], v[128:131], v[68:71]
    ds_read_b128 v[168:171], v12 offset:18432
    v_mfma_f32_16x16x32_bf16 v[72:75], a[224:227], v[132:135], v[72:75]
    ds_read_b128 v[172:175], v13 offset:18432
    v_mfma_f32_16x16x32_bf16 v[76:79], a[224:227], v[136:139], v[76:79]
    ds_read_b128 v[176:179], v14 offset:18432
    v_mfma_f32_16x16x32_bf16 v[80:83], a[224:227], v[140:143], v[80:83]
    ds_read_b128 v[180:183], v15 offset:18432
    v_mfma_f32_16x16x32_bf16 v[84:87], v[144:147], v[128:131], v[84:87]
    ds_read_b128 v[184:187], v27 offset:22528
    s_waitcnt lgkmcnt(5)
    v_mfma_f32_16x16x32_bf16 v[68:71], a[228:231], v[148:151], v[68:71]
    ds_read_b128 v[128:131], v12 offset:19456
    s_waitcnt vmcnt(5)
    v_mfma_f32_16x16x32_bf16 v[72:75], a[228:231], v[152:155], v[72:75]
    ds_read_b128 v[132:135], v13 offset:19456
    s_barrier
    v_mfma_f32_16x16x32_bf16 v[76:79], a[228:231], v[156:159], v[76:79]
    ds_read_b128 v[136:139], v14 offset:19456
    v_mfma_f32_16x16x32_bf16 v[80:83], a[228:231], v[160:163], v[80:83]
    ds_read_b128 v[140:143], v15 offset:19456
    v_mfma_f32_16x16x32_bf16 v[84:87], v[164:167], v[148:151], v[84:87]
    ds_read_b128 v[144:147], v27 offset:23552
    s_waitcnt lgkmcnt(5)
    v_mfma_f32_16x16x32_bf16 v[68:71], a[232:235], v[168:171], v[68:71]
    ds_read_b128 v[148:151], v12 offset:0
    v_mfma_f32_16x16x32_bf16 v[72:75], a[232:235], v[172:175], v[72:75]
    ds_read_b128 v[152:155], v13 offset:0
    v_mfma_f32_16x16x32_bf16 v[76:79], a[232:235], v[176:179], v[76:79]
    ds_read_b128 v[156:159], v14 offset:0
    v_mfma_f32_16x16x32_bf16 v[80:83], a[232:235], v[180:183], v[80:83]
    ds_read_b128 v[160:163], v15 offset:0
    v_mfma_f32_16x16x32_bf16 v[84:87], v[184:187], v[168:171], v[84:87]
    ds_read_b128 v[164:167], v27 offset:28672
    s_waitcnt lgkmcnt(5)
    v_mfma_f32_16x16x32_bf16 v[68:71], a[236:239], v[128:131], v[68:71]
    ds_read_b128 v[168:171], v12 offset:1024
    v_mfma_f32_16x16x32_bf16 v[72:75], a[236:239], v[132:135], v[72:75]
    ds_read_b128 v[172:175], v13 offset:1024
    v_mfma_f32_16x16x32_bf16 v[76:79], a[236:239], v[136:139], v[76:79]
    ds_read_b128 v[176:179], v14 offset:1024
    v_mfma_f32_16x16x32_bf16 v[80:83], a[236:239], v[140:143], v[80:83]
    ds_read_b128 v[180:183], v15 offset:1024
    v_mfma_f32_16x16x32_bf16 v[84:87], v[144:147], v[128:131], v[84:87]
    ds_read_b128 v[184:187], v27 offset:29696
    s_waitcnt lgkmcnt(5)
    v_mfma_f32_16x16x32_bf16 v[68:71], a[240:243], v[148:151], v[68:71]
    ds_read_b128 v[128:131], v12 offset:2048
    v_mfma_f32_16x16x32_bf16 v[72:75], a[240:243], v[152:155], v[72:75]
    ds_read_b128 v[132:135], v13 offset:2048
    v_mfma_f32_16x16x32_bf16 v[76:79], a[240:243], v[156:159], v[76:79]
    ds_read_b128 v[136:139], v14 offset:2048
    v_mfma_f32_16x16x32_bf16 v[80:83], a[240:243], v[160:163], v[80:83]
    ds_read_b128 v[140:143], v15 offset:2048
    v_mfma_f32_16x16x32_bf16 v[84:87], v[164:167], v[148:151], v[84:87]
    ds_read_b128 v[144:147], v27 offset:34816
    s_waitcnt lgkmcnt(5)
    v_mfma_f32_16x16x32_bf16 v[68:71], a[244:247], v[168:171], v[68:71]
    ds_read_b128 v[148:151], v12 offset:3072
    s_waitcnt vmcnt(0)
    v_mfma_f32_16x16x32_bf16 v[72:75], a[244:247], v[172:175], v[72:75]
    ds_read_b128 v[152:155], v13 offset:3072
    s_barrier
    v_mfma_f32_16x16x32_bf16 v[76:79], a[244:247], v[176:179], v[76:79]
    ds_read_b128 v[156:159], v14 offset:3072
    v_mfma_f32_16x16x32_bf16 v[80:83], a[244:247], v[180:183], v[80:83]
    ds_read_b128 v[160:163], v15 offset:3072
    v_mfma_f32_16x16x32_bf16 v[84:87], v[184:187], v[168:171], v[84:87]
    ds_read_b128 v[164:167], v27 offset:35840
    s_waitcnt lgkmcnt(5)
    v_mfma_f32_16x16x32_bf16 v[68:71], a[248:251], v[128:131], v[68:71]
    ds_read_b128 v[168:171], v12 offset:4096
    v_mfma_f32_16x16x32_bf16 v[72:75], a[248:251], v[132:135], v[72:75]
    ds_read_b128 v[172:175], v13 offset:4096
    v_mfma_f32_16x16x32_bf16 v[76:79], a[248:251], v[136:139], v[76:79]
    ds_read_b128 v[176:179], v14 offset:4096
    v_mfma_f32_16x16x32_bf16 v[80:83], a[248:251], v[140:143], v[80:83]
    ds_read_b128 v[180:183], v15 offset:4096
    v_mfma_f32_16x16x32_bf16 v[84:87], v[144:147], v[128:131], v[84:87]
    ds_read_b128 v[184:187], v27 offset:40960
    s_waitcnt lgkmcnt(5)
    v_mfma_f32_16x16x32_bf16 v[68:71], a[252:255], v[148:151], v[68:71]
    ds_read_b128 v[128:131], v12 offset:5120
    v_mfma_f32_16x16x32_bf16 v[72:75], a[252:255], v[152:155], v[72:75]
    ds_read_b128 v[132:135], v13 offset:5120
    v_mfma_f32_16x16x32_bf16 v[76:79], a[252:255], v[156:159], v[76:79]
    ds_read_b128 v[136:139], v14 offset:5120
    v_mfma_f32_16x16x32_bf16 v[80:83], a[252:255], v[160:163], v[80:83]
    ds_read_b128 v[140:143], v15 offset:5120
    v_mfma_f32_16x16x32_bf16 v[84:87], v[164:167], v[148:151], v[84:87]
    ds_read_b128 v[144:147], v27 offset:41984
    s_waitcnt lgkmcnt(5)
    v_mfma_f32_16x16x32_bf16 v[68:71], v[192:195], v[168:171], v[68:71]
    ds_read_b128 v[148:151], v12 offset:6144
    v_mfma_f32_16x16x32_bf16 v[72:75], v[192:195], v[172:175], v[72:75]
    ds_read_b128 v[152:155], v13 offset:6144
    v_mfma_f32_16x16x32_bf16 v[76:79], v[192:195], v[176:179], v[76:79]
    ds_read_b128 v[156:159], v14 offset:6144
    v_mfma_f32_16x16x32_bf16 v[80:83], v[192:195], v[180:183], v[80:83]
    ds_read_b128 v[160:163], v15 offset:6144
    v_mfma_f32_16x16x32_bf16 v[84:87], v[184:187], v[168:171], v[84:87]
    ds_read_b128 v[164:167], v27 offset:47104
    s_waitcnt lgkmcnt(5)
    v_mfma_f32_16x16x32_bf16 v[68:71], v[196:199], v[128:131], v[68:71]
    ds_read_b128 v[168:171], v12 offset:7168
    v_mfma_f32_16x16x32_bf16 v[72:75], v[196:199], v[132:135], v[72:75]
    ds_read_b128 v[172:175], v13 offset:7168
    v_mfma_f32_16x16x32_bf16 v[76:79], v[196:199], v[136:139], v[76:79]
    ds_read_b128 v[176:179], v14 offset:7168
    v_mfma_f32_16x16x32_bf16 v[80:83], v[196:199], v[140:143], v[80:83]
    ds_read_b128 v[180:183], v15 offset:7168
    v_mfma_f32_16x16x32_bf16 v[84:87], v[144:147], v[128:131], v[84:87]
    ds_read_b128 v[184:187], v27 offset:48128
    s_waitcnt lgkmcnt(5)
    v_mfma_f32_16x16x32_bf16 v[68:71], v[200:203], v[148:151], v[68:71]
    v_mfma_f32_16x16x32_bf16 v[72:75], v[200:203], v[152:155], v[72:75]
    v_mfma_f32_16x16x32_bf16 v[76:79], v[200:203], v[156:159], v[76:79]
    v_mfma_f32_16x16x32_bf16 v[80:83], v[200:203], v[160:163], v[80:83]
    v_mfma_f32_16x16x32_bf16 v[84:87], v[164:167], v[148:151], v[84:87]
    s_waitcnt lgkmcnt(0)
    v_mfma_f32_16x16x32_bf16 v[68:71], v[204:207], v[168:171], v[68:71]
    v_mfma_f32_16x16x32_bf16 v[72:75], v[204:207], v[172:175], v[72:75]
    v_mfma_f32_16x16x32_bf16 v[76:79], v[204:207], v[176:179], v[76:79]
    v_mfma_f32_16x16x32_bf16 v[80:83], v[204:207], v[180:183], v[80:83]
    v_mfma_f32_16x16x32_bf16 v[84:87], v[184:187], v[168:171], v[84:87]
    s_lshl_b32 s61, s17, 5
    s_lshl_b32 s60, s16, 5
    s_nop 5
    v_permlane16_swap_b32 v68, v72
    v_permlane16_swap_b32 v69, v73
    v_permlane16_swap_b32 v70, v74
    v_permlane16_swap_b32 v71, v75
    v_pk_add_f32 v[68:69], v[68:69], v[40:41]
    v_pk_add_f32 v[70:71], v[70:71], v[42:43]
    v_pk_add_f32 v[72:73], v[72:73], v[44:45]
    v_pk_add_f32 v[74:75], v[74:75], v[46:47]
    v_cvt_pk_bf16_f32 v144, v68, v69
    v_cvt_pk_bf16_f32 v145, v70, v71
    v_cvt_pk_bf16_f32 v146, v72, v73
    v_cvt_pk_bf16_f32 v147, v74, v75
    buffer_store_dwordx4 v[144:147], v8, s[12:15], s60 offen
    v_permlane16_swap_b32 v76, v80
    v_permlane16_swap_b32 v77, v81
    v_permlane16_swap_b32 v78, v82
    v_permlane16_swap_b32 v79, v83
    v_pk_add_f32 v[76:77], v[76:77], v[48:49]
    v_pk_add_f32 v[78:79], v[78:79], v[50:51]
    v_pk_add_f32 v[80:81], v[80:81], v[52:53]
    v_pk_add_f32 v[82:83], v[82:83], v[54:55]
    v_cvt_pk_bf16_f32 v148, v76, v77
    v_cvt_pk_bf16_f32 v149, v78, v79
    v_cvt_pk_bf16_f32 v150, v80, v81
    v_cvt_pk_bf16_f32 v151, v82, v83
    buffer_store_dwordx4 v[148:151], v9, s[12:15], s60 offen
    v_pk_add_f32 v[84:85], v[84:85], v[56:57]
    v_pk_add_f32 v[86:87], v[86:87], v[58:59]
    v_cvt_pk_bf16_f32 v152, v84, v85
    v_cvt_pk_bf16_f32 v153, v86, v87
    buffer_store_dwordx2 v[152:153], v10, s[12:15], s61 offen
D_END:
    s_endpgm
D_EXIT:
    s_endpgm
D_CODE_END:
.section .rodata,"a"
.p2align 6
.amdhsa_kernel sequential_preLN__ssm_conv_s4__mixer_s_mlp__prompt_kernel
  .amdhsa_next_free_vgpr 512
  .amdhsa_next_free_sgpr 102
  .amdhsa_accum_offset 256
  .amdhsa_group_segment_fixed_size 0
  .amdhsa_kernarg_size 136
  .amdhsa_user_sgpr_count 2
  .amdhsa_user_sgpr_kernarg_segment_ptr 1
  .amdhsa_system_sgpr_workgroup_id_x 1
.end_amdhsa_kernel
```
